```python
import torch

def _softmax(x, axis=-1):
    return torch.softmax(x, dim=axis)
def _gelu(x):
    return torch.nn.functional.gelu(x, approximate="tanh")
def _silu(x):
    return torch.nn.functional.silu(x)
def _sigmoid(x):
    return torch.sigmoid(x)
def _layernorm(x, axis=-1, eps=1e-5):
    m = x.mean(dim=axis, keepdim=True)
    v = x.var(dim=axis, keepdim=True, unbiased=False)
    return (x - m) / torch.sqrt(v + eps)
def _scatter_add(tgt, idx, src, axis=0):
    return tgt.clone().index_add_(axis, idx, src)
def _segment_sum(src, seg, n):
    out = torch.zeros((n,) + src.shape[1:], dtype=src.dtype)
    return out.index_add_(0, seg, src)
def _pad(x, pw):
    flat = tuple(v for pair in reversed(pw) for v in pair)
    return torch.nn.functional.pad(x, flat)

kernel_name = 'recurrent_scan__linear_kernel_hedgehog__dense_activation_gelu__prompt'

def setup_inputs():

    _w = (lambda a: (lambda t: t.to(torch.bfloat16) if t.is_floating_point() else t)(torch.as_tensor(a)))
    def _A_setup():
        B, S, D, H = 1, 2048, 576, 32
        Dh = D // H
        return {
            "x": _w((lambda *s: torch.randn(*s, dtype=torch.bfloat16) * 0.05)(B, S, D)),
            "wqkv": _w((lambda *s: torch.randn(*s, dtype=torch.bfloat16) * 0.4)(D, 3 * D)),
            "w_phi": _w((lambda *s: torch.randn(*s, dtype=torch.bfloat16) * 0.4)(H, Dh, Dh) * (Dh ** -0.5)),
            "wo": _w((lambda *s: torch.randn(*s, dtype=torch.bfloat16) * 0.2)(D, D)),
        }
    _A_in = _A_setup()

    def _B_setup():
        B, S, D, F = 1, 2048, 576, 4608
        return {
            "x": _w((lambda *s: torch.randn(*s, dtype=torch.bfloat16) * 0.05)(B, S, D)),
            "w1": _w((lambda *s: torch.randn(*s, dtype=torch.bfloat16) * 0.4)(D, F) * (D ** -0.5)),
            "b1": _w((lambda *s: torch.randn(*s, dtype=torch.bfloat16) * 12.8)(F) * 0.01),
            "w2": _w((lambda *s: torch.randn(*s, dtype=torch.bfloat16) * 0.1)(F, D) * (F ** -0.5)),
            "b2": _w((lambda *s: torch.randn(*s, dtype=torch.bfloat16) * 0.8)(D) * 0.01),
        }
    _B_in = _B_setup()

    return {
        "A_x": _A_in["x"],
        "A_wqkv": _A_in["wqkv"],
        "A_w_phi": _A_in["w_phi"],
        "A_wo": _A_in["wo"],
        "B_x": _B_in["x"],
        "B_w1": _B_in["w1"],
        "B_b1": _B_in["b1"],
        "B_w2": _B_in["w2"],
        "B_b2": _B_in["b2"],
    }

def reference(A_x, A_wqkv, A_w_phi, A_wo, B_x, B_w1, B_b1, B_w2, B_b2):
    def _A_ref(x, wqkv, w_phi, wo):
        B, S, D = x.shape
        H = 32; Dh = D // H
        qkv = (lambda x, *d: x.permute(*d))((x @ wqkv).reshape(B, S, 3, H, Dh), 2, 0, 3, 1, 4)
        q, k, v = qkv[0], qkv[1], qkv[2]
        pq = torch.einsum("bhsd,hdf->bhsf", q, w_phi)
        pk = torch.einsum("bhsd,hdf->bhsf", k, w_phi)
        phi_q = torch.concatenate([_softmax(pq, axis=-1), _softmax(-pq, axis=-1)], axis=-1)
        phi_k = torch.concatenate([_softmax(pk, axis=-1), _softmax(-pk, axis=-1)], axis=-1)
        kv = torch.einsum("bhsf,bhsd->bhfd", phi_k, v)
        z  = torch.einsum("bhsf->bhf", phi_k)
        num = torch.einsum("bhqf,bhfd->bhqd", phi_q, kv)
        den = torch.einsum("bhqf,bhf->bhq", phi_q, z)[..., None] + 1e-6
        o = num / den
        return (lambda x, *d: x.permute(*d))(o, 0, 2, 1, 3).reshape(B, S, D) @ wo

    def _B_ref(x, w1, b1, w2, b2):
        h = torch.einsum("bsd,df->bsf", x, w1) + b1
        h = _gelu(h)
        return torch.einsum("bsf,fd->bsd", h, w2) + b2

    x = A_x
    xn = _layernorm(x, axis=-1)
    s = _A_ref(xn, A_wqkv, A_w_phi, A_wo)
    g = _silu(_B_ref(xn, B_w1, B_b1, B_w2, B_b2))
    return x + s * g
```

```asm
; @launch kernel=ln_kernel grid=(64,1,1) block=(256,1,1) lds=0
; @launch kernel=gemm1_kernel grid=(528,1,1) block=(256,1,1) lds=81920
; @launch kernel=attna_kernel grid=(256,1,1) block=(256,1,1) lds=52736
; @launch kernel=attnb_kernel grid=(256,1,1) block=(256,1,1) lds=8192
; @launch kernel=gemm5_kernel grid=(240,1,1) block=(256,1,1) lds=143360
; @launch kernel=reduce_kernel grid=(576,1,1) block=(256,1,1) lds=0
.amdgcn_target "amdgcn-amd-amdhsa--gfx950"
.text
.globl ln_kernel
.p2align 8
.type ln_kernel,@function
ln_kernel:
    s_cmp_ge_u32 s2, 64
    s_cbranch_scc1 .ln_end
    s_load_dwordx2 s[4:5], s[0:1], 0
    s_load_dwordx2 s[6:7], s[0:1], 88
    s_waitcnt lgkmcnt(0)
    s_mov_b32 s8, s4
    s_mov_b32 s9, s5
    s_mov_b32 s10, 2359296
    s_mov_b32 s11, 0x00020000
    s_mov_b32 s12, s6
    s_mov_b32 s13, s7
    s_mov_b32 s14, 2359296
    s_mov_b32 s15, 0x00020000
    v_lshrrev_b32 v1, 3, v0
    s_lshl_b32 s3, s2, 5
    v_add_u32 v1, s3, v1
    v_and_b32 v2, 7, v0
    v_mul_u32_u24 v1, 1152, v1
    v_lshl_add_u32 v1, v2, 4, v1
    buffer_load_dwordx4 v[8:11], v1, s[8:11], 0 offen offset:0
    buffer_load_dwordx4 v[12:15], v1, s[8:11], 0 offen offset:128
    buffer_load_dwordx4 v[16:19], v1, s[8:11], 0 offen offset:256
    buffer_load_dwordx4 v[20:23], v1, s[8:11], 0 offen offset:384
    buffer_load_dwordx4 v[24:27], v1, s[8:11], 0 offen offset:512
    buffer_load_dwordx4 v[28:31], v1, s[8:11], 0 offen offset:640
    buffer_load_dwordx4 v[32:35], v1, s[8:11], 0 offen offset:768
    buffer_load_dwordx4 v[36:39], v1, s[8:11], 0 offen offset:896
    buffer_load_dwordx4 v[40:43], v1, s[8:11], 0 offen offset:1024
    s_waitcnt vmcnt(0)
    v_lshlrev_b32 v48, 16, v8
    v_and_b32 v49, 0xffff0000, v8
    v_lshlrev_b32 v50, 16, v9
    v_and_b32 v51, 0xffff0000, v9
    v_lshlrev_b32 v52, 16, v10
    v_and_b32 v53, 0xffff0000, v10
    v_lshlrev_b32 v54, 16, v11
    v_and_b32 v55, 0xffff0000, v11
    v_lshlrev_b32 v56, 16, v12
    v_and_b32 v57, 0xffff0000, v12
    v_lshlrev_b32 v58, 16, v13
    v_and_b32 v59, 0xffff0000, v13
    v_lshlrev_b32 v60, 16, v14
    v_and_b32 v61, 0xffff0000, v14
    v_lshlrev_b32 v62, 16, v15
    v_and_b32 v63, 0xffff0000, v15
    v_lshlrev_b32 v64, 16, v16
    v_and_b32 v65, 0xffff0000, v16
    v_lshlrev_b32 v66, 16, v17
    v_and_b32 v67, 0xffff0000, v17
    v_lshlrev_b32 v68, 16, v18
    v_and_b32 v69, 0xffff0000, v18
    v_lshlrev_b32 v70, 16, v19
    v_and_b32 v71, 0xffff0000, v19
    v_lshlrev_b32 v72, 16, v20
    v_and_b32 v73, 0xffff0000, v20
    v_lshlrev_b32 v74, 16, v21
    v_and_b32 v75, 0xffff0000, v21
    v_lshlrev_b32 v76, 16, v22
    v_and_b32 v77, 0xffff0000, v22
    v_lshlrev_b32 v78, 16, v23
    v_and_b32 v79, 0xffff0000, v23
    v_lshlrev_b32 v80, 16, v24
    v_and_b32 v81, 0xffff0000, v24
    v_lshlrev_b32 v82, 16, v25
    v_and_b32 v83, 0xffff0000, v25
    v_lshlrev_b32 v84, 16, v26
    v_and_b32 v85, 0xffff0000, v26
    v_lshlrev_b32 v86, 16, v27
    v_and_b32 v87, 0xffff0000, v27
    v_lshlrev_b32 v88, 16, v28
    v_and_b32 v89, 0xffff0000, v28
    v_lshlrev_b32 v90, 16, v29
    v_and_b32 v91, 0xffff0000, v29
    v_lshlrev_b32 v92, 16, v30
    v_and_b32 v93, 0xffff0000, v30
    v_lshlrev_b32 v94, 16, v31
    v_and_b32 v95, 0xffff0000, v31
    v_lshlrev_b32 v96, 16, v32
    v_and_b32 v97, 0xffff0000, v32
    v_lshlrev_b32 v98, 16, v33
    v_and_b32 v99, 0xffff0000, v33
    v_lshlrev_b32 v100, 16, v34
    v_and_b32 v101, 0xffff0000, v34
    v_lshlrev_b32 v102, 16, v35
    v_and_b32 v103, 0xffff0000, v35
    v_lshlrev_b32 v104, 16, v36
    v_and_b32 v105, 0xffff0000, v36
    v_lshlrev_b32 v106, 16, v37
    v_and_b32 v107, 0xffff0000, v37
    v_lshlrev_b32 v108, 16, v38
    v_and_b32 v109, 0xffff0000, v38
    v_lshlrev_b32 v110, 16, v39
    v_and_b32 v111, 0xffff0000, v39
    v_lshlrev_b32 v112, 16, v40
    v_and_b32 v113, 0xffff0000, v40
    v_lshlrev_b32 v114, 16, v41
    v_and_b32 v115, 0xffff0000, v41
    v_lshlrev_b32 v116, 16, v42
    v_and_b32 v117, 0xffff0000, v42
    v_lshlrev_b32 v118, 16, v43
    v_and_b32 v119, 0xffff0000, v43
    v_add_f32 v2, v48, v49
    v_add_f32 v2, v2, v50
    v_add_f32 v2, v2, v51
    v_add_f32 v2, v2, v52
    v_add_f32 v2, v2, v53
    v_add_f32 v2, v2, v54
    v_add_f32 v2, v2, v55
    v_add_f32 v2, v2, v56
    v_add_f32 v2, v2, v57
    v_add_f32 v2, v2, v58
    v_add_f32 v2, v2, v59
    v_add_f32 v2, v2, v60
    v_add_f32 v2, v2, v61
    v_add_f32 v2, v2, v62
    v_add_f32 v2, v2, v63
    v_add_f32 v2, v2, v64
    v_add_f32 v2, v2, v65
    v_add_f32 v2, v2, v66
    v_add_f32 v2, v2, v67
    v_add_f32 v2, v2, v68
    v_add_f32 v2, v2, v69
    v_add_f32 v2, v2, v70
    v_add_f32 v2, v2, v71
    v_add_f32 v2, v2, v72
    v_add_f32 v2, v2, v73
    v_add_f32 v2, v2, v74
    v_add_f32 v2, v2, v75
    v_add_f32 v2, v2, v76
    v_add_f32 v2, v2, v77
    v_add_f32 v2, v2, v78
    v_add_f32 v2, v2, v79
    v_add_f32 v2, v2, v80
    v_add_f32 v2, v2, v81
    v_add_f32 v2, v2, v82
    v_add_f32 v2, v2, v83
    v_add_f32 v2, v2, v84
    v_add_f32 v2, v2, v85
    v_add_f32 v2, v2, v86
    v_add_f32 v2, v2, v87
    v_add_f32 v2, v2, v88
    v_add_f32 v2, v2, v89
    v_add_f32 v2, v2, v90
    v_add_f32 v2, v2, v91
    v_add_f32 v2, v2, v92
    v_add_f32 v2, v2, v93
    v_add_f32 v2, v2, v94
    v_add_f32 v2, v2, v95
    v_add_f32 v2, v2, v96
    v_add_f32 v2, v2, v97
    v_add_f32 v2, v2, v98
    v_add_f32 v2, v2, v99
    v_add_f32 v2, v2, v100
    v_add_f32 v2, v2, v101
    v_add_f32 v2, v2, v102
    v_add_f32 v2, v2, v103
    v_add_f32 v2, v2, v104
    v_add_f32 v2, v2, v105
    v_add_f32 v2, v2, v106
    v_add_f32 v2, v2, v107
    v_add_f32 v2, v2, v108
    v_add_f32 v2, v2, v109
    v_add_f32 v2, v2, v110
    v_add_f32 v2, v2, v111
    v_add_f32 v2, v2, v112
    v_add_f32 v2, v2, v113
    v_add_f32 v2, v2, v114
    v_add_f32 v2, v2, v115
    v_add_f32 v2, v2, v116
    v_add_f32 v2, v2, v117
    v_add_f32 v2, v2, v118
    v_add_f32 v2, v2, v119
    s_nop 1
    v_add_f32_dpp v3, v2, v2 quad_perm:[1,0,3,2] row_mask:0xf bank_mask:0xf
    s_nop 1
    v_add_f32_dpp v2, v3, v3 quad_perm:[2,3,0,1] row_mask:0xf bank_mask:0xf
    s_nop 1
    v_add_f32_dpp v3, v2, v2 row_half_mirror row_mask:0xf bank_mask:0xf
    v_mov_b32 v2, v3
    v_mul_f32 v2, 0x3ae38e39, v2
    v_sub_f32 v4, v48, v2
    v_mul_f32 v5, v4, v4
    v_sub_f32 v4, v49, v2
    v_fmac_f32 v5, v4, v4
    v_sub_f32 v4, v50, v2
    v_fmac_f32 v5, v4, v4
    v_sub_f32 v4, v51, v2
    v_fmac_f32 v5, v4, v4
    v_sub_f32 v4, v52, v2
    v_fmac_f32 v5, v4, v4
    v_sub_f32 v4, v53, v2
    v_fmac_f32 v5, v4, v4
    v_sub_f32 v4, v54, v2
    v_fmac_f32 v5, v4, v4
    v_sub_f32 v4, v55, v2
    v_fmac_f32 v5, v4, v4
    v_sub_f32 v4, v56, v2
    v_fmac_f32 v5, v4, v4
    v_sub_f32 v4, v57, v2
    v_fmac_f32 v5, v4, v4
    v_sub_f32 v4, v58, v2
    v_fmac_f32 v5, v4, v4
    v_sub_f32 v4, v59, v2
    v_fmac_f32 v5, v4, v4
    v_sub_f32 v4, v60, v2
    v_fmac_f32 v5, v4, v4
    v_sub_f32 v4, v61, v2
    v_fmac_f32 v5, v4, v4
    v_sub_f32 v4, v62, v2
    v_fmac_f32 v5, v4, v4
    v_sub_f32 v4, v63, v2
    v_fmac_f32 v5, v4, v4
    v_sub_f32 v4, v64, v2
    v_fmac_f32 v5, v4, v4
    v_sub_f32 v4, v65, v2
    v_fmac_f32 v5, v4, v4
    v_sub_f32 v4, v66, v2
    v_fmac_f32 v5, v4, v4
    v_sub_f32 v4, v67, v2
    v_fmac_f32 v5, v4, v4
    v_sub_f32 v4, v68, v2
    v_fmac_f32 v5, v4, v4
    v_sub_f32 v4, v69, v2
    v_fmac_f32 v5, v4, v4
    v_sub_f32 v4, v70, v2
    v_fmac_f32 v5, v4, v4
    v_sub_f32 v4, v71, v2
    v_fmac_f32 v5, v4, v4
    v_sub_f32 v4, v72, v2
    v_fmac_f32 v5, v4, v4
    v_sub_f32 v4, v73, v2
    v_fmac_f32 v5, v4, v4
    v_sub_f32 v4, v74, v2
    v_fmac_f32 v5, v4, v4
    v_sub_f32 v4, v75, v2
    v_fmac_f32 v5, v4, v4
    v_sub_f32 v4, v76, v2
    v_fmac_f32 v5, v4, v4
    v_sub_f32 v4, v77, v2
    v_fmac_f32 v5, v4, v4
    v_sub_f32 v4, v78, v2
    v_fmac_f32 v5, v4, v4
    v_sub_f32 v4, v79, v2
    v_fmac_f32 v5, v4, v4
    v_sub_f32 v4, v80, v2
    v_fmac_f32 v5, v4, v4
    v_sub_f32 v4, v81, v2
    v_fmac_f32 v5, v4, v4
    v_sub_f32 v4, v82, v2
    v_fmac_f32 v5, v4, v4
    v_sub_f32 v4, v83, v2
    v_fmac_f32 v5, v4, v4
    v_sub_f32 v4, v84, v2
    v_fmac_f32 v5, v4, v4
    v_sub_f32 v4, v85, v2
    v_fmac_f32 v5, v4, v4
    v_sub_f32 v4, v86, v2
    v_fmac_f32 v5, v4, v4
    v_sub_f32 v4, v87, v2
    v_fmac_f32 v5, v4, v4
    v_sub_f32 v4, v88, v2
    v_fmac_f32 v5, v4, v4
    v_sub_f32 v4, v89, v2
    v_fmac_f32 v5, v4, v4
    v_sub_f32 v4, v90, v2
    v_fmac_f32 v5, v4, v4
    v_sub_f32 v4, v91, v2
    v_fmac_f32 v5, v4, v4
    v_sub_f32 v4, v92, v2
    v_fmac_f32 v5, v4, v4
    v_sub_f32 v4, v93, v2
    v_fmac_f32 v5, v4, v4
    v_sub_f32 v4, v94, v2
    v_fmac_f32 v5, v4, v4
    v_sub_f32 v4, v95, v2
    v_fmac_f32 v5, v4, v4
    v_sub_f32 v4, v96, v2
    v_fmac_f32 v5, v4, v4
    v_sub_f32 v4, v97, v2
    v_fmac_f32 v5, v4, v4
    v_sub_f32 v4, v98, v2
    v_fmac_f32 v5, v4, v4
    v_sub_f32 v4, v99, v2
    v_fmac_f32 v5, v4, v4
    v_sub_f32 v4, v100, v2
    v_fmac_f32 v5, v4, v4
    v_sub_f32 v4, v101, v2
    v_fmac_f32 v5, v4, v4
    v_sub_f32 v4, v102, v2
    v_fmac_f32 v5, v4, v4
    v_sub_f32 v4, v103, v2
    v_fmac_f32 v5, v4, v4
    v_sub_f32 v4, v104, v2
    v_fmac_f32 v5, v4, v4
    v_sub_f32 v4, v105, v2
    v_fmac_f32 v5, v4, v4
    v_sub_f32 v4, v106, v2
    v_fmac_f32 v5, v4, v4
    v_sub_f32 v4, v107, v2
    v_fmac_f32 v5, v4, v4
    v_sub_f32 v4, v108, v2
    v_fmac_f32 v5, v4, v4
    v_sub_f32 v4, v109, v2
    v_fmac_f32 v5, v4, v4
    v_sub_f32 v4, v110, v2
    v_fmac_f32 v5, v4, v4
    v_sub_f32 v4, v111, v2
    v_fmac_f32 v5, v4, v4
    v_sub_f32 v4, v112, v2
    v_fmac_f32 v5, v4, v4
    v_sub_f32 v4, v113, v2
    v_fmac_f32 v5, v4, v4
    v_sub_f32 v4, v114, v2
    v_fmac_f32 v5, v4, v4
    v_sub_f32 v4, v115, v2
    v_fmac_f32 v5, v4, v4
    v_sub_f32 v4, v116, v2
    v_fmac_f32 v5, v4, v4
    v_sub_f32 v4, v117, v2
    v_fmac_f32 v5, v4, v4
    v_sub_f32 v4, v118, v2
    v_fmac_f32 v5, v4, v4
    v_sub_f32 v4, v119, v2
    v_fmac_f32 v5, v4, v4
    s_nop 1
    v_add_f32_dpp v3, v5, v5 quad_perm:[1,0,3,2] row_mask:0xf bank_mask:0xf
    s_nop 1
    v_add_f32_dpp v5, v3, v3 quad_perm:[2,3,0,1] row_mask:0xf bank_mask:0xf
    s_nop 1
    v_add_f32_dpp v3, v5, v5 row_half_mirror row_mask:0xf bank_mask:0xf
    v_mov_b32 v5, v3
    v_mul_f32 v5, 0x3ae38e39, v5
    v_cvt_pk_bf16_f32 v6, v2, v5
    v_lshlrev_b32 v2, 16, v6
    v_and_b32 v5, 0xffff0000, v6
    v_add_f32 v5, 0x3727c5ac, v5
    v_cvt_pk_bf16_f32 v6, v5, v5
    v_lshlrev_b32 v5, 16, v6
    v_sqrt_f32 v5, v5
    s_nop 0
    v_cvt_pk_bf16_f32 v6, v5, v5
    v_lshlrev_b32 v5, 16, v6
    v_rcp_f32 v5, v5
    s_nop 0
    v_sub_f32 v48, v48, v2
    v_sub_f32 v49, v49, v2
    v_cvt_pk_bf16_f32 v4, v48, v49
    v_lshlrev_b32 v48, 16, v4
    v_and_b32 v49, 0xffff0000, v4
    v_mul_f32 v48, v48, v5
    v_mul_f32 v49, v49, v5
    v_cvt_pk_bf16_f32 v8, v48, v49
    v_sub_f32 v50, v50, v2
    v_sub_f32 v51, v51, v2
    v_cvt_pk_bf16_f32 v4, v50, v51
    v_lshlrev_b32 v50, 16, v4
    v_and_b32 v51, 0xffff0000, v4
    v_mul_f32 v50, v50, v5
    v_mul_f32 v51, v51, v5
    v_cvt_pk_bf16_f32 v9, v50, v51
    v_sub_f32 v52, v52, v2
    v_sub_f32 v53, v53, v2
    v_cvt_pk_bf16_f32 v4, v52, v53
    v_lshlrev_b32 v52, 16, v4
    v_and_b32 v53, 0xffff0000, v4
    v_mul_f32 v52, v52, v5
    v_mul_f32 v53, v53, v5
    v_cvt_pk_bf16_f32 v10, v52, v53
    v_sub_f32 v54, v54, v2
    v_sub_f32 v55, v55, v2
    v_cvt_pk_bf16_f32 v4, v54, v55
    v_lshlrev_b32 v54, 16, v4
    v_and_b32 v55, 0xffff0000, v4
    v_mul_f32 v54, v54, v5
    v_mul_f32 v55, v55, v5
    v_cvt_pk_bf16_f32 v11, v54, v55
    v_sub_f32 v56, v56, v2
    v_sub_f32 v57, v57, v2
    v_cvt_pk_bf16_f32 v4, v56, v57
    v_lshlrev_b32 v56, 16, v4
    v_and_b32 v57, 0xffff0000, v4
    v_mul_f32 v56, v56, v5
    v_mul_f32 v57, v57, v5
    v_cvt_pk_bf16_f32 v12, v56, v57
    v_sub_f32 v58, v58, v2
    v_sub_f32 v59, v59, v2
    v_cvt_pk_bf16_f32 v4, v58, v59
    v_lshlrev_b32 v58, 16, v4
    v_and_b32 v59, 0xffff0000, v4
    v_mul_f32 v58, v58, v5
    v_mul_f32 v59, v59, v5
    v_cvt_pk_bf16_f32 v13, v58, v59
    v_sub_f32 v60, v60, v2
    v_sub_f32 v61, v61, v2
    v_cvt_pk_bf16_f32 v4, v60, v61
    v_lshlrev_b32 v60, 16, v4
    v_and_b32 v61, 0xffff0000, v4
    v_mul_f32 v60, v60, v5
    v_mul_f32 v61, v61, v5
    v_cvt_pk_bf16_f32 v14, v60, v61
    v_sub_f32 v62, v62, v2
    v_sub_f32 v63, v63, v2
    v_cvt_pk_bf16_f32 v4, v62, v63
    v_lshlrev_b32 v62, 16, v4
    v_and_b32 v63, 0xffff0000, v4
    v_mul_f32 v62, v62, v5
    v_mul_f32 v63, v63, v5
    v_cvt_pk_bf16_f32 v15, v62, v63
    v_sub_f32 v64, v64, v2
    v_sub_f32 v65, v65, v2
    v_cvt_pk_bf16_f32 v4, v64, v65
    v_lshlrev_b32 v64, 16, v4
    v_and_b32 v65, 0xffff0000, v4
    v_mul_f32 v64, v64, v5
    v_mul_f32 v65, v65, v5
    v_cvt_pk_bf16_f32 v16, v64, v65
    v_sub_f32 v66, v66, v2
    v_sub_f32 v67, v67, v2
    v_cvt_pk_bf16_f32 v4, v66, v67
    v_lshlrev_b32 v66, 16, v4
    v_and_b32 v67, 0xffff0000, v4
    v_mul_f32 v66, v66, v5
    v_mul_f32 v67, v67, v5
    v_cvt_pk_bf16_f32 v17, v66, v67
    v_sub_f32 v68, v68, v2
    v_sub_f32 v69, v69, v2
    v_cvt_pk_bf16_f32 v4, v68, v69
    v_lshlrev_b32 v68, 16, v4
    v_and_b32 v69, 0xffff0000, v4
    v_mul_f32 v68, v68, v5
    v_mul_f32 v69, v69, v5
    v_cvt_pk_bf16_f32 v18, v68, v69
    v_sub_f32 v70, v70, v2
    v_sub_f32 v71, v71, v2
    v_cvt_pk_bf16_f32 v4, v70, v71
    v_lshlrev_b32 v70, 16, v4
    v_and_b32 v71, 0xffff0000, v4
    v_mul_f32 v70, v70, v5
    v_mul_f32 v71, v71, v5
    v_cvt_pk_bf16_f32 v19, v70, v71
    v_sub_f32 v72, v72, v2
    v_sub_f32 v73, v73, v2
    v_cvt_pk_bf16_f32 v4, v72, v73
    v_lshlrev_b32 v72, 16, v4
    v_and_b32 v73, 0xffff0000, v4
    v_mul_f32 v72, v72, v5
    v_mul_f32 v73, v73, v5
    v_cvt_pk_bf16_f32 v20, v72, v73
    v_sub_f32 v74, v74, v2
    v_sub_f32 v75, v75, v2
    v_cvt_pk_bf16_f32 v4, v74, v75
    v_lshlrev_b32 v74, 16, v4
    v_and_b32 v75, 0xffff0000, v4
    v_mul_f32 v74, v74, v5
    v_mul_f32 v75, v75, v5
    v_cvt_pk_bf16_f32 v21, v74, v75
    v_sub_f32 v76, v76, v2
    v_sub_f32 v77, v77, v2
    v_cvt_pk_bf16_f32 v4, v76, v77
    v_lshlrev_b32 v76, 16, v4
    v_and_b32 v77, 0xffff0000, v4
    v_mul_f32 v76, v76, v5
    v_mul_f32 v77, v77, v5
    v_cvt_pk_bf16_f32 v22, v76, v77
    v_sub_f32 v78, v78, v2
    v_sub_f32 v79, v79, v2
    v_cvt_pk_bf16_f32 v4, v78, v79
    v_lshlrev_b32 v78, 16, v4
    v_and_b32 v79, 0xffff0000, v4
    v_mul_f32 v78, v78, v5
    v_mul_f32 v79, v79, v5
    v_cvt_pk_bf16_f32 v23, v78, v79
    v_sub_f32 v80, v80, v2
    v_sub_f32 v81, v81, v2
    v_cvt_pk_bf16_f32 v4, v80, v81
    v_lshlrev_b32 v80, 16, v4
    v_and_b32 v81, 0xffff0000, v4
    v_mul_f32 v80, v80, v5
    v_mul_f32 v81, v81, v5
    v_cvt_pk_bf16_f32 v24, v80, v81
    v_sub_f32 v82, v82, v2
    v_sub_f32 v83, v83, v2
    v_cvt_pk_bf16_f32 v4, v82, v83
    v_lshlrev_b32 v82, 16, v4
    v_and_b32 v83, 0xffff0000, v4
    v_mul_f32 v82, v82, v5
    v_mul_f32 v83, v83, v5
    v_cvt_pk_bf16_f32 v25, v82, v83
    v_sub_f32 v84, v84, v2
    v_sub_f32 v85, v85, v2
    v_cvt_pk_bf16_f32 v4, v84, v85
    v_lshlrev_b32 v84, 16, v4
    v_and_b32 v85, 0xffff0000, v4
    v_mul_f32 v84, v84, v5
    v_mul_f32 v85, v85, v5
    v_cvt_pk_bf16_f32 v26, v84, v85
    v_sub_f32 v86, v86, v2
    v_sub_f32 v87, v87, v2
    v_cvt_pk_bf16_f32 v4, v86, v87
    v_lshlrev_b32 v86, 16, v4
    v_and_b32 v87, 0xffff0000, v4
    v_mul_f32 v86, v86, v5
    v_mul_f32 v87, v87, v5
    v_cvt_pk_bf16_f32 v27, v86, v87
    v_sub_f32 v88, v88, v2
    v_sub_f32 v89, v89, v2
    v_cvt_pk_bf16_f32 v4, v88, v89
    v_lshlrev_b32 v88, 16, v4
    v_and_b32 v89, 0xffff0000, v4
    v_mul_f32 v88, v88, v5
    v_mul_f32 v89, v89, v5
    v_cvt_pk_bf16_f32 v28, v88, v89
    v_sub_f32 v90, v90, v2
    v_sub_f32 v91, v91, v2
    v_cvt_pk_bf16_f32 v4, v90, v91
    v_lshlrev_b32 v90, 16, v4
    v_and_b32 v91, 0xffff0000, v4
    v_mul_f32 v90, v90, v5
    v_mul_f32 v91, v91, v5
    v_cvt_pk_bf16_f32 v29, v90, v91
    v_sub_f32 v92, v92, v2
    v_sub_f32 v93, v93, v2
    v_cvt_pk_bf16_f32 v4, v92, v93
    v_lshlrev_b32 v92, 16, v4
    v_and_b32 v93, 0xffff0000, v4
    v_mul_f32 v92, v92, v5
    v_mul_f32 v93, v93, v5
    v_cvt_pk_bf16_f32 v30, v92, v93
    v_sub_f32 v94, v94, v2
    v_sub_f32 v95, v95, v2
    v_cvt_pk_bf16_f32 v4, v94, v95
    v_lshlrev_b32 v94, 16, v4
    v_and_b32 v95, 0xffff0000, v4
    v_mul_f32 v94, v94, v5
    v_mul_f32 v95, v95, v5
    v_cvt_pk_bf16_f32 v31, v94, v95
    v_sub_f32 v96, v96, v2
    v_sub_f32 v97, v97, v2
    v_cvt_pk_bf16_f32 v4, v96, v97
    v_lshlrev_b32 v96, 16, v4
    v_and_b32 v97, 0xffff0000, v4
    v_mul_f32 v96, v96, v5
    v_mul_f32 v97, v97, v5
    v_cvt_pk_bf16_f32 v32, v96, v97
    v_sub_f32 v98, v98, v2
    v_sub_f32 v99, v99, v2
    v_cvt_pk_bf16_f32 v4, v98, v99
    v_lshlrev_b32 v98, 16, v4
    v_and_b32 v99, 0xffff0000, v4
    v_mul_f32 v98, v98, v5
    v_mul_f32 v99, v99, v5
    v_cvt_pk_bf16_f32 v33, v98, v99
    v_sub_f32 v100, v100, v2
    v_sub_f32 v101, v101, v2
    v_cvt_pk_bf16_f32 v4, v100, v101
    v_lshlrev_b32 v100, 16, v4
    v_and_b32 v101, 0xffff0000, v4
    v_mul_f32 v100, v100, v5
    v_mul_f32 v101, v101, v5
    v_cvt_pk_bf16_f32 v34, v100, v101
    v_sub_f32 v102, v102, v2
    v_sub_f32 v103, v103, v2
    v_cvt_pk_bf16_f32 v4, v102, v103
    v_lshlrev_b32 v102, 16, v4
    v_and_b32 v103, 0xffff0000, v4
    v_mul_f32 v102, v102, v5
    v_mul_f32 v103, v103, v5
    v_cvt_pk_bf16_f32 v35, v102, v103
    v_sub_f32 v104, v104, v2
    v_sub_f32 v105, v105, v2
    v_cvt_pk_bf16_f32 v4, v104, v105
    v_lshlrev_b32 v104, 16, v4
    v_and_b32 v105, 0xffff0000, v4
    v_mul_f32 v104, v104, v5
    v_mul_f32 v105, v105, v5
    v_cvt_pk_bf16_f32 v36, v104, v105
    v_sub_f32 v106, v106, v2
    v_sub_f32 v107, v107, v2
    v_cvt_pk_bf16_f32 v4, v106, v107
    v_lshlrev_b32 v106, 16, v4
    v_and_b32 v107, 0xffff0000, v4
    v_mul_f32 v106, v106, v5
    v_mul_f32 v107, v107, v5
    v_cvt_pk_bf16_f32 v37, v106, v107
    v_sub_f32 v108, v108, v2
    v_sub_f32 v109, v109, v2
    v_cvt_pk_bf16_f32 v4, v108, v109
    v_lshlrev_b32 v108, 16, v4
    v_and_b32 v109, 0xffff0000, v4
    v_mul_f32 v108, v108, v5
    v_mul_f32 v109, v109, v5
    v_cvt_pk_bf16_f32 v38, v108, v109
    v_sub_f32 v110, v110, v2
    v_sub_f32 v111, v111, v2
    v_cvt_pk_bf16_f32 v4, v110, v111
    v_lshlrev_b32 v110, 16, v4
    v_and_b32 v111, 0xffff0000, v4
    v_mul_f32 v110, v110, v5
    v_mul_f32 v111, v111, v5
    v_cvt_pk_bf16_f32 v39, v110, v111
    v_sub_f32 v112, v112, v2
    v_sub_f32 v113, v113, v2
    v_cvt_pk_bf16_f32 v4, v112, v113
    v_lshlrev_b32 v112, 16, v4
    v_and_b32 v113, 0xffff0000, v4
    v_mul_f32 v112, v112, v5
    v_mul_f32 v113, v113, v5
    v_cvt_pk_bf16_f32 v40, v112, v113
    v_sub_f32 v114, v114, v2
    v_sub_f32 v115, v115, v2
    v_cvt_pk_bf16_f32 v4, v114, v115
    v_lshlrev_b32 v114, 16, v4
    v_and_b32 v115, 0xffff0000, v4
    v_mul_f32 v114, v114, v5
    v_mul_f32 v115, v115, v5
    v_cvt_pk_bf16_f32 v41, v114, v115
    v_sub_f32 v116, v116, v2
    v_sub_f32 v117, v117, v2
    v_cvt_pk_bf16_f32 v4, v116, v117
    v_lshlrev_b32 v116, 16, v4
    v_and_b32 v117, 0xffff0000, v4
    v_mul_f32 v116, v116, v5
    v_mul_f32 v117, v117, v5
    v_cvt_pk_bf16_f32 v42, v116, v117
    v_sub_f32 v118, v118, v2
    v_sub_f32 v119, v119, v2
    v_cvt_pk_bf16_f32 v4, v118, v119
    v_lshlrev_b32 v118, 16, v4
    v_and_b32 v119, 0xffff0000, v4
    v_mul_f32 v118, v118, v5
    v_mul_f32 v119, v119, v5
    v_cvt_pk_bf16_f32 v43, v118, v119
    buffer_store_dwordx4 v[8:11], v1, s[12:15], 0 offen offset:0
    buffer_store_dwordx4 v[12:15], v1, s[12:15], 0 offen offset:128
    buffer_store_dwordx4 v[16:19], v1, s[12:15], 0 offen offset:256
    buffer_store_dwordx4 v[20:23], v1, s[12:15], 0 offen offset:384
    buffer_store_dwordx4 v[24:27], v1, s[12:15], 0 offen offset:512
    buffer_store_dwordx4 v[28:31], v1, s[12:15], 0 offen offset:640
    buffer_store_dwordx4 v[32:35], v1, s[12:15], 0 offen offset:768
    buffer_store_dwordx4 v[36:39], v1, s[12:15], 0 offen offset:896
    buffer_store_dwordx4 v[40:43], v1, s[12:15], 0 offen offset:1024
.ln_end:
    s_endpgm
.globl gemm1_kernel
.p2align 8
.type gemm1_kernel,@function
gemm1_kernel:
    s_cmp_ge_u32 s2, 528
    s_cbranch_scc1 .g1_end
    s_load_dwordx2 s[4:5], s[0:1], 8
    s_load_dwordx2 s[6:7], s[0:1], 40
    s_load_dwordx2 s[8:9], s[0:1], 88
    s_load_dwordx2 s[10:11], s[0:1], 48
    s_and_b32 s3, s2, 7
    s_mul_i32 s3, s3, 66
    s_lshr_b32 s12, s2, 3
    s_add_u32 s3, s3, s12
    s_lshr_b32 s12, s3, 4
    s_and_b32 s3, s3, 15
    s_lshl_b32 s40, s3, 7
    s_waitcnt lgkmcnt(0)
    s_mov_b32 s16, s8
    s_mov_b32 s17, s9
    s_mov_b32 s18, 2359296
    s_mov_b32 s19, 0x00020000
    s_cmp_ge_u32 s12, 9
    s_cbranch_scc1 .g1_ffn
    s_mov_b32 s20, s4
    s_mov_b32 s21, s5
    s_mov_b32 s22, 1990656
    s_mov_b32 s23, 0x00020000
    s_mul_i32 s41, s12, 192
    s_mov_b32 s44, 0
    s_mov_b32 s45, 0
    v_and_b32 v17, 63, v0
    v_lshrrev_b32 v18, 6, v0
    v_mul_u32_u24 v19, 128, v18
    v_add_u32 v19, v19, v17
    v_lshrrev_b32 v20, 2, v19
    v_and_b32 v19, 3, v19
    v_bfe_u32 v21, v20, 2, 2
    v_xor_b32 v19, v19, v21
    v_add_u32 v20, s40, v20
    s_mov_b32 s42, 1152
    v_mul_lo_u32 v20, v20, s42
    v_lshl_add_u32 v1, v19, 4, v20
    v_mul_u32_u24 v19, 128, v18
    v_add_u32 v19, v19, v17
    v_add_u32 v19, 64, v19
    v_lshrrev_b32 v20, 2, v19
    v_and_b32 v19, 3, v19
    v_bfe_u32 v21, v20, 2, 2
    v_xor_b32 v19, v19, v21
    v_add_u32 v20, s40, v20
    s_mov_b32 s42, 1152
    v_mul_lo_u32 v20, v20, s42
    v_lshl_add_u32 v2, v19, 4, v20
    v_mul_u32_u24 v19, 192, v18
    v_add_u32 v19, v19, v17
    s_mov_b32 s42, 683
    v_mul_lo_u32 v20, v19, s42
    v_lshrrev_b32 v20, 14, v20
    v_mul_u32_u24 v21, 24, v20
    v_sub_u32 v19, v19, v21
    v_bfe_u32 v21, v20, 1, 1
    v_lshlrev_b32 v21, 2, v21
    v_xor_b32 v19, v19, v21
    s_mov_b32 s42, 3456
    v_mul_lo_u32 v20, v20, s42
    v_lshl_add_u32 v20, v19, 4, v20
    s_lshl_b32 s42, s41, 1
    v_add_u32 v4, s42, v20
    v_mul_u32_u24 v19, 192, v18
    v_add_u32 v19, v19, v17
    v_add_u32 v19, 64, v19
    s_mov_b32 s42, 683
    v_mul_lo_u32 v20, v19, s42
    v_lshrrev_b32 v20, 14, v20
    v_mul_u32_u24 v21, 24, v20
    v_sub_u32 v19, v19, v21
    v_bfe_u32 v21, v20, 1, 1
    v_lshlrev_b32 v21, 2, v21
    v_xor_b32 v19, v19, v21
    s_mov_b32 s42, 3456
    v_mul_lo_u32 v20, v20, s42
    v_lshl_add_u32 v20, v19, 4, v20
    s_lshl_b32 s42, s41, 1
    v_add_u32 v5, s42, v20
    v_mul_u32_u24 v19, 192, v18
    v_add_u32 v19, v19, v17
    v_add_u32 v19, 128, v19
    s_mov_b32 s42, 683
    v_mul_lo_u32 v20, v19, s42
    v_lshrrev_b32 v20, 14, v20
    v_mul_u32_u24 v21, 24, v20
    v_sub_u32 v19, v19, v21
    v_bfe_u32 v21, v20, 1, 1
    v_lshlrev_b32 v21, 2, v21
    v_xor_b32 v19, v19, v21
    s_mov_b32 s42, 3456
    v_mul_lo_u32 v20, v20, s42
    v_lshl_add_u32 v20, v19, 4, v20
    s_lshl_b32 s42, s41, 1
    v_add_u32 v6, s42, v20
    s_nop 0
    v_readfirstlane_b32 s47, v18
    s_mul_i32 s48, s47, 2048
    s_mul_i32 s49, s47, 3072
    s_add_u32 s49, s49, 8192
    v_lshrrev_b32 v19, 1, v18
    v_mul_u32_u24 v19, 64, v19
    v_and_b32 v20, 31, v17
    v_add_u32 v19, v19, v20
    v_bfe_u32 v20, v19, 2, 2
    v_lshrrev_b32 v21, 5, v17
    v_add_u32 v22, 0, v21
    v_xor_b32 v22, v22, v20
    v_lshlrev_b32 v22, 4, v22
    v_mul_u32_u24 v7, 64, v19
    v_add_u32 v7, v7, v22
    v_add_u32 v22, 2, v21
    v_xor_b32 v22, v22, v20
    v_lshlrev_b32 v22, 4, v22
    v_mul_u32_u24 v8, 64, v19
    v_add_u32 v8, v8, v22
    v_lshrrev_b32 v19, 5, v17
    v_lshlrev_b32 v19, 3, v19
    v_bfe_u32 v20, v17, 2, 2
    v_add_u32 v19, v19, v20
    v_mul_u32_u24 v19, 384, v19
    v_bfe_u32 v20, v17, 4, 1
    v_lshl_add_u32 v19, v20, 5, v19
    v_and_b32 v20, 3, v17
    v_lshl_add_u32 v19, v20, 3, v19
    v_add_u32 v19, 8192, v19
    v_and_b32 v20, 1, v18
    v_mul_u32_u24 v20, 3, v20
    v_bfe_u32 v21, v17, 3, 1
    v_add_u32 v22, 0, v20
    v_xor_b32 v22, v22, v21
    v_lshl_add_u32 v9, v22, 6, v19
    v_add_u32 v22, 1, v20
    v_xor_b32 v22, v22, v21
    v_lshl_add_u32 v10, v22, 6, v19
    v_add_u32 v22, 2, v20
    v_xor_b32 v22, v22, v21
    v_lshl_add_u32 v11, v22, 6, v19
    v_add_u32 v160, 32768, v7
    v_add_u32 v161, 32768, v8
    v_add_u32 v162, 32768, v9
    v_add_u32 v163, 32768, v10
    v_add_u32 v164, 32768, v11
    v_mov_b32 v64, 0
    v_mov_b32 v65, 0
    v_mov_b32 v66, 0
    v_mov_b32 v67, 0
    v_mov_b32 v68, 0
    v_mov_b32 v69, 0
    v_mov_b32 v70, 0
    v_mov_b32 v71, 0
    v_mov_b32 v72, 0
    v_mov_b32 v73, 0
    v_mov_b32 v74, 0
    v_mov_b32 v75, 0
    v_mov_b32 v76, 0
    v_mov_b32 v77, 0
    v_mov_b32 v78, 0
    v_mov_b32 v79, 0
    v_mov_b32 v80, 0
    v_mov_b32 v81, 0
    v_mov_b32 v82, 0
    v_mov_b32 v83, 0
    v_mov_b32 v84, 0
    v_mov_b32 v85, 0
    v_mov_b32 v86, 0
    v_mov_b32 v87, 0
    v_mov_b32 v88, 0
    v_mov_b32 v89, 0
    v_mov_b32 v90, 0
    v_mov_b32 v91, 0
    v_mov_b32 v92, 0
    v_mov_b32 v93, 0
    v_mov_b32 v94, 0
    v_mov_b32 v95, 0
    v_mov_b32 v96, 0
    v_mov_b32 v97, 0
    v_mov_b32 v98, 0
    v_mov_b32 v99, 0
    v_mov_b32 v100, 0
    v_mov_b32 v101, 0
    v_mov_b32 v102, 0
    v_mov_b32 v103, 0
    v_mov_b32 v104, 0
    v_mov_b32 v105, 0
    v_mov_b32 v106, 0
    v_mov_b32 v107, 0
    v_mov_b32 v108, 0
    v_mov_b32 v109, 0
    v_mov_b32 v110, 0
    v_mov_b32 v111, 0
    v_mov_b32 v112, 0
    v_mov_b32 v113, 0
    v_mov_b32 v114, 0
    v_mov_b32 v115, 0
    v_mov_b32 v116, 0
    v_mov_b32 v117, 0
    v_mov_b32 v118, 0
    v_mov_b32 v119, 0
    v_mov_b32 v120, 0
    v_mov_b32 v121, 0
    v_mov_b32 v122, 0
    v_mov_b32 v123, 0
    v_mov_b32 v124, 0
    v_mov_b32 v125, 0
    v_mov_b32 v126, 0
    v_mov_b32 v127, 0
    v_mov_b32 v128, 0
    v_mov_b32 v129, 0
    v_mov_b32 v130, 0
    v_mov_b32 v131, 0
    v_mov_b32 v132, 0
    v_mov_b32 v133, 0
    v_mov_b32 v134, 0
    v_mov_b32 v135, 0
    v_mov_b32 v136, 0
    v_mov_b32 v137, 0
    v_mov_b32 v138, 0
    v_mov_b32 v139, 0
    v_mov_b32 v140, 0
    v_mov_b32 v141, 0
    v_mov_b32 v142, 0
    v_mov_b32 v143, 0
    v_mov_b32 v144, 0
    v_mov_b32 v145, 0
    v_mov_b32 v146, 0
    v_mov_b32 v147, 0
    v_mov_b32 v148, 0
    v_mov_b32 v149, 0
    v_mov_b32 v150, 0
    v_mov_b32 v151, 0
    v_mov_b32 v152, 0
    v_mov_b32 v153, 0
    v_mov_b32 v154, 0
    v_mov_b32 v155, 0
    v_mov_b32 v156, 0
    v_mov_b32 v157, 0
    v_mov_b32 v158, 0
    v_mov_b32 v159, 0
    s_add_u32 m0, s48, 0
    s_nop 0
    buffer_load_dwordx4 v1, s[16:19], s44 offen lds
    s_add_u32 m0, s48, 1024
    s_nop 0
    buffer_load_dwordx4 v2, s[16:19], s44 offen lds
    s_add_u32 m0, s49, 0
    s_nop 0
    buffer_load_dwordx4 v4, s[20:23], s45 offen lds
    s_add_u32 m0, s49, 1024
    s_nop 0
    buffer_load_dwordx4 v5, s[20:23], s45 offen lds
    s_add_u32 m0, s49, 2048
    s_nop 0
    buffer_load_dwordx4 v6, s[20:23], s45 offen lds
    s_add_u32 s44, s44, 64
    s_add_u32 s45, s45, 110592
    s_add_u32 m0, s48, 20480
    s_nop 0
    buffer_load_dwordx4 v1, s[16:19], s44 offen lds
    s_add_u32 m0, s48, 21504
    s_nop 0
    buffer_load_dwordx4 v2, s[16:19], s44 offen lds
    s_add_u32 m0, s49, 20480
    s_nop 0
    buffer_load_dwordx4 v4, s[20:23], s45 offen lds
    s_add_u32 m0, s49, 21504
    s_nop 0
    buffer_load_dwordx4 v5, s[20:23], s45 offen lds
    s_add_u32 m0, s49, 22528
    s_nop 0
    buffer_load_dwordx4 v6, s[20:23], s45 offen lds
    s_add_u32 s44, s44, 64
    s_add_u32 s45, s45, 110592
    s_add_u32 m0, s48, 40960
    s_nop 0
    buffer_load_dwordx4 v1, s[16:19], s44 offen lds
    s_add_u32 m0, s48, 41984
    s_nop 0
    buffer_load_dwordx4 v2, s[16:19], s44 offen lds
    s_add_u32 m0, s49, 40960
    s_nop 0
    buffer_load_dwordx4 v4, s[20:23], s45 offen lds
    s_add_u32 m0, s49, 41984
    s_nop 0
    buffer_load_dwordx4 v5, s[20:23], s45 offen lds
    s_add_u32 m0, s49, 43008
    s_nop 0
    buffer_load_dwordx4 v6, s[20:23], s45 offen lds
    s_add_u32 s44, s44, 64
    s_add_u32 s45, s45, 110592
    s_waitcnt vmcnt(10)
    s_barrier
    ds_read_b128 v[24:27], v7 offset:0
    ds_read_b128 v[28:31], v7 offset:2048
    ds_read_b64_tr_b16 v[32:33], v9 offset:0
    ds_read_b64_tr_b16 v[34:35], v9 offset:1536
    ds_read_b64_tr_b16 v[36:37], v10 offset:0
    ds_read_b64_tr_b16 v[38:39], v10 offset:1536
    ds_read_b64_tr_b16 v[40:41], v11 offset:0
    ds_read_b64_tr_b16 v[42:43], v11 offset:1536
    s_mov_b32 s46, 3
.g1q_loop:
    s_waitcnt lgkmcnt(0)
    v_mfma_f32_32x32x16_bf16 v[64:79], v[32:35], v[24:27], v[64:79]
    ds_read_b128 v[44:47], v8 offset:0
    ds_read_b128 v[48:51], v8 offset:2048
    v_mfma_f32_32x32x16_bf16 v[80:95], v[32:35], v[28:31], v[80:95]
    ds_read_b64_tr_b16 v[52:53], v9 offset:6144
    ds_read_b64_tr_b16 v[54:55], v9 offset:7680
    v_mfma_f32_32x32x16_bf16 v[96:111], v[36:39], v[24:27], v[96:111]
    ds_read_b64_tr_b16 v[56:57], v10 offset:6144
    ds_read_b64_tr_b16 v[58:59], v10 offset:7680
    v_mfma_f32_32x32x16_bf16 v[112:127], v[36:39], v[28:31], v[112:127]
    ds_read_b64_tr_b16 v[60:61], v11 offset:6144
    ds_read_b64_tr_b16 v[62:63], v11 offset:7680
    v_mfma_f32_32x32x16_bf16 v[128:143], v[40:43], v[24:27], v[128:143]
    v_mfma_f32_32x32x16_bf16 v[144:159], v[40:43], v[28:31], v[144:159]
    s_waitcnt lgkmcnt(0)
    s_waitcnt vmcnt(5)
    s_barrier
    v_mfma_f32_32x32x16_bf16 v[64:79], v[52:55], v[44:47], v[64:79]
    s_add_u32 m0, s48, 61440
    s_nop 0
    buffer_load_dwordx4 v1, s[16:19], s44 offen lds
    s_add_u32 m0, s48, 62464
    s_nop 0
    buffer_load_dwordx4 v2, s[16:19], s44 offen lds
    s_add_u32 m0, s49, 61440
    s_nop 0
    buffer_load_dwordx4 v4, s[20:23], s45 offen lds
    v_mfma_f32_32x32x16_bf16 v[80:95], v[52:55], v[48:51], v[80:95]
    s_add_u32 m0, s49, 62464
    s_nop 0
    buffer_load_dwordx4 v5, s[20:23], s45 offen lds
    s_add_u32 m0, s49, 63488
    s_nop 0
    buffer_load_dwordx4 v6, s[20:23], s45 offen lds
    s_add_u32 s44, s44, 64
    v_mfma_f32_32x32x16_bf16 v[96:111], v[56:59], v[44:47], v[96:111]
    s_add_u32 s45, s45, 110592
    ds_read_b128 v[24:27], v7 offset:20480
    ds_read_b128 v[28:31], v7 offset:22528
    v_mfma_f32_32x32x16_bf16 v[112:127], v[56:59], v[48:51], v[112:127]
    ds_read_b64_tr_b16 v[32:33], v9 offset:20480
    ds_read_b64_tr_b16 v[34:35], v9 offset:22016
    ds_read_b64_tr_b16 v[36:37], v10 offset:20480
    v_mfma_f32_32x32x16_bf16 v[128:143], v[60:63], v[44:47], v[128:143]
    ds_read_b64_tr_b16 v[38:39], v10 offset:22016
    ds_read_b64_tr_b16 v[40:41], v11 offset:20480
    ds_read_b64_tr_b16 v[42:43], v11 offset:22016
    v_mfma_f32_32x32x16_bf16 v[144:159], v[60:63], v[48:51], v[144:159]
    s_waitcnt lgkmcnt(0)
    v_mfma_f32_32x32x16_bf16 v[64:79], v[32:35], v[24:27], v[64:79]
    ds_read_b128 v[44:47], v8 offset:20480
    ds_read_b128 v[48:51], v8 offset:22528
    v_mfma_f32_32x32x16_bf16 v[80:95], v[32:35], v[28:31], v[80:95]
    ds_read_b64_tr_b16 v[52:53], v9 offset:26624
    ds_read_b64_tr_b16 v[54:55], v9 offset:28160
    v_mfma_f32_32x32x16_bf16 v[96:111], v[36:39], v[24:27], v[96:111]
    ds_read_b64_tr_b16 v[56:57], v10 offset:26624
    ds_read_b64_tr_b16 v[58:59], v10 offset:28160
    v_mfma_f32_32x32x16_bf16 v[112:127], v[36:39], v[28:31], v[112:127]
    ds_read_b64_tr_b16 v[60:61], v11 offset:26624
    ds_read_b64_tr_b16 v[62:63], v11 offset:28160
    v_mfma_f32_32x32x16_bf16 v[128:143], v[40:43], v[24:27], v[128:143]
    v_mfma_f32_32x32x16_bf16 v[144:159], v[40:43], v[28:31], v[144:159]
    s_waitcnt lgkmcnt(0)
    s_waitcnt vmcnt(5)
    s_barrier
    v_mfma_f32_32x32x16_bf16 v[64:79], v[52:55], v[44:47], v[64:79]
    s_add_u32 m0, s48, 0
    s_nop 0
    buffer_load_dwordx4 v1, s[16:19], s44 offen lds
    s_add_u32 m0, s48, 1024
    s_nop 0
    buffer_load_dwordx4 v2, s[16:19], s44 offen lds
    s_add_u32 m0, s49, 0
    s_nop 0
    buffer_load_dwordx4 v4, s[20:23], s45 offen lds
    v_mfma_f32_32x32x16_bf16 v[80:95], v[52:55], v[48:51], v[80:95]
    s_add_u32 m0, s49, 1024
    s_nop 0
    buffer_load_dwordx4 v5, s[20:23], s45 offen lds
    s_add_u32 m0, s49, 2048
    s_nop 0
    buffer_load_dwordx4 v6, s[20:23], s45 offen lds
    s_add_u32 s44, s44, 64
    v_mfma_f32_32x32x16_bf16 v[96:111], v[56:59], v[44:47], v[96:111]
    s_add_u32 s45, s45, 110592
    ds_read_b128 v[24:27], v160 offset:8192
    ds_read_b128 v[28:31], v160 offset:10240
    v_mfma_f32_32x32x16_bf16 v[112:127], v[56:59], v[48:51], v[112:127]
    ds_read_b64_tr_b16 v[32:33], v162 offset:8192
    ds_read_b64_tr_b16 v[34:35], v162 offset:9728
    ds_read_b64_tr_b16 v[36:37], v163 offset:8192
    v_mfma_f32_32x32x16_bf16 v[128:143], v[60:63], v[44:47], v[128:143]
    ds_read_b64_tr_b16 v[38:39], v163 offset:9728
    ds_read_b64_tr_b16 v[40:41], v164 offset:8192
    ds_read_b64_tr_b16 v[42:43], v164 offset:9728
    v_mfma_f32_32x32x16_bf16 v[144:159], v[60:63], v[48:51], v[144:159]
    s_waitcnt lgkmcnt(0)
    v_mfma_f32_32x32x16_bf16 v[64:79], v[32:35], v[24:27], v[64:79]
    ds_read_b128 v[44:47], v161 offset:8192
    ds_read_b128 v[48:51], v161 offset:10240
    v_mfma_f32_32x32x16_bf16 v[80:95], v[32:35], v[28:31], v[80:95]
    ds_read_b64_tr_b16 v[52:53], v162 offset:14336
    ds_read_b64_tr_b16 v[54:55], v162 offset:15872
    v_mfma_f32_32x32x16_bf16 v[96:111], v[36:39], v[24:27], v[96:111]
    ds_read_b64_tr_b16 v[56:57], v163 offset:14336
    ds_read_b64_tr_b16 v[58:59], v163 offset:15872
    v_mfma_f32_32x32x16_bf16 v[112:127], v[36:39], v[28:31], v[112:127]
    ds_read_b64_tr_b16 v[60:61], v164 offset:14336
    ds_read_b64_tr_b16 v[62:63], v164 offset:15872
    v_mfma_f32_32x32x16_bf16 v[128:143], v[40:43], v[24:27], v[128:143]
    v_mfma_f32_32x32x16_bf16 v[144:159], v[40:43], v[28:31], v[144:159]
    s_waitcnt lgkmcnt(0)
    s_waitcnt vmcnt(5)
    s_barrier
    v_mfma_f32_32x32x16_bf16 v[64:79], v[52:55], v[44:47], v[64:79]
    s_add_u32 m0, s48, 20480
    s_nop 0
    buffer_load_dwordx4 v1, s[16:19], s44 offen lds
    s_add_u32 m0, s48, 21504
    s_nop 0
    buffer_load_dwordx4 v2, s[16:19], s44 offen lds
    s_add_u32 m0, s49, 20480
    s_nop 0
    buffer_load_dwordx4 v4, s[20:23], s45 offen lds
    v_mfma_f32_32x32x16_bf16 v[80:95], v[52:55], v[48:51], v[80:95]
    s_add_u32 m0, s49, 21504
    s_nop 0
    buffer_load_dwordx4 v5, s[20:23], s45 offen lds
    s_add_u32 m0, s49, 22528
    s_nop 0
    buffer_load_dwordx4 v6, s[20:23], s45 offen lds
    s_add_u32 s44, s44, 64
    v_mfma_f32_32x32x16_bf16 v[96:111], v[56:59], v[44:47], v[96:111]
    s_add_u32 s45, s45, 110592
    ds_read_b128 v[24:27], v160 offset:28672
    ds_read_b128 v[28:31], v160 offset:30720
    v_mfma_f32_32x32x16_bf16 v[112:127], v[56:59], v[48:51], v[112:127]
    ds_read_b64_tr_b16 v[32:33], v162 offset:28672
    ds_read_b64_tr_b16 v[34:35], v162 offset:30208
    ds_read_b64_tr_b16 v[36:37], v163 offset:28672
    v_mfma_f32_32x32x16_bf16 v[128:143], v[60:63], v[44:47], v[128:143]
    ds_read_b64_tr_b16 v[38:39], v163 offset:30208
    ds_read_b64_tr_b16 v[40:41], v164 offset:28672
    ds_read_b64_tr_b16 v[42:43], v164 offset:30208
    v_mfma_f32_32x32x16_bf16 v[144:159], v[60:63], v[48:51], v[144:159]
    s_waitcnt lgkmcnt(0)
    v_mfma_f32_32x32x16_bf16 v[64:79], v[32:35], v[24:27], v[64:79]
    ds_read_b128 v[44:47], v161 offset:28672
    ds_read_b128 v[48:51], v161 offset:30720
    v_mfma_f32_32x32x16_bf16 v[80:95], v[32:35], v[28:31], v[80:95]
    ds_read_b64_tr_b16 v[52:53], v162 offset:34816
    ds_read_b64_tr_b16 v[54:55], v162 offset:36352
    v_mfma_f32_32x32x16_bf16 v[96:111], v[36:39], v[24:27], v[96:111]
    ds_read_b64_tr_b16 v[56:57], v163 offset:34816
    ds_read_b64_tr_b16 v[58:59], v163 offset:36352
    v_mfma_f32_32x32x16_bf16 v[112:127], v[36:39], v[28:31], v[112:127]
    ds_read_b64_tr_b16 v[60:61], v164 offset:34816
    ds_read_b64_tr_b16 v[62:63], v164 offset:36352
    v_mfma_f32_32x32x16_bf16 v[128:143], v[40:43], v[24:27], v[128:143]
    v_mfma_f32_32x32x16_bf16 v[144:159], v[40:43], v[28:31], v[144:159]
    s_waitcnt lgkmcnt(0)
    s_waitcnt vmcnt(5)
    s_barrier
    v_mfma_f32_32x32x16_bf16 v[64:79], v[52:55], v[44:47], v[64:79]
    s_add_u32 m0, s48, 40960
    s_nop 0
    buffer_load_dwordx4 v1, s[16:19], s44 offen lds
    s_add_u32 m0, s48, 41984
    s_nop 0
    buffer_load_dwordx4 v2, s[16:19], s44 offen lds
    s_add_u32 m0, s49, 40960
    s_nop 0
    buffer_load_dwordx4 v4, s[20:23], s45 offen lds
    v_mfma_f32_32x32x16_bf16 v[80:95], v[52:55], v[48:51], v[80:95]
    s_add_u32 m0, s49, 41984
    s_nop 0
    buffer_load_dwordx4 v5, s[20:23], s45 offen lds
    s_add_u32 m0, s49, 43008
    s_nop 0
    buffer_load_dwordx4 v6, s[20:23], s45 offen lds
    s_add_u32 s44, s44, 64
    v_mfma_f32_32x32x16_bf16 v[96:111], v[56:59], v[44:47], v[96:111]
    s_add_u32 s45, s45, 110592
    ds_read_b128 v[24:27], v7 offset:0
    ds_read_b128 v[28:31], v7 offset:2048
    v_mfma_f32_32x32x16_bf16 v[112:127], v[56:59], v[48:51], v[112:127]
    ds_read_b64_tr_b16 v[32:33], v9 offset:0
    ds_read_b64_tr_b16 v[34:35], v9 offset:1536
    ds_read_b64_tr_b16 v[36:37], v10 offset:0
    v_mfma_f32_32x32x16_bf16 v[128:143], v[60:63], v[44:47], v[128:143]
    ds_read_b64_tr_b16 v[38:39], v10 offset:1536
    ds_read_b64_tr_b16 v[40:41], v11 offset:0
    ds_read_b64_tr_b16 v[42:43], v11 offset:1536
    v_mfma_f32_32x32x16_bf16 v[144:159], v[60:63], v[48:51], v[144:159]
    s_sub_u32 s46, s46, 1
    s_cmp_lg_u32 s46, 0
    s_cbranch_scc1 .g1q_loop
    s_waitcnt lgkmcnt(0)
    v_mfma_f32_32x32x16_bf16 v[64:79], v[32:35], v[24:27], v[64:79]
    ds_read_b128 v[44:47], v8 offset:0
    ds_read_b128 v[48:51], v8 offset:2048
    v_mfma_f32_32x32x16_bf16 v[80:95], v[32:35], v[28:31], v[80:95]
    ds_read_b64_tr_b16 v[52:53], v9 offset:6144
    ds_read_b64_tr_b16 v[54:55], v9 offset:7680
    v_mfma_f32_32x32x16_bf16 v[96:111], v[36:39], v[24:27], v[96:111]
    ds_read_b64_tr_b16 v[56:57], v10 offset:6144
    ds_read_b64_tr_b16 v[58:59], v10 offset:7680
    v_mfma_f32_32x32x16_bf16 v[112:127], v[36:39], v[28:31], v[112:127]
    ds_read_b64_tr_b16 v[60:61], v11 offset:6144
    ds_read_b64_tr_b16 v[62:63], v11 offset:7680
    v_mfma_f32_32x32x16_bf16 v[128:143], v[40:43], v[24:27], v[128:143]
    v_mfma_f32_32x32x16_bf16 v[144:159], v[40:43], v[28:31], v[144:159]
    s_waitcnt lgkmcnt(0)
    s_waitcnt vmcnt(5)
    s_barrier
    v_mfma_f32_32x32x16_bf16 v[64:79], v[52:55], v[44:47], v[64:79]
    s_add_u32 m0, s48, 61440
    s_nop 0
    buffer_load_dwordx4 v1, s[16:19], s44 offen lds
    s_add_u32 m0, s48, 62464
    s_nop 0
    buffer_load_dwordx4 v2, s[16:19], s44 offen lds
    s_add_u32 m0, s49, 61440
    s_nop 0
    buffer_load_dwordx4 v4, s[20:23], s45 offen lds
    v_mfma_f32_32x32x16_bf16 v[80:95], v[52:55], v[48:51], v[80:95]
    s_add_u32 m0, s49, 62464
    s_nop 0
    buffer_load_dwordx4 v5, s[20:23], s45 offen lds
    s_add_u32 m0, s49, 63488
    s_nop 0
    buffer_load_dwordx4 v6, s[20:23], s45 offen lds
    s_add_u32 s44, s44, 64
    v_mfma_f32_32x32x16_bf16 v[96:111], v[56:59], v[44:47], v[96:111]
    s_add_u32 s45, s45, 110592
    ds_read_b128 v[24:27], v7 offset:20480
    ds_read_b128 v[28:31], v7 offset:22528
    v_mfma_f32_32x32x16_bf16 v[112:127], v[56:59], v[48:51], v[112:127]
    ds_read_b64_tr_b16 v[32:33], v9 offset:20480
    ds_read_b64_tr_b16 v[34:35], v9 offset:22016
    ds_read_b64_tr_b16 v[36:37], v10 offset:20480
    v_mfma_f32_32x32x16_bf16 v[128:143], v[60:63], v[44:47], v[128:143]
    ds_read_b64_tr_b16 v[38:39], v10 offset:22016
    ds_read_b64_tr_b16 v[40:41], v11 offset:20480
    ds_read_b64_tr_b16 v[42:43], v11 offset:22016
    v_mfma_f32_32x32x16_bf16 v[144:159], v[60:63], v[48:51], v[144:159]
    s_waitcnt lgkmcnt(0)
    v_mfma_f32_32x32x16_bf16 v[64:79], v[32:35], v[24:27], v[64:79]
    ds_read_b128 v[44:47], v8 offset:20480
    ds_read_b128 v[48:51], v8 offset:22528
    v_mfma_f32_32x32x16_bf16 v[80:95], v[32:35], v[28:31], v[80:95]
    ds_read_b64_tr_b16 v[52:53], v9 offset:26624
    ds_read_b64_tr_b16 v[54:55], v9 offset:28160
    v_mfma_f32_32x32x16_bf16 v[96:111], v[36:39], v[24:27], v[96:111]
    ds_read_b64_tr_b16 v[56:57], v10 offset:26624
    ds_read_b64_tr_b16 v[58:59], v10 offset:28160
    v_mfma_f32_32x32x16_bf16 v[112:127], v[36:39], v[28:31], v[112:127]
    ds_read_b64_tr_b16 v[60:61], v11 offset:26624
    ds_read_b64_tr_b16 v[62:63], v11 offset:28160
    v_mfma_f32_32x32x16_bf16 v[128:143], v[40:43], v[24:27], v[128:143]
    v_mfma_f32_32x32x16_bf16 v[144:159], v[40:43], v[28:31], v[144:159]
    s_waitcnt lgkmcnt(0)
    s_waitcnt vmcnt(5)
    s_barrier
    v_mfma_f32_32x32x16_bf16 v[64:79], v[52:55], v[44:47], v[64:79]
    s_add_u32 m0, s48, 0
    s_nop 0
    buffer_load_dwordx4 v1, s[16:19], s44 offen lds
    s_add_u32 m0, s48, 1024
    s_nop 0
    buffer_load_dwordx4 v2, s[16:19], s44 offen lds
    s_add_u32 m0, s49, 0
    s_nop 0
    buffer_load_dwordx4 v4, s[20:23], s45 offen lds
    v_mfma_f32_32x32x16_bf16 v[80:95], v[52:55], v[48:51], v[80:95]
    s_add_u32 m0, s49, 1024
    s_nop 0
    buffer_load_dwordx4 v5, s[20:23], s45 offen lds
    s_add_u32 m0, s49, 2048
    s_nop 0
    buffer_load_dwordx4 v6, s[20:23], s45 offen lds
    s_add_u32 s44, s44, 64
    v_mfma_f32_32x32x16_bf16 v[96:111], v[56:59], v[44:47], v[96:111]
    s_add_u32 s45, s45, 110592
    ds_read_b128 v[24:27], v160 offset:8192
    ds_read_b128 v[28:31], v160 offset:10240
    v_mfma_f32_32x32x16_bf16 v[112:127], v[56:59], v[48:51], v[112:127]
    ds_read_b64_tr_b16 v[32:33], v162 offset:8192
    ds_read_b64_tr_b16 v[34:35], v162 offset:9728
    ds_read_b64_tr_b16 v[36:37], v163 offset:8192
    v_mfma_f32_32x32x16_bf16 v[128:143], v[60:63], v[44:47], v[128:143]
    ds_read_b64_tr_b16 v[38:39], v163 offset:9728
    ds_read_b64_tr_b16 v[40:41], v164 offset:8192
    ds_read_b64_tr_b16 v[42:43], v164 offset:9728
    v_mfma_f32_32x32x16_bf16 v[144:159], v[60:63], v[48:51], v[144:159]
    s_waitcnt lgkmcnt(0)
    v_mfma_f32_32x32x16_bf16 v[64:79], v[32:35], v[24:27], v[64:79]
    ds_read_b128 v[44:47], v161 offset:8192
    ds_read_b128 v[48:51], v161 offset:10240
    v_mfma_f32_32x32x16_bf16 v[80:95], v[32:35], v[28:31], v[80:95]
    ds_read_b64_tr_b16 v[52:53], v162 offset:14336
    ds_read_b64_tr_b16 v[54:55], v162 offset:15872
    v_mfma_f32_32x32x16_bf16 v[96:111], v[36:39], v[24:27], v[96:111]
    ds_read_b64_tr_b16 v[56:57], v163 offset:14336
    ds_read_b64_tr_b16 v[58:59], v163 offset:15872
    v_mfma_f32_32x32x16_bf16 v[112:127], v[36:39], v[28:31], v[112:127]
    ds_read_b64_tr_b16 v[60:61], v164 offset:14336
    ds_read_b64_tr_b16 v[62:63], v164 offset:15872
    v_mfma_f32_32x32x16_bf16 v[128:143], v[40:43], v[24:27], v[128:143]
    v_mfma_f32_32x32x16_bf16 v[144:159], v[40:43], v[28:31], v[144:159]
    s_waitcnt lgkmcnt(0)
    s_waitcnt vmcnt(5)
    s_barrier
    v_mfma_f32_32x32x16_bf16 v[64:79], v[52:55], v[44:47], v[64:79]
    s_add_u32 m0, s48, 20480
    s_nop 0
    buffer_load_dwordx4 v1, s[16:19], s44 offen lds
    s_add_u32 m0, s48, 21504
    s_nop 0
    buffer_load_dwordx4 v2, s[16:19], s44 offen lds
    s_add_u32 m0, s49, 20480
    s_nop 0
    buffer_load_dwordx4 v4, s[20:23], s45 offen lds
    v_mfma_f32_32x32x16_bf16 v[80:95], v[52:55], v[48:51], v[80:95]
    s_add_u32 m0, s49, 21504
    s_nop 0
    buffer_load_dwordx4 v5, s[20:23], s45 offen lds
    s_add_u32 m0, s49, 22528
    s_nop 0
    buffer_load_dwordx4 v6, s[20:23], s45 offen lds
    s_add_u32 s44, s44, 64
    v_mfma_f32_32x32x16_bf16 v[96:111], v[56:59], v[44:47], v[96:111]
    s_add_u32 s45, s45, 110592
    ds_read_b128 v[24:27], v160 offset:28672
    ds_read_b128 v[28:31], v160 offset:30720
    v_mfma_f32_32x32x16_bf16 v[112:127], v[56:59], v[48:51], v[112:127]
    ds_read_b64_tr_b16 v[32:33], v162 offset:28672
    ds_read_b64_tr_b16 v[34:35], v162 offset:30208
    ds_read_b64_tr_b16 v[36:37], v163 offset:28672
    v_mfma_f32_32x32x16_bf16 v[128:143], v[60:63], v[44:47], v[128:143]
    ds_read_b64_tr_b16 v[38:39], v163 offset:30208
    ds_read_b64_tr_b16 v[40:41], v164 offset:28672
    ds_read_b64_tr_b16 v[42:43], v164 offset:30208
    v_mfma_f32_32x32x16_bf16 v[144:159], v[60:63], v[48:51], v[144:159]
    s_waitcnt lgkmcnt(0)
    v_mfma_f32_32x32x16_bf16 v[64:79], v[32:35], v[24:27], v[64:79]
    ds_read_b128 v[44:47], v161 offset:28672
    ds_read_b128 v[48:51], v161 offset:30720
    v_mfma_f32_32x32x16_bf16 v[80:95], v[32:35], v[28:31], v[80:95]
    ds_read_b64_tr_b16 v[52:53], v162 offset:34816
    ds_read_b64_tr_b16 v[54:55], v162 offset:36352
    v_mfma_f32_32x32x16_bf16 v[96:111], v[36:39], v[24:27], v[96:111]
    ds_read_b64_tr_b16 v[56:57], v163 offset:34816
    ds_read_b64_tr_b16 v[58:59], v163 offset:36352
    v_mfma_f32_32x32x16_bf16 v[112:127], v[36:39], v[28:31], v[112:127]
    ds_read_b64_tr_b16 v[60:61], v164 offset:34816
    ds_read_b64_tr_b16 v[62:63], v164 offset:36352
    v_mfma_f32_32x32x16_bf16 v[128:143], v[40:43], v[24:27], v[128:143]
    v_mfma_f32_32x32x16_bf16 v[144:159], v[40:43], v[28:31], v[144:159]
    s_waitcnt lgkmcnt(0)
    s_waitcnt vmcnt(5)
    s_barrier
    v_mfma_f32_32x32x16_bf16 v[64:79], v[52:55], v[44:47], v[64:79]
    ds_read_b128 v[24:27], v7 offset:0
    ds_read_b128 v[28:31], v7 offset:2048
    v_mfma_f32_32x32x16_bf16 v[80:95], v[52:55], v[48:51], v[80:95]
    ds_read_b64_tr_b16 v[32:33], v9 offset:0
    ds_read_b64_tr_b16 v[34:35], v9 offset:1536
    v_mfma_f32_32x32x16_bf16 v[96:111], v[56:59], v[44:47], v[96:111]
    ds_read_b64_tr_b16 v[36:37], v10 offset:0
    ds_read_b64_tr_b16 v[38:39], v10 offset:1536
    v_mfma_f32_32x32x16_bf16 v[112:127], v[56:59], v[48:51], v[112:127]
    ds_read_b64_tr_b16 v[40:41], v11 offset:0
    ds_read_b64_tr_b16 v[42:43], v11 offset:1536
    v_mfma_f32_32x32x16_bf16 v[128:143], v[60:63], v[44:47], v[128:143]
    v_mfma_f32_32x32x16_bf16 v[144:159], v[60:63], v[48:51], v[144:159]
    s_waitcnt lgkmcnt(0)
    v_mfma_f32_32x32x16_bf16 v[64:79], v[32:35], v[24:27], v[64:79]
    ds_read_b128 v[44:47], v8 offset:0
    ds_read_b128 v[48:51], v8 offset:2048
    v_mfma_f32_32x32x16_bf16 v[80:95], v[32:35], v[28:31], v[80:95]
    ds_read_b64_tr_b16 v[52:53], v9 offset:6144
    ds_read_b64_tr_b16 v[54:55], v9 offset:7680
    v_mfma_f32_32x32x16_bf16 v[96:111], v[36:39], v[24:27], v[96:111]
    ds_read_b64_tr_b16 v[56:57], v10 offset:6144
    ds_read_b64_tr_b16 v[58:59], v10 offset:7680
    v_mfma_f32_32x32x16_bf16 v[112:127], v[36:39], v[28:31], v[112:127]
    ds_read_b64_tr_b16 v[60:61], v11 offset:6144
    ds_read_b64_tr_b16 v[62:63], v11 offset:7680
    v_mfma_f32_32x32x16_bf16 v[128:143], v[40:43], v[24:27], v[128:143]
    v_mfma_f32_32x32x16_bf16 v[144:159], v[40:43], v[28:31], v[144:159]
    s_waitcnt lgkmcnt(0)
    s_waitcnt vmcnt(0)
    s_barrier
    v_mfma_f32_32x32x16_bf16 v[64:79], v[52:55], v[44:47], v[64:79]
    ds_read_b128 v[24:27], v7 offset:20480
    ds_read_b128 v[28:31], v7 offset:22528
    v_mfma_f32_32x32x16_bf16 v[80:95], v[52:55], v[48:51], v[80:95]
    ds_read_b64_tr_b16 v[32:33], v9 offset:20480
    ds_read_b64_tr_b16 v[34:35], v9 offset:22016
    v_mfma_f32_32x32x16_bf16 v[96:111], v[56:59], v[44:47], v[96:111]
    ds_read_b64_tr_b16 v[36:37], v10 offset:20480
    ds_read_b64_tr_b16 v[38:39], v10 offset:22016
    v_mfma_f32_32x32x16_bf16 v[112:127], v[56:59], v[48:51], v[112:127]
    ds_read_b64_tr_b16 v[40:41], v11 offset:20480
    ds_read_b64_tr_b16 v[42:43], v11 offset:22016
    v_mfma_f32_32x32x16_bf16 v[128:143], v[60:63], v[44:47], v[128:143]
    v_mfma_f32_32x32x16_bf16 v[144:159], v[60:63], v[48:51], v[144:159]
    s_waitcnt lgkmcnt(0)
    v_mfma_f32_32x32x16_bf16 v[64:79], v[32:35], v[24:27], v[64:79]
    ds_read_b128 v[44:47], v8 offset:20480
    ds_read_b128 v[48:51], v8 offset:22528
    v_mfma_f32_32x32x16_bf16 v[80:95], v[32:35], v[28:31], v[80:95]
    ds_read_b64_tr_b16 v[52:53], v9 offset:26624
    ds_read_b64_tr_b16 v[54:55], v9 offset:28160
    v_mfma_f32_32x32x16_bf16 v[96:111], v[36:39], v[24:27], v[96:111]
    ds_read_b64_tr_b16 v[56:57], v10 offset:26624
    ds_read_b64_tr_b16 v[58:59], v10 offset:28160
    v_mfma_f32_32x32x16_bf16 v[112:127], v[36:39], v[28:31], v[112:127]
    ds_read_b64_tr_b16 v[60:61], v11 offset:26624
    ds_read_b64_tr_b16 v[62:63], v11 offset:28160
    v_mfma_f32_32x32x16_bf16 v[128:143], v[40:43], v[24:27], v[128:143]
    v_mfma_f32_32x32x16_bf16 v[144:159], v[40:43], v[28:31], v[144:159]
    s_waitcnt lgkmcnt(0)
    v_mfma_f32_32x32x16_bf16 v[64:79], v[52:55], v[44:47], v[64:79]
    v_mfma_f32_32x32x16_bf16 v[80:95], v[52:55], v[48:51], v[80:95]
    v_mfma_f32_32x32x16_bf16 v[96:111], v[56:59], v[44:47], v[96:111]
    v_mfma_f32_32x32x16_bf16 v[112:127], v[56:59], v[48:51], v[112:127]
    v_mfma_f32_32x32x16_bf16 v[128:143], v[60:63], v[44:47], v[128:143]
    v_mfma_f32_32x32x16_bf16 v[144:159], v[60:63], v[48:51], v[144:159]
    s_nop 15
    s_add_u32 s24, s8, 3145728
    s_addc_u32 s25, s9, 0
    s_mov_b32 s26, 7077888
    s_mov_b32 s27, 0x00020000
    s_barrier
    v_lshrrev_b32 v18, 6, v0
    v_lshrrev_b32 v19, 1, v18
    v_mul_u32_u24 v19, 64, v19
    v_and_b32 v20, 31, v0
    v_add_u32 v19, v19, v20
    v_mul_u32_u24 v19, 400, v19
    v_and_b32 v18, 1, v18
    v_mul_u32_u24 v18, 96, v18
    v_bfe_u32 v20, v0, 5, 1
    v_lshl_add_u32 v18, v20, 2, v18
    v_mul_u32_u24 v18, 2, v18
    v_add_u32 v1, v18, v19
    v_lshrrev_b32 v18, 6, v0
    v_lshrrev_b32 v19, 1, v18
    v_mul_u32_u24 v19, 64, v19
    v_and_b32 v20, 31, v0
    v_add_u32 v19, v19, v20
    v_add_u32 v19, s40, v19
    s_mov_b32 s42, 3456
    v_mul_lo_u32 v17, v19, s42
    v_and_b32 v18, 1, v18
    v_mul_u32_u24 v18, 96, v18
    v_bfe_u32 v20, v0, 5, 1
    v_lshl_add_u32 v18, v20, 2, v18
    v_add_u32 v18, s41, v18
    v_lshl_add_u32 v17, v18, 1, v17
    v_cvt_pk_bf16_f32 v64, v64, v65
    v_cvt_pk_bf16_f32 v65, v66, v67
    ds_write_b64 v1, v[64:65] offset:0
    v_cvt_pk_bf16_f32 v80, v80, v81
    v_cvt_pk_bf16_f32 v81, v82, v83
    ds_write_b64 v1, v[80:81] offset:12800
    v_cvt_pk_bf16_f32 v68, v68, v69
    v_cvt_pk_bf16_f32 v69, v70, v71
    ds_write_b64 v1, v[68:69] offset:16
    v_cvt_pk_bf16_f32 v84, v84, v85
    v_cvt_pk_bf16_f32 v85, v86, v87
    ds_write_b64 v1, v[84:85] offset:12816
    v_cvt_pk_bf16_f32 v72, v72, v73
    v_cvt_pk_bf16_f32 v73, v74, v75
    ds_write_b64 v1, v[72:73] offset:32
    v_cvt_pk_bf16_f32 v88, v88, v89
    v_cvt_pk_bf16_f32 v89, v90, v91
    ds_write_b64 v1, v[88:89] offset:12832
    v_cvt_pk_bf16_f32 v76, v76, v77
    v_cvt_pk_bf16_f32 v77, v78, v79
    ds_write_b64 v1, v[76:77] offset:48
    v_cvt_pk_bf16_f32 v92, v92, v93
    v_cvt_pk_bf16_f32 v93, v94, v95
    ds_write_b64 v1, v[92:93] offset:12848
    v_cvt_pk_bf16_f32 v96, v96, v97
    v_cvt_pk_bf16_f32 v97, v98, v99
    ds_write_b64 v1, v[96:97] offset:64
    v_cvt_pk_bf16_f32 v112, v112, v113
    v_cvt_pk_bf16_f32 v113, v114, v115
    ds_write_b64 v1, v[112:113] offset:12864
    v_cvt_pk_bf16_f32 v100, v100, v101
    v_cvt_pk_bf16_f32 v101, v102, v103
    ds_write_b64 v1, v[100:101] offset:80
    v_cvt_pk_bf16_f32 v116, v116, v117
    v_cvt_pk_bf16_f32 v117, v118, v119
    ds_write_b64 v1, v[116:117] offset:12880
    v_cvt_pk_bf16_f32 v104, v104, v105
    v_cvt_pk_bf16_f32 v105, v106, v107
    ds_write_b64 v1, v[104:105] offset:96
    v_cvt_pk_bf16_f32 v120, v120, v121
    v_cvt_pk_bf16_f32 v121, v122, v123
    ds_write_b64 v1, v[120:121] offset:12896
    v_cvt_pk_bf16_f32 v108, v108, v109
    v_cvt_pk_bf16_f32 v109, v110, v111
    ds_write_b64 v1, v[108:109] offset:112
    v_cvt_pk_bf16_f32 v124, v124, v125
    v_cvt_pk_bf16_f32 v125, v126, v127
    ds_write_b64 v1, v[124:125] offset:12912
    v_cvt_pk_bf16_f32 v128, v128, v129
    v_cvt_pk_bf16_f32 v129, v130, v131
    ds_write_b64 v1, v[128:129] offset:128
    v_cvt_pk_bf16_f32 v144, v144, v145
    v_cvt_pk_bf16_f32 v145, v146, v147
    ds_write_b64 v1, v[144:145] offset:12928
    v_cvt_pk_bf16_f32 v132, v132, v133
    v_cvt_pk_bf16_f32 v133, v134, v135
    ds_write_b64 v1, v[132:133] offset:144
    v_cvt_pk_bf16_f32 v148, v148, v149
    v_cvt_pk_bf16_f32 v149, v150, v151
    ds_write_b64 v1, v[148:149] offset:12944
    v_cvt_pk_bf16_f32 v136, v136, v137
    v_cvt_pk_bf16_f32 v137, v138, v139
    ds_write_b64 v1, v[136:137] offset:160
    v_cvt_pk_bf16_f32 v152, v152, v153
    v_cvt_pk_bf16_f32 v153, v154, v155
    ds_write_b64 v1, v[152:153] offset:12960
    v_cvt_pk_bf16_f32 v140, v140, v141
    v_cvt_pk_bf16_f32 v141, v142, v143
    ds_write_b64 v1, v[140:141] offset:176
    v_cvt_pk_bf16_f32 v156, v156, v157
    v_cvt_pk_bf16_f32 v157, v158, v159
    ds_write_b64 v1, v[156:157] offset:12976
    s_waitcnt lgkmcnt(0)
    s_barrier
    s_mov_b32 s42, 178956971
    s_lshl_b32 s43, s41, 1
    v_add_u32 v17, 0, v0
    v_mul_hi_u32 v18, v17, s42
    v_mul_u32_u24 v19, 24, v18
    v_sub_u32 v19, v17, v19
    v_mul_u32_u24 v20, 400, v18
    v_lshl_add_u32 v20, v19, 4, v20
    ds_read_b128 v[24:27], v20
    v_add_u32 v18, s40, v18
    v_mul_u32_u24 v18, 3456, v18
    v_lshl_add_u32 v18, v19, 4, v18
    v_add_u32 v48, s43, v18
    v_add_u32 v17, 256, v0
    v_mul_hi_u32 v18, v17, s42
    v_mul_u32_u24 v19, 24, v18
    v_sub_u32 v19, v17, v19
    v_mul_u32_u24 v20, 400, v18
    v_lshl_add_u32 v20, v19, 4, v20
    ds_read_b128 v[28:31], v20
    v_add_u32 v18, s40, v18
    v_mul_u32_u24 v18, 3456, v18
    v_lshl_add_u32 v18, v19, 4, v18
    v_add_u32 v49, s43, v18
    v_add_u32 v17, 512, v0
    v_mul_hi_u32 v18, v17, s42
    v_mul_u32_u24 v19, 24, v18
    v_sub_u32 v19, v17, v19
    v_mul_u32_u24 v20, 400, v18
    v_lshl_add_u32 v20, v19, 4, v20
    ds_read_b128 v[32:35], v20
    v_add_u32 v18, s40, v18
    v_mul_u32_u24 v18, 3456, v18
    v_lshl_add_u32 v18, v19, 4, v18
    v_add_u32 v50, s43, v18
    v_add_u32 v17, 768, v0
    v_mul_hi_u32 v18, v17, s42
    v_mul_u32_u24 v19, 24, v18
    v_sub_u32 v19, v17, v19
    v_mul_u32_u24 v20, 400, v18
    v_lshl_add_u32 v20, v19, 4, v20
    ds_read_b128 v[36:39], v20
    v_add_u32 v18, s40, v18
    v_mul_u32_u24 v18, 3456, v18
    v_lshl_add_u32 v18, v19, 4, v18
    v_add_u32 v51, s43, v18
    v_add_u32 v17, 1024, v0
    v_mul_hi_u32 v18, v17, s42
    v_mul_u32_u24 v19, 24, v18
    v_sub_u32 v19, v17, v19
    v_mul_u32_u24 v20, 400, v18
    v_lshl_add_u32 v20, v19, 4, v20
    ds_read_b128 v[40:43], v20
    v_add_u32 v18, s40, v18
    v_mul_u32_u24 v18, 3456, v18
    v_lshl_add_u32 v18, v19, 4, v18
    v_add_u32 v52, s43, v18
    v_add_u32 v17, 1280, v0
    v_mul_hi_u32 v18, v17, s42
    v_mul_u32_u24 v19, 24, v18
    v_sub_u32 v19, v17, v19
    v_mul_u32_u24 v20, 400, v18
    v_lshl_add_u32 v20, v19, 4, v20
    ds_read_b128 v[44:47], v20
    v_add_u32 v18, s40, v18
    v_mul_u32_u24 v18, 3456, v18
    v_lshl_add_u32 v18, v19, 4, v18
    v_add_u32 v53, s43, v18
    s_waitcnt lgkmcnt(0)
    buffer_store_dwordx4 v[24:27], v48, s[24:27], 0 offen
    buffer_store_dwordx4 v[28:31], v49, s[24:27], 0 offen
    buffer_store_dwordx4 v[32:35], v50, s[24:27], 0 offen
    buffer_store_dwordx4 v[36:39], v51, s[24:27], 0 offen
    buffer_store_dwordx4 v[40:43], v52, s[24:27], 0 offen
    buffer_store_dwordx4 v[44:47], v53, s[24:27], 0 offen
    s_nop 1
    v_add_u32 v17, 1536, v0
    v_mul_hi_u32 v18, v17, s42
    v_mul_u32_u24 v19, 24, v18
    v_sub_u32 v19, v17, v19
    v_mul_u32_u24 v20, 400, v18
    v_lshl_add_u32 v20, v19, 4, v20
    ds_read_b128 v[24:27], v20
    v_add_u32 v18, s40, v18
    v_mul_u32_u24 v18, 3456, v18
    v_lshl_add_u32 v18, v19, 4, v18
    v_add_u32 v48, s43, v18
    v_add_u32 v17, 1792, v0
    v_mul_hi_u32 v18, v17, s42
    v_mul_u32_u24 v19, 24, v18
    v_sub_u32 v19, v17, v19
    v_mul_u32_u24 v20, 400, v18
    v_lshl_add_u32 v20, v19, 4, v20
    ds_read_b128 v[28:31], v20
    v_add_u32 v18, s40, v18
    v_mul_u32_u24 v18, 3456, v18
    v_lshl_add_u32 v18, v19, 4, v18
    v_add_u32 v49, s43, v18
    v_add_u32 v17, 2048, v0
    v_mul_hi_u32 v18, v17, s42
    v_mul_u32_u24 v19, 24, v18
    v_sub_u32 v19, v17, v19
    v_mul_u32_u24 v20, 400, v18
    v_lshl_add_u32 v20, v19, 4, v20
    ds_read_b128 v[32:35], v20
    v_add_u32 v18, s40, v18
    v_mul_u32_u24 v18, 3456, v18
    v_lshl_add_u32 v18, v19, 4, v18
    v_add_u32 v50, s43, v18
    v_add_u32 v17, 2304, v0
    v_mul_hi_u32 v18, v17, s42
    v_mul_u32_u24 v19, 24, v18
    v_sub_u32 v19, v17, v19
    v_mul_u32_u24 v20, 400, v18
    v_lshl_add_u32 v20, v19, 4, v20
    ds_read_b128 v[36:39], v20
    v_add_u32 v18, s40, v18
    v_mul_u32_u24 v18, 3456, v18
    v_lshl_add_u32 v18, v19, 4, v18
    v_add_u32 v51, s43, v18
    v_add_u32 v17, 2560, v0
    v_mul_hi_u32 v18, v17, s42
    v_mul_u32_u24 v19, 24, v18
    v_sub_u32 v19, v17, v19
    v_mul_u32_u24 v20, 400, v18
    v_lshl_add_u32 v20, v19, 4, v20
    ds_read_b128 v[40:43], v20
    v_add_u32 v18, s40, v18
    v_mul_u32_u24 v18, 3456, v18
    v_lshl_add_u32 v18, v19, 4, v18
    v_add_u32 v52, s43, v18
    v_add_u32 v17, 2816, v0
    v_mul_hi_u32 v18, v17, s42
    v_mul_u32_u24 v19, 24, v18
    v_sub_u32 v19, v17, v19
    v_mul_u32_u24 v20, 400, v18
    v_lshl_add_u32 v20, v19, 4, v20
    ds_read_b128 v[44:47], v20
    v_add_u32 v18, s40, v18
    v_mul_u32_u24 v18, 3456, v18
    v_lshl_add_u32 v18, v19, 4, v18
    v_add_u32 v53, s43, v18
    s_waitcnt lgkmcnt(0)
    buffer_store_dwordx4 v[24:27], v48, s[24:27], 0 offen
    buffer_store_dwordx4 v[28:31], v49, s[24:27], 0 offen
    buffer_store_dwordx4 v[32:35], v50, s[24:27], 0 offen
    buffer_store_dwordx4 v[36:39], v51, s[24:27], 0 offen
    buffer_store_dwordx4 v[40:43], v52, s[24:27], 0 offen
    buffer_store_dwordx4 v[44:47], v53, s[24:27], 0 offen
    s_nop 1
    s_branch .g1_end
.g1_ffn:
    s_mov_b32 s20, s6
    s_mov_b32 s21, s7
    s_mov_b32 s22, 5308416
    s_mov_b32 s23, 0x00020000
    s_sub_u32 s12, s12, 9
    s_mul_i32 s41, s12, 192
    s_mov_b32 s44, 0
    s_mov_b32 s45, 0
    v_and_b32 v17, 63, v0
    v_lshrrev_b32 v18, 6, v0
    v_mul_u32_u24 v19, 128, v18
    v_add_u32 v19, v19, v17
    v_lshrrev_b32 v20, 2, v19
    v_and_b32 v19, 3, v19
    v_bfe_u32 v21, v20, 2, 2
    v_xor_b32 v19, v19, v21
    v_add_u32 v20, s40, v20
    s_mov_b32 s42, 1152
    v_mul_lo_u32 v20, v20, s42
    v_lshl_add_u32 v1, v19, 4, v20
    v_mul_u32_u24 v19, 128, v18
    v_add_u32 v19, v19, v17
    v_add_u32 v19, 64, v19
    v_lshrrev_b32 v20, 2, v19
    v_and_b32 v19, 3, v19
    v_bfe_u32 v21, v20, 2, 2
    v_xor_b32 v19, v19, v21
    v_add_u32 v20, s40, v20
    s_mov_b32 s42, 1152
    v_mul_lo_u32 v20, v20, s42
    v_lshl_add_u32 v2, v19, 4, v20
    v_mul_u32_u24 v19, 192, v18
    v_add_u32 v19, v19, v17
    s_mov_b32 s42, 683
    v_mul_lo_u32 v20, v19, s42
    v_lshrrev_b32 v20, 14, v20
    v_mul_u32_u24 v21, 24, v20
    v_sub_u32 v19, v19, v21
    v_bfe_u32 v21, v20, 1, 1
    v_lshlrev_b32 v21, 2, v21
    v_xor_b32 v19, v19, v21
    s_mov_b32 s42, 9216
    v_mul_lo_u32 v20, v20, s42
    v_lshl_add_u32 v20, v19, 4, v20
    s_lshl_b32 s42, s41, 1
    v_add_u32 v4, s42, v20
    v_mul_u32_u24 v19, 192, v18
    v_add_u32 v19, v19, v17
    v_add_u32 v19, 64, v19
    s_mov_b32 s42, 683
    v_mul_lo_u32 v20, v19, s42
    v_lshrrev_b32 v20, 14, v20
    v_mul_u32_u24 v21, 24, v20
    v_sub_u32 v19, v19, v21
    v_bfe_u32 v21, v20, 1, 1
    v_lshlrev_b32 v21, 2, v21
    v_xor_b32 v19, v19, v21
    s_mov_b32 s42, 9216
    v_mul_lo_u32 v20, v20, s42
    v_lshl_add_u32 v20, v19, 4, v20
    s_lshl_b32 s42, s41, 1
    v_add_u32 v5, s42, v20
    v_mul_u32_u24 v19, 192, v18
    v_add_u32 v19, v19, v17
    v_add_u32 v19, 128, v19
    s_mov_b32 s42, 683
    v_mul_lo_u32 v20, v19, s42
    v_lshrrev_b32 v20, 14, v20
    v_mul_u32_u24 v21, 24, v20
    v_sub_u32 v19, v19, v21
    v_bfe_u32 v21, v20, 1, 1
    v_lshlrev_b32 v21, 2, v21
    v_xor_b32 v19, v19, v21
    s_mov_b32 s42, 9216
    v_mul_lo_u32 v20, v20, s42
    v_lshl_add_u32 v20, v19, 4, v20
    s_lshl_b32 s42, s41, 1
    v_add_u32 v6, s42, v20
    s_nop 0
    v_readfirstlane_b32 s47, v18
    s_mul_i32 s48, s47, 2048
    s_mul_i32 s49, s47, 3072
    s_add_u32 s49, s49, 8192
    v_lshrrev_b32 v19, 1, v18
    v_mul_u32_u24 v19, 64, v19
    v_and_b32 v20, 31, v17
    v_add_u32 v19, v19, v20
    v_bfe_u32 v20, v19, 2, 2
    v_lshrrev_b32 v21, 5, v17
    v_add_u32 v22, 0, v21
    v_xor_b32 v22, v22, v20
    v_lshlrev_b32 v22, 4, v22
    v_mul_u32_u24 v7, 64, v19
    v_add_u32 v7, v7, v22
    v_add_u32 v22, 2, v21
    v_xor_b32 v22, v22, v20
    v_lshlrev_b32 v22, 4, v22
    v_mul_u32_u24 v8, 64, v19
    v_add_u32 v8, v8, v22
    v_lshrrev_b32 v19, 5, v17
    v_lshlrev_b32 v19, 3, v19
    v_bfe_u32 v20, v17, 2, 2
    v_add_u32 v19, v19, v20
    v_mul_u32_u24 v19, 384, v19
    v_bfe_u32 v20, v17, 4, 1
    v_lshl_add_u32 v19, v20, 5, v19
    v_and_b32 v20, 3, v17
    v_lshl_add_u32 v19, v20, 3, v19
    v_add_u32 v19, 8192, v19
    v_and_b32 v20, 1, v18
    v_mul_u32_u24 v20, 3, v20
    v_bfe_u32 v21, v17, 3, 1
    v_add_u32 v22, 0, v20
    v_xor_b32 v22, v22, v21
    v_lshl_add_u32 v9, v22, 6, v19
    v_add_u32 v22, 1, v20
    v_xor_b32 v22, v22, v21
    v_lshl_add_u32 v10, v22, 6, v19
    v_add_u32 v22, 2, v20
    v_xor_b32 v22, v22, v21
    v_lshl_add_u32 v11, v22, 6, v19
    v_add_u32 v160, 32768, v7
    v_add_u32 v161, 32768, v8
    v_add_u32 v162, 32768, v9
    v_add_u32 v163, 32768, v10
    v_add_u32 v164, 32768, v11
    v_mov_b32 v64, 0
    v_mov_b32 v65, 0
    v_mov_b32 v66, 0
    v_mov_b32 v67, 0
    v_mov_b32 v68, 0
    v_mov_b32 v69, 0
    v_mov_b32 v70, 0
    v_mov_b32 v71, 0
    v_mov_b32 v72, 0
    v_mov_b32 v73, 0
    v_mov_b32 v74, 0
    v_mov_b32 v75, 0
    v_mov_b32 v76, 0
    v_mov_b32 v77, 0
    v_mov_b32 v78, 0
    v_mov_b32 v79, 0
    v_mov_b32 v80, 0
    v_mov_b32 v81, 0
    v_mov_b32 v82, 0
    v_mov_b32 v83, 0
    v_mov_b32 v84, 0
    v_mov_b32 v85, 0
    v_mov_b32 v86, 0
    v_mov_b32 v87, 0
    v_mov_b32 v88, 0
    v_mov_b32 v89, 0
    v_mov_b32 v90, 0
    v_mov_b32 v91, 0
    v_mov_b32 v92, 0
    v_mov_b32 v93, 0
    v_mov_b32 v94, 0
    v_mov_b32 v95, 0
    v_mov_b32 v96, 0
    v_mov_b32 v97, 0
    v_mov_b32 v98, 0
    v_mov_b32 v99, 0
    v_mov_b32 v100, 0
    v_mov_b32 v101, 0
    v_mov_b32 v102, 0
    v_mov_b32 v103, 0
    v_mov_b32 v104, 0
    v_mov_b32 v105, 0
    v_mov_b32 v106, 0
    v_mov_b32 v107, 0
    v_mov_b32 v108, 0
    v_mov_b32 v109, 0
    v_mov_b32 v110, 0
    v_mov_b32 v111, 0
    v_mov_b32 v112, 0
    v_mov_b32 v113, 0
    v_mov_b32 v114, 0
    v_mov_b32 v115, 0
    v_mov_b32 v116, 0
    v_mov_b32 v117, 0
    v_mov_b32 v118, 0
    v_mov_b32 v119, 0
    v_mov_b32 v120, 0
    v_mov_b32 v121, 0
    v_mov_b32 v122, 0
    v_mov_b32 v123, 0
    v_mov_b32 v124, 0
    v_mov_b32 v125, 0
    v_mov_b32 v126, 0
    v_mov_b32 v127, 0
    v_mov_b32 v128, 0
    v_mov_b32 v129, 0
    v_mov_b32 v130, 0
    v_mov_b32 v131, 0
    v_mov_b32 v132, 0
    v_mov_b32 v133, 0
    v_mov_b32 v134, 0
    v_mov_b32 v135, 0
    v_mov_b32 v136, 0
    v_mov_b32 v137, 0
    v_mov_b32 v138, 0
    v_mov_b32 v139, 0
    v_mov_b32 v140, 0
    v_mov_b32 v141, 0
    v_mov_b32 v142, 0
    v_mov_b32 v143, 0
    v_mov_b32 v144, 0
    v_mov_b32 v145, 0
    v_mov_b32 v146, 0
    v_mov_b32 v147, 0
    v_mov_b32 v148, 0
    v_mov_b32 v149, 0
    v_mov_b32 v150, 0
    v_mov_b32 v151, 0
    v_mov_b32 v152, 0
    v_mov_b32 v153, 0
    v_mov_b32 v154, 0
    v_mov_b32 v155, 0
    v_mov_b32 v156, 0
    v_mov_b32 v157, 0
    v_mov_b32 v158, 0
    v_mov_b32 v159, 0
    s_add_u32 m0, s48, 0
    s_nop 0
    buffer_load_dwordx4 v1, s[16:19], s44 offen lds
    s_add_u32 m0, s48, 1024
    s_nop 0
    buffer_load_dwordx4 v2, s[16:19], s44 offen lds
    s_add_u32 m0, s49, 0
    s_nop 0
    buffer_load_dwordx4 v4, s[20:23], s45 offen lds
    s_add_u32 m0, s49, 1024
    s_nop 0
    buffer_load_dwordx4 v5, s[20:23], s45 offen lds
    s_add_u32 m0, s49, 2048
    s_nop 0
    buffer_load_dwordx4 v6, s[20:23], s45 offen lds
    s_add_u32 s44, s44, 64
    s_add_u32 s45, s45, 294912
    s_add_u32 m0, s48, 20480
    s_nop 0
    buffer_load_dwordx4 v1, s[16:19], s44 offen lds
    s_add_u32 m0, s48, 21504
    s_nop 0
    buffer_load_dwordx4 v2, s[16:19], s44 offen lds
    s_add_u32 m0, s49, 20480
    s_nop 0
    buffer_load_dwordx4 v4, s[20:23], s45 offen lds
    s_add_u32 m0, s49, 21504
    s_nop 0
    buffer_load_dwordx4 v5, s[20:23], s45 offen lds
    s_add_u32 m0, s49, 22528
    s_nop 0
    buffer_load_dwordx4 v6, s[20:23], s45 offen lds
    s_add_u32 s44, s44, 64
    s_add_u32 s45, s45, 294912
    s_add_u32 m0, s48, 40960
    s_nop 0
    buffer_load_dwordx4 v1, s[16:19], s44 offen lds
    s_add_u32 m0, s48, 41984
    s_nop 0
    buffer_load_dwordx4 v2, s[16:19], s44 offen lds
    s_add_u32 m0, s49, 40960
    s_nop 0
    buffer_load_dwordx4 v4, s[20:23], s45 offen lds
    s_add_u32 m0, s49, 41984
    s_nop 0
    buffer_load_dwordx4 v5, s[20:23], s45 offen lds
    s_add_u32 m0, s49, 43008
    s_nop 0
    buffer_load_dwordx4 v6, s[20:23], s45 offen lds
    s_add_u32 s44, s44, 64
    s_add_u32 s45, s45, 294912
    s_waitcnt vmcnt(10)
    s_barrier
    ds_read_b128 v[24:27], v7 offset:0
    ds_read_b128 v[28:31], v7 offset:2048
    ds_read_b64_tr_b16 v[32:33], v9 offset:0
    ds_read_b64_tr_b16 v[34:35], v9 offset:1536
    ds_read_b64_tr_b16 v[36:37], v10 offset:0
    ds_read_b64_tr_b16 v[38:39], v10 offset:1536
    ds_read_b64_tr_b16 v[40:41], v11 offset:0
    ds_read_b64_tr_b16 v[42:43], v11 offset:1536
    s_mov_b32 s46, 3
.g1f_loop:
    s_waitcnt lgkmcnt(0)
    v_mfma_f32_32x32x16_bf16 v[64:79], v[32:35], v[24:27], v[64:79]
    ds_read_b128 v[44:47], v8 offset:0
    ds_read_b128 v[48:51], v8 offset:2048
    v_mfma_f32_32x32x16_bf16 v[80:95], v[32:35], v[28:31], v[80:95]
    ds_read_b64_tr_b16 v[52:53], v9 offset:6144
    ds_read_b64_tr_b16 v[54:55], v9 offset:7680
    v_mfma_f32_32x32x16_bf16 v[96:111], v[36:39], v[24:27], v[96:111]
    ds_read_b64_tr_b16 v[56:57], v10 offset:6144
    ds_read_b64_tr_b16 v[58:59], v10 offset:7680
    v_mfma_f32_32x32x16_bf16 v[112:127], v[36:39], v[28:31], v[112:127]
    ds_read_b64_tr_b16 v[60:61], v11 offset:6144
    ds_read_b64_tr_b16 v[62:63], v11 offset:7680
    v_mfma_f32_32x32x16_bf16 v[128:143], v[40:43], v[24:27], v[128:143]
    v_mfma_f32_32x32x16_bf16 v[144:159], v[40:43], v[28:31], v[144:159]
    s_waitcnt lgkmcnt(0)
    s_waitcnt vmcnt(5)
    s_barrier
    v_mfma_f32_32x32x16_bf16 v[64:79], v[52:55], v[44:47], v[64:79]
    s_add_u32 m0, s48, 61440
    s_nop 0
    buffer_load_dwordx4 v1, s[16:19], s44 offen lds
    s_add_u32 m0, s48, 62464
    s_nop 0
    buffer_load_dwordx4 v2, s[16:19], s44 offen lds
    s_add_u32 m0, s49, 61440
    s_nop 0
    buffer_load_dwordx4 v4, s[20:23], s45 offen lds
    v_mfma_f32_32x32x16_bf16 v[80:95], v[52:55], v[48:51], v[80:95]
    s_add_u32 m0, s49, 62464
    s_nop 0
    buffer_load_dwordx4 v5, s[20:23], s45 offen lds
    s_add_u32 m0, s49, 63488
    s_nop 0
    buffer_load_dwordx4 v6, s[20:23], s45 offen lds
    s_add_u32 s44, s44, 64
    v_mfma_f32_32x32x16_bf16 v[96:111], v[56:59], v[44:47], v[96:111]
    s_add_u32 s45, s45, 294912
    ds_read_b128 v[24:27], v7 offset:20480
    ds_read_b128 v[28:31], v7 offset:22528
    v_mfma_f32_32x32x16_bf16 v[112:127], v[56:59], v[48:51], v[112:127]
    ds_read_b64_tr_b16 v[32:33], v9 offset:20480
    ds_read_b64_tr_b16 v[34:35], v9 offset:22016
    ds_read_b64_tr_b16 v[36:37], v10 offset:20480
    v_mfma_f32_32x32x16_bf16 v[128:143], v[60:63], v[44:47], v[128:143]
    ds_read_b64_tr_b16 v[38:39], v10 offset:22016
    ds_read_b64_tr_b16 v[40:41], v11 offset:20480
    ds_read_b64_tr_b16 v[42:43], v11 offset:22016
    v_mfma_f32_32x32x16_bf16 v[144:159], v[60:63], v[48:51], v[144:159]
    s_waitcnt lgkmcnt(0)
    v_mfma_f32_32x32x16_bf16 v[64:79], v[32:35], v[24:27], v[64:79]
    ds_read_b128 v[44:47], v8 offset:20480
    ds_read_b128 v[48:51], v8 offset:22528
    v_mfma_f32_32x32x16_bf16 v[80:95], v[32:35], v[28:31], v[80:95]
    ds_read_b64_tr_b16 v[52:53], v9 offset:26624
    ds_read_b64_tr_b16 v[54:55], v9 offset:28160
    v_mfma_f32_32x32x16_bf16 v[96:111], v[36:39], v[24:27], v[96:111]
    ds_read_b64_tr_b16 v[56:57], v10 offset:26624
    ds_read_b64_tr_b16 v[58:59], v10 offset:28160
    v_mfma_f32_32x32x16_bf16 v[112:127], v[36:39], v[28:31], v[112:127]
    ds_read_b64_tr_b16 v[60:61], v11 offset:26624
    ds_read_b64_tr_b16 v[62:63], v11 offset:28160
    v_mfma_f32_32x32x16_bf16 v[128:143], v[40:43], v[24:27], v[128:143]
    v_mfma_f32_32x32x16_bf16 v[144:159], v[40:43], v[28:31], v[144:159]
    s_waitcnt lgkmcnt(0)
    s_waitcnt vmcnt(5)
    s_barrier
    v_mfma_f32_32x32x16_bf16 v[64:79], v[52:55], v[44:47], v[64:79]
    s_add_u32 m0, s48, 0
    s_nop 0
    buffer_load_dwordx4 v1, s[16:19], s44 offen lds
    s_add_u32 m0, s48, 1024
    s_nop 0
    buffer_load_dwordx4 v2, s[16:19], s44 offen lds
    s_add_u32 m0, s49, 0
    s_nop 0
    buffer_load_dwordx4 v4, s[20:23], s45 offen lds
    v_mfma_f32_32x32x16_bf16 v[80:95], v[52:55], v[48:51], v[80:95]
    s_add_u32 m0, s49, 1024
    s_nop 0
    buffer_load_dwordx4 v5, s[20:23], s45 offen lds
    s_add_u32 m0, s49, 2048
    s_nop 0
    buffer_load_dwordx4 v6, s[20:23], s45 offen lds
    s_add_u32 s44, s44, 64
    v_mfma_f32_32x32x16_bf16 v[96:111], v[56:59], v[44:47], v[96:111]
    s_add_u32 s45, s45, 294912
    ds_read_b128 v[24:27], v160 offset:8192
    ds_read_b128 v[28:31], v160 offset:10240
    v_mfma_f32_32x32x16_bf16 v[112:127], v[56:59], v[48:51], v[112:127]
    ds_read_b64_tr_b16 v[32:33], v162 offset:8192
    ds_read_b64_tr_b16 v[34:35], v162 offset:9728
    ds_read_b64_tr_b16 v[36:37], v163 offset:8192
    v_mfma_f32_32x32x16_bf16 v[128:143], v[60:63], v[44:47], v[128:143]
    ds_read_b64_tr_b16 v[38:39], v163 offset:9728
    ds_read_b64_tr_b16 v[40:41], v164 offset:8192
    ds_read_b64_tr_b16 v[42:43], v164 offset:9728
    v_mfma_f32_32x32x16_bf16 v[144:159], v[60:63], v[48:51], v[144:159]
    s_waitcnt lgkmcnt(0)
    v_mfma_f32_32x32x16_bf16 v[64:79], v[32:35], v[24:27], v[64:79]
    ds_read_b128 v[44:47], v161 offset:8192
    ds_read_b128 v[48:51], v161 offset:10240
    v_mfma_f32_32x32x16_bf16 v[80:95], v[32:35], v[28:31], v[80:95]
    ds_read_b64_tr_b16 v[52:53], v162 offset:14336
    ds_read_b64_tr_b16 v[54:55], v162 offset:15872
    v_mfma_f32_32x32x16_bf16 v[96:111], v[36:39], v[24:27], v[96:111]
    ds_read_b64_tr_b16 v[56:57], v163 offset:14336
    ds_read_b64_tr_b16 v[58:59], v163 offset:15872
    v_mfma_f32_32x32x16_bf16 v[112:127], v[36:39], v[28:31], v[112:127]
    ds_read_b64_tr_b16 v[60:61], v164 offset:14336
    ds_read_b64_tr_b16 v[62:63], v164 offset:15872
    v_mfma_f32_32x32x16_bf16 v[128:143], v[40:43], v[24:27], v[128:143]
    v_mfma_f32_32x32x16_bf16 v[144:159], v[40:43], v[28:31], v[144:159]
    s_waitcnt lgkmcnt(0)
    s_waitcnt vmcnt(5)
    s_barrier
    v_mfma_f32_32x32x16_bf16 v[64:79], v[52:55], v[44:47], v[64:79]
    s_add_u32 m0, s48, 20480
    s_nop 0
    buffer_load_dwordx4 v1, s[16:19], s44 offen lds
    s_add_u32 m0, s48, 21504
    s_nop 0
    buffer_load_dwordx4 v2, s[16:19], s44 offen lds
    s_add_u32 m0, s49, 20480
    s_nop 0
    buffer_load_dwordx4 v4, s[20:23], s45 offen lds
    v_mfma_f32_32x32x16_bf16 v[80:95], v[52:55], v[48:51], v[80:95]
    s_add_u32 m0, s49, 21504
    s_nop 0
    buffer_load_dwordx4 v5, s[20:23], s45 offen lds
    s_add_u32 m0, s49, 22528
    s_nop 0
    buffer_load_dwordx4 v6, s[20:23], s45 offen lds
    s_add_u32 s44, s44, 64
    v_mfma_f32_32x32x16_bf16 v[96:111], v[56:59], v[44:47], v[96:111]
    s_add_u32 s45, s45, 294912
    ds_read_b128 v[24:27], v160 offset:28672
    ds_read_b128 v[28:31], v160 offset:30720
    v_mfma_f32_32x32x16_bf16 v[112:127], v[56:59], v[48:51], v[112:127]
    ds_read_b64_tr_b16 v[32:33], v162 offset:28672
    ds_read_b64_tr_b16 v[34:35], v162 offset:30208
    ds_read_b64_tr_b16 v[36:37], v163 offset:28672
    v_mfma_f32_32x32x16_bf16 v[128:143], v[60:63], v[44:47], v[128:143]
    ds_read_b64_tr_b16 v[38:39], v163 offset:30208
    ds_read_b64_tr_b16 v[40:41], v164 offset:28672
    ds_read_b64_tr_b16 v[42:43], v164 offset:30208
    v_mfma_f32_32x32x16_bf16 v[144:159], v[60:63], v[48:51], v[144:159]
    s_waitcnt lgkmcnt(0)
    v_mfma_f32_32x32x16_bf16 v[64:79], v[32:35], v[24:27], v[64:79]
    ds_read_b128 v[44:47], v161 offset:28672
    ds_read_b128 v[48:51], v161 offset:30720
    v_mfma_f32_32x32x16_bf16 v[80:95], v[32:35], v[28:31], v[80:95]
    ds_read_b64_tr_b16 v[52:53], v162 offset:34816
    ds_read_b64_tr_b16 v[54:55], v162 offset:36352
    v_mfma_f32_32x32x16_bf16 v[96:111], v[36:39], v[24:27], v[96:111]
    ds_read_b64_tr_b16 v[56:57], v163 offset:34816
    ds_read_b64_tr_b16 v[58:59], v163 offset:36352
    v_mfma_f32_32x32x16_bf16 v[112:127], v[36:39], v[28:31], v[112:127]
    ds_read_b64_tr_b16 v[60:61], v164 offset:34816
    ds_read_b64_tr_b16 v[62:63], v164 offset:36352
    v_mfma_f32_32x32x16_bf16 v[128:143], v[40:43], v[24:27], v[128:143]
    v_mfma_f32_32x32x16_bf16 v[144:159], v[40:43], v[28:31], v[144:159]
    s_waitcnt lgkmcnt(0)
    s_waitcnt vmcnt(5)
    s_barrier
    v_mfma_f32_32x32x16_bf16 v[64:79], v[52:55], v[44:47], v[64:79]
    s_add_u32 m0, s48, 40960
    s_nop 0
    buffer_load_dwordx4 v1, s[16:19], s44 offen lds
    s_add_u32 m0, s48, 41984
    s_nop 0
    buffer_load_dwordx4 v2, s[16:19], s44 offen lds
    s_add_u32 m0, s49, 40960
    s_nop 0
    buffer_load_dwordx4 v4, s[20:23], s45 offen lds
    v_mfma_f32_32x32x16_bf16 v[80:95], v[52:55], v[48:51], v[80:95]
    s_add_u32 m0, s49, 41984
    s_nop 0
    buffer_load_dwordx4 v5, s[20:23], s45 offen lds
    s_add_u32 m0, s49, 43008
    s_nop 0
    buffer_load_dwordx4 v6, s[20:23], s45 offen lds
    s_add_u32 s44, s44, 64
    v_mfma_f32_32x32x16_bf16 v[96:111], v[56:59], v[44:47], v[96:111]
    s_add_u32 s45, s45, 294912
    ds_read_b128 v[24:27], v7 offset:0
    ds_read_b128 v[28:31], v7 offset:2048
    v_mfma_f32_32x32x16_bf16 v[112:127], v[56:59], v[48:51], v[112:127]
    ds_read_b64_tr_b16 v[32:33], v9 offset:0
    ds_read_b64_tr_b16 v[34:35], v9 offset:1536
    ds_read_b64_tr_b16 v[36:37], v10 offset:0
    v_mfma_f32_32x32x16_bf16 v[128:143], v[60:63], v[44:47], v[128:143]
    ds_read_b64_tr_b16 v[38:39], v10 offset:1536
    ds_read_b64_tr_b16 v[40:41], v11 offset:0
    ds_read_b64_tr_b16 v[42:43], v11 offset:1536
    v_mfma_f32_32x32x16_bf16 v[144:159], v[60:63], v[48:51], v[144:159]
    s_sub_u32 s46, s46, 1
    s_cmp_lg_u32 s46, 0
    s_cbranch_scc1 .g1f_loop
    s_waitcnt lgkmcnt(0)
    v_mfma_f32_32x32x16_bf16 v[64:79], v[32:35], v[24:27], v[64:79]
    ds_read_b128 v[44:47], v8 offset:0
    ds_read_b128 v[48:51], v8 offset:2048
    v_mfma_f32_32x32x16_bf16 v[80:95], v[32:35], v[28:31], v[80:95]
    ds_read_b64_tr_b16 v[52:53], v9 offset:6144
    ds_read_b64_tr_b16 v[54:55], v9 offset:7680
    v_mfma_f32_32x32x16_bf16 v[96:111], v[36:39], v[24:27], v[96:111]
    ds_read_b64_tr_b16 v[56:57], v10 offset:6144
    ds_read_b64_tr_b16 v[58:59], v10 offset:7680
    v_mfma_f32_32x32x16_bf16 v[112:127], v[36:39], v[28:31], v[112:127]
    ds_read_b64_tr_b16 v[60:61], v11 offset:6144
    ds_read_b64_tr_b16 v[62:63], v11 offset:7680
    v_mfma_f32_32x32x16_bf16 v[128:143], v[40:43], v[24:27], v[128:143]
    v_mfma_f32_32x32x16_bf16 v[144:159], v[40:43], v[28:31], v[144:159]
    s_waitcnt lgkmcnt(0)
    s_waitcnt vmcnt(5)
    s_barrier
    v_mfma_f32_32x32x16_bf16 v[64:79], v[52:55], v[44:47], v[64:79]
    s_add_u32 m0, s48, 61440
    s_nop 0
    buffer_load_dwordx4 v1, s[16:19], s44 offen lds
    s_add_u32 m0, s48, 62464
    s_nop 0
    buffer_load_dwordx4 v2, s[16:19], s44 offen lds
    s_add_u32 m0, s49, 61440
    s_nop 0
    buffer_load_dwordx4 v4, s[20:23], s45 offen lds
    v_mfma_f32_32x32x16_bf16 v[80:95], v[52:55], v[48:51], v[80:95]
    s_add_u32 m0, s49, 62464
    s_nop 0
    buffer_load_dwordx4 v5, s[20:23], s45 offen lds
    s_add_u32 m0, s49, 63488
    s_nop 0
    buffer_load_dwordx4 v6, s[20:23], s45 offen lds
    s_add_u32 s44, s44, 64
    v_mfma_f32_32x32x16_bf16 v[96:111], v[56:59], v[44:47], v[96:111]
    s_add_u32 s45, s45, 294912
    ds_read_b128 v[24:27], v7 offset:20480
    ds_read_b128 v[28:31], v7 offset:22528
    v_mfma_f32_32x32x16_bf16 v[112:127], v[56:59], v[48:51], v[112:127]
    ds_read_b64_tr_b16 v[32:33], v9 offset:20480
    ds_read_b64_tr_b16 v[34:35], v9 offset:22016
    ds_read_b64_tr_b16 v[36:37], v10 offset:20480
    v_mfma_f32_32x32x16_bf16 v[128:143], v[60:63], v[44:47], v[128:143]
    ds_read_b64_tr_b16 v[38:39], v10 offset:22016
    ds_read_b64_tr_b16 v[40:41], v11 offset:20480
    ds_read_b64_tr_b16 v[42:43], v11 offset:22016
    v_mfma_f32_32x32x16_bf16 v[144:159], v[60:63], v[48:51], v[144:159]
    s_waitcnt lgkmcnt(0)
    v_mfma_f32_32x32x16_bf16 v[64:79], v[32:35], v[24:27], v[64:79]
    ds_read_b128 v[44:47], v8 offset:20480
    ds_read_b128 v[48:51], v8 offset:22528
    v_mfma_f32_32x32x16_bf16 v[80:95], v[32:35], v[28:31], v[80:95]
    ds_read_b64_tr_b16 v[52:53], v9 offset:26624
    ds_read_b64_tr_b16 v[54:55], v9 offset:28160
    v_mfma_f32_32x32x16_bf16 v[96:111], v[36:39], v[24:27], v[96:111]
    ds_read_b64_tr_b16 v[56:57], v10 offset:26624
    ds_read_b64_tr_b16 v[58:59], v10 offset:28160
    v_mfma_f32_32x32x16_bf16 v[112:127], v[36:39], v[28:31], v[112:127]
    ds_read_b64_tr_b16 v[60:61], v11 offset:26624
    ds_read_b64_tr_b16 v[62:63], v11 offset:28160
    v_mfma_f32_32x32x16_bf16 v[128:143], v[40:43], v[24:27], v[128:143]
    v_mfma_f32_32x32x16_bf16 v[144:159], v[40:43], v[28:31], v[144:159]
    s_waitcnt lgkmcnt(0)
    s_waitcnt vmcnt(5)
    s_barrier
    v_mfma_f32_32x32x16_bf16 v[64:79], v[52:55], v[44:47], v[64:79]
    s_add_u32 m0, s48, 0
    s_nop 0
    buffer_load_dwordx4 v1, s[16:19], s44 offen lds
    s_add_u32 m0, s48, 1024
    s_nop 0
    buffer_load_dwordx4 v2, s[16:19], s44 offen lds
    s_add_u32 m0, s49, 0
    s_nop 0
    buffer_load_dwordx4 v4, s[20:23], s45 offen lds
    v_mfma_f32_32x32x16_bf16 v[80:95], v[52:55], v[48:51], v[80:95]
    s_add_u32 m0, s49, 1024
    s_nop 0
    buffer_load_dwordx4 v5, s[20:23], s45 offen lds
    s_add_u32 m0, s49, 2048
    s_nop 0
    buffer_load_dwordx4 v6, s[20:23], s45 offen lds
    s_add_u32 s44, s44, 64
    v_mfma_f32_32x32x16_bf16 v[96:111], v[56:59], v[44:47], v[96:111]
    s_add_u32 s45, s45, 294912
    ds_read_b128 v[24:27], v160 offset:8192
    ds_read_b128 v[28:31], v160 offset:10240
    v_mfma_f32_32x32x16_bf16 v[112:127], v[56:59], v[48:51], v[112:127]
    ds_read_b64_tr_b16 v[32:33], v162 offset:8192
    ds_read_b64_tr_b16 v[34:35], v162 offset:9728
    ds_read_b64_tr_b16 v[36:37], v163 offset:8192
    v_mfma_f32_32x32x16_bf16 v[128:143], v[60:63], v[44:47], v[128:143]
    ds_read_b64_tr_b16 v[38:39], v163 offset:9728
    ds_read_b64_tr_b16 v[40:41], v164 offset:8192
    ds_read_b64_tr_b16 v[42:43], v164 offset:9728
    v_mfma_f32_32x32x16_bf16 v[144:159], v[60:63], v[48:51], v[144:159]
    s_waitcnt lgkmcnt(0)
    v_mfma_f32_32x32x16_bf16 v[64:79], v[32:35], v[24:27], v[64:79]
    ds_read_b128 v[44:47], v161 offset:8192
    ds_read_b128 v[48:51], v161 offset:10240
    v_mfma_f32_32x32x16_bf16 v[80:95], v[32:35], v[28:31], v[80:95]
    ds_read_b64_tr_b16 v[52:53], v162 offset:14336
    ds_read_b64_tr_b16 v[54:55], v162 offset:15872
    v_mfma_f32_32x32x16_bf16 v[96:111], v[36:39], v[24:27], v[96:111]
    ds_read_b64_tr_b16 v[56:57], v163 offset:14336
    ds_read_b64_tr_b16 v[58:59], v163 offset:15872
    v_mfma_f32_32x32x16_bf16 v[112:127], v[36:39], v[28:31], v[112:127]
    ds_read_b64_tr_b16 v[60:61], v164 offset:14336
    ds_read_b64_tr_b16 v[62:63], v164 offset:15872
    v_mfma_f32_32x32x16_bf16 v[128:143], v[40:43], v[24:27], v[128:143]
    v_mfma_f32_32x32x16_bf16 v[144:159], v[40:43], v[28:31], v[144:159]
    s_waitcnt lgkmcnt(0)
    s_waitcnt vmcnt(5)
    s_barrier
    v_mfma_f32_32x32x16_bf16 v[64:79], v[52:55], v[44:47], v[64:79]
    s_add_u32 m0, s48, 20480
    s_nop 0
    buffer_load_dwordx4 v1, s[16:19], s44 offen lds
    s_add_u32 m0, s48, 21504
    s_nop 0
    buffer_load_dwordx4 v2, s[16:19], s44 offen lds
    s_add_u32 m0, s49, 20480
    s_nop 0
    buffer_load_dwordx4 v4, s[20:23], s45 offen lds
    v_mfma_f32_32x32x16_bf16 v[80:95], v[52:55], v[48:51], v[80:95]
    s_add_u32 m0, s49, 21504
    s_nop 0
    buffer_load_dwordx4 v5, s[20:23], s45 offen lds
    s_add_u32 m0, s49, 22528
    s_nop 0
    buffer_load_dwordx4 v6, s[20:23], s45 offen lds
    s_add_u32 s44, s44, 64
    v_mfma_f32_32x32x16_bf16 v[96:111], v[56:59], v[44:47], v[96:111]
    s_add_u32 s45, s45, 294912
    ds_read_b128 v[24:27], v160 offset:28672
    ds_read_b128 v[28:31], v160 offset:30720
    v_mfma_f32_32x32x16_bf16 v[112:127], v[56:59], v[48:51], v[112:127]
    ds_read_b64_tr_b16 v[32:33], v162 offset:28672
    ds_read_b64_tr_b16 v[34:35], v162 offset:30208
    ds_read_b64_tr_b16 v[36:37], v163 offset:28672
    v_mfma_f32_32x32x16_bf16 v[128:143], v[60:63], v[44:47], v[128:143]
    ds_read_b64_tr_b16 v[38:39], v163 offset:30208
    ds_read_b64_tr_b16 v[40:41], v164 offset:28672
    ds_read_b64_tr_b16 v[42:43], v164 offset:30208
    v_mfma_f32_32x32x16_bf16 v[144:159], v[60:63], v[48:51], v[144:159]
    s_waitcnt lgkmcnt(0)
    v_mfma_f32_32x32x16_bf16 v[64:79], v[32:35], v[24:27], v[64:79]
    ds_read_b128 v[44:47], v161 offset:28672
    ds_read_b128 v[48:51], v161 offset:30720
    v_mfma_f32_32x32x16_bf16 v[80:95], v[32:35], v[28:31], v[80:95]
    ds_read_b64_tr_b16 v[52:53], v162 offset:34816
    ds_read_b64_tr_b16 v[54:55], v162 offset:36352
    v_mfma_f32_32x32x16_bf16 v[96:111], v[36:39], v[24:27], v[96:111]
    ds_read_b64_tr_b16 v[56:57], v163 offset:34816
    ds_read_b64_tr_b16 v[58:59], v163 offset:36352
    v_mfma_f32_32x32x16_bf16 v[112:127], v[36:39], v[28:31], v[112:127]
    ds_read_b64_tr_b16 v[60:61], v164 offset:34816
    ds_read_b64_tr_b16 v[62:63], v164 offset:36352
    v_mfma_f32_32x32x16_bf16 v[128:143], v[40:43], v[24:27], v[128:143]
    v_mfma_f32_32x32x16_bf16 v[144:159], v[40:43], v[28:31], v[144:159]
    s_waitcnt lgkmcnt(0)
    s_waitcnt vmcnt(5)
    s_barrier
    v_mfma_f32_32x32x16_bf16 v[64:79], v[52:55], v[44:47], v[64:79]
    ds_read_b128 v[24:27], v7 offset:0
    ds_read_b128 v[28:31], v7 offset:2048
    v_mfma_f32_32x32x16_bf16 v[80:95], v[52:55], v[48:51], v[80:95]
    ds_read_b64_tr_b16 v[32:33], v9 offset:0
    ds_read_b64_tr_b16 v[34:35], v9 offset:1536
    v_mfma_f32_32x32x16_bf16 v[96:111], v[56:59], v[44:47], v[96:111]
    ds_read_b64_tr_b16 v[36:37], v10 offset:0
    ds_read_b64_tr_b16 v[38:39], v10 offset:1536
    v_mfma_f32_32x32x16_bf16 v[112:127], v[56:59], v[48:51], v[112:127]
    ds_read_b64_tr_b16 v[40:41], v11 offset:0
    ds_read_b64_tr_b16 v[42:43], v11 offset:1536
    v_mfma_f32_32x32x16_bf16 v[128:143], v[60:63], v[44:47], v[128:143]
    v_mfma_f32_32x32x16_bf16 v[144:159], v[60:63], v[48:51], v[144:159]
    s_waitcnt lgkmcnt(0)
    v_mfma_f32_32x32x16_bf16 v[64:79], v[32:35], v[24:27], v[64:79]
    ds_read_b128 v[44:47], v8 offset:0
    ds_read_b128 v[48:51], v8 offset:2048
    v_mfma_f32_32x32x16_bf16 v[80:95], v[32:35], v[28:31], v[80:95]
    ds_read_b64_tr_b16 v[52:53], v9 offset:6144
    ds_read_b64_tr_b16 v[54:55], v9 offset:7680
    v_mfma_f32_32x32x16_bf16 v[96:111], v[36:39], v[24:27], v[96:111]
    ds_read_b64_tr_b16 v[56:57], v10 offset:6144
    ds_read_b64_tr_b16 v[58:59], v10 offset:7680
    v_mfma_f32_32x32x16_bf16 v[112:127], v[36:39], v[28:31], v[112:127]
    ds_read_b64_tr_b16 v[60:61], v11 offset:6144
    ds_read_b64_tr_b16 v[62:63], v11 offset:7680
    v_mfma_f32_32x32x16_bf16 v[128:143], v[40:43], v[24:27], v[128:143]
    v_mfma_f32_32x32x16_bf16 v[144:159], v[40:43], v[28:31], v[144:159]
    s_waitcnt lgkmcnt(0)
    s_waitcnt vmcnt(0)
    s_barrier
    v_mfma_f32_32x32x16_bf16 v[64:79], v[52:55], v[44:47], v[64:79]
    ds_read_b128 v[24:27], v7 offset:20480
    ds_read_b128 v[28:31], v7 offset:22528
    v_mfma_f32_32x32x16_bf16 v[80:95], v[52:55], v[48:51], v[80:95]
    ds_read_b64_tr_b16 v[32:33], v9 offset:20480
    ds_read_b64_tr_b16 v[34:35], v9 offset:22016
    v_mfma_f32_32x32x16_bf16 v[96:111], v[56:59], v[44:47], v[96:111]
    ds_read_b64_tr_b16 v[36:37], v10 offset:20480
    ds_read_b64_tr_b16 v[38:39], v10 offset:22016
    v_mfma_f32_32x32x16_bf16 v[112:127], v[56:59], v[48:51], v[112:127]
    ds_read_b64_tr_b16 v[40:41], v11 offset:20480
    ds_read_b64_tr_b16 v[42:43], v11 offset:22016
    v_mfma_f32_32x32x16_bf16 v[128:143], v[60:63], v[44:47], v[128:143]
    v_mfma_f32_32x32x16_bf16 v[144:159], v[60:63], v[48:51], v[144:159]
    s_waitcnt lgkmcnt(0)
    v_mfma_f32_32x32x16_bf16 v[64:79], v[32:35], v[24:27], v[64:79]
    ds_read_b128 v[44:47], v8 offset:20480
    ds_read_b128 v[48:51], v8 offset:22528
    v_mfma_f32_32x32x16_bf16 v[80:95], v[32:35], v[28:31], v[80:95]
    ds_read_b64_tr_b16 v[52:53], v9 offset:26624
    ds_read_b64_tr_b16 v[54:55], v9 offset:28160
    v_mfma_f32_32x32x16_bf16 v[96:111], v[36:39], v[24:27], v[96:111]
    ds_read_b64_tr_b16 v[56:57], v10 offset:26624
    ds_read_b64_tr_b16 v[58:59], v10 offset:28160
    v_mfma_f32_32x32x16_bf16 v[112:127], v[36:39], v[28:31], v[112:127]
    ds_read_b64_tr_b16 v[60:61], v11 offset:26624
    ds_read_b64_tr_b16 v[62:63], v11 offset:28160
    v_mfma_f32_32x32x16_bf16 v[128:143], v[40:43], v[24:27], v[128:143]
    v_mfma_f32_32x32x16_bf16 v[144:159], v[40:43], v[28:31], v[144:159]
    s_waitcnt lgkmcnt(0)
    v_mfma_f32_32x32x16_bf16 v[64:79], v[52:55], v[44:47], v[64:79]
    v_mfma_f32_32x32x16_bf16 v[80:95], v[52:55], v[48:51], v[80:95]
    v_mfma_f32_32x32x16_bf16 v[96:111], v[56:59], v[44:47], v[96:111]
    v_mfma_f32_32x32x16_bf16 v[112:127], v[56:59], v[48:51], v[112:127]
    v_mfma_f32_32x32x16_bf16 v[128:143], v[60:63], v[44:47], v[128:143]
    v_mfma_f32_32x32x16_bf16 v[144:159], v[60:63], v[48:51], v[144:159]
    s_nop 15
    s_add_u32 s24, s8, 10485760
    s_addc_u32 s25, s9, 0
    s_mov_b32 s26, 18874368
    s_mov_b32 s27, 0x00020000
    s_mov_b32 s28, s10
    s_mov_b32 s29, s11
    s_mov_b32 s30, 9216
    s_mov_b32 s31, 0x00020000
    s_barrier
    v_lshrrev_b32 v18, 6, v0
    v_lshrrev_b32 v19, 1, v18
    v_mul_u32_u24 v19, 64, v19
    v_and_b32 v20, 31, v0
    v_add_u32 v19, v19, v20
    v_mul_u32_u24 v19, 400, v19
    v_and_b32 v18, 1, v18
    v_mul_u32_u24 v18, 96, v18
    v_bfe_u32 v20, v0, 5, 1
    v_lshl_add_u32 v18, v20, 2, v18
    v_mul_u32_u24 v18, 2, v18
    v_add_u32 v1, v18, v19
    v_lshrrev_b32 v18, 6, v0
    v_lshrrev_b32 v19, 1, v18
    v_mul_u32_u24 v19, 64, v19
    v_and_b32 v20, 31, v0
    v_add_u32 v19, v19, v20
    v_add_u32 v19, s40, v19
    s_mov_b32 s42, 9216
    v_mul_lo_u32 v17, v19, s42
    v_and_b32 v18, 1, v18
    v_mul_u32_u24 v18, 96, v18
    v_bfe_u32 v20, v0, 5, 1
    v_lshl_add_u32 v18, v20, 2, v18
    v_add_u32 v18, s41, v18
    v_lshl_add_u32 v17, v18, 1, v17
    v_mov_b32 v48, 0xc0135761
    v_mov_b32 v49, 0xc0135761
    v_mov_b32 v50, 0xbdd2d3e8
    v_mov_b32 v51, 0xbdd2d3e8
    v_mov_b32 v52, 1.0
    v_mov_b32 v53, 1.0
    v_lshlrev_b32 v18, 1, v18
    buffer_load_dwordx2 v[24:25], v18, s[28:31], 0 offen offset:0
    buffer_load_dwordx2 v[26:27], v18, s[28:31], 0 offen offset:16
    buffer_load_dwordx2 v[28:29], v18, s[28:31], 0 offen offset:32
    buffer_load_dwordx2 v[30:31], v18, s[28:31], 0 offen offset:48
    buffer_load_dwordx2 v[32:33], v18, s[28:31], 0 offen offset:64
    buffer_load_dwordx2 v[34:35], v18, s[28:31], 0 offen offset:80
    buffer_load_dwordx2 v[36:37], v18, s[28:31], 0 offen offset:96
    buffer_load_dwordx2 v[38:39], v18, s[28:31], 0 offen offset:112
    buffer_load_dwordx2 v[40:41], v18, s[28:31], 0 offen offset:128
    buffer_load_dwordx2 v[42:43], v18, s[28:31], 0 offen offset:144
    buffer_load_dwordx2 v[44:45], v18, s[28:31], 0 offen offset:160
    buffer_load_dwordx2 v[46:47], v18, s[28:31], 0 offen offset:176
    s_waitcnt vmcnt(0)
    v_lshlrev_b32 v54, 16, v24
    v_and_b32 v55, 0xffff0000, v24
    v_lshlrev_b32 v56, 16, v25
    v_and_b32 v57, 0xffff0000, v25
    v_pk_add_f32 v[64:65], v[64:65], v[54:55]
    v_pk_add_f32 v[66:67], v[66:67], v[56:57]
    v_pk_mul_f32 v[58:59], v[64:65], v[64:65]
    v_pk_mul_f32 v[60:61], v[66:67], v[66:67]
    v_pk_fma_f32 v[58:59], v[58:59], v[50:51], v[48:49]
    v_pk_fma_f32 v[60:61], v[60:61], v[50:51], v[48:49]
    v_pk_mul_f32 v[58:59], v[58:59], v[64:65]
    v_pk_mul_f32 v[60:61], v[60:61], v[66:67]
    v_exp_f32 v58, v58
    v_exp_f32 v59, v59
    v_exp_f32 v60, v60
    v_exp_f32 v61, v61
    v_pk_add_f32 v[58:59], v[58:59], v[52:53]
    v_pk_add_f32 v[60:61], v[60:61], v[52:53]
    v_rcp_f32 v58, v58
    v_rcp_f32 v59, v59
    v_rcp_f32 v60, v60
    v_rcp_f32 v61, v61
    v_pk_mul_f32 v[64:65], v[64:65], v[58:59]
    v_pk_mul_f32 v[66:67], v[66:67], v[60:61]
    v_cvt_pk_bf16_f32 v64, v64, v65
    v_cvt_pk_bf16_f32 v65, v66, v67
    ds_write_b64 v1, v[64:65] offset:0
    v_pk_add_f32 v[80:81], v[80:81], v[54:55]
    v_pk_add_f32 v[82:83], v[82:83], v[56:57]
    v_pk_mul_f32 v[58:59], v[80:81], v[80:81]
    v_pk_mul_f32 v[60:61], v[82:83], v[82:83]
    v_pk_fma_f32 v[58:59], v[58:59], v[50:51], v[48:49]
    v_pk_fma_f32 v[60:61], v[60:61], v[50:51], v[48:49]
    v_pk_mul_f32 v[58:59], v[58:59], v[80:81]
    v_pk_mul_f32 v[60:61], v[60:61], v[82:83]
    v_exp_f32 v58, v58
    v_exp_f32 v59, v59
    v_exp_f32 v60, v60
    v_exp_f32 v61, v61
    v_pk_add_f32 v[58:59], v[58:59], v[52:53]
    v_pk_add_f32 v[60:61], v[60:61], v[52:53]
    v_rcp_f32 v58, v58
    v_rcp_f32 v59, v59
    v_rcp_f32 v60, v60
    v_rcp_f32 v61, v61
    v_pk_mul_f32 v[80:81], v[80:81], v[58:59]
    v_pk_mul_f32 v[82:83], v[82:83], v[60:61]
    v_cvt_pk_bf16_f32 v80, v80, v81
    v_cvt_pk_bf16_f32 v81, v82, v83
    ds_write_b64 v1, v[80:81] offset:12800
    v_lshlrev_b32 v54, 16, v26
    v_and_b32 v55, 0xffff0000, v26
    v_lshlrev_b32 v56, 16, v27
    v_and_b32 v57, 0xffff0000, v27
    v_pk_add_f32 v[68:69], v[68:69], v[54:55]
    v_pk_add_f32 v[70:71], v[70:71], v[56:57]
    v_pk_mul_f32 v[58:59], v[68:69], v[68:69]
    v_pk_mul_f32 v[60:61], v[70:71], v[70:71]
    v_pk_fma_f32 v[58:59], v[58:59], v[50:51], v[48:49]
    v_pk_fma_f32 v[60:61], v[60:61], v[50:51], v[48:49]
    v_pk_mul_f32 v[58:59], v[58:59], v[68:69]
    v_pk_mul_f32 v[60:61], v[60:61], v[70:71]
    v_exp_f32 v58, v58
    v_exp_f32 v59, v59
    v_exp_f32 v60, v60
    v_exp_f32 v61, v61
    v_pk_add_f32 v[58:59], v[58:59], v[52:53]
    v_pk_add_f32 v[60:61], v[60:61], v[52:53]
    v_rcp_f32 v58, v58
    v_rcp_f32 v59, v59
    v_rcp_f32 v60, v60
    v_rcp_f32 v61, v61
    v_pk_mul_f32 v[68:69], v[68:69], v[58:59]
    v_pk_mul_f32 v[70:71], v[70:71], v[60:61]
    v_cvt_pk_bf16_f32 v68, v68, v69
    v_cvt_pk_bf16_f32 v69, v70, v71
    ds_write_b64 v1, v[68:69] offset:16
    v_pk_add_f32 v[84:85], v[84:85], v[54:55]
    v_pk_add_f32 v[86:87], v[86:87], v[56:57]
    v_pk_mul_f32 v[58:59], v[84:85], v[84:85]
    v_pk_mul_f32 v[60:61], v[86:87], v[86:87]
    v_pk_fma_f32 v[58:59], v[58:59], v[50:51], v[48:49]
    v_pk_fma_f32 v[60:61], v[60:61], v[50:51], v[48:49]
    v_pk_mul_f32 v[58:59], v[58:59], v[84:85]
    v_pk_mul_f32 v[60:61], v[60:61], v[86:87]
    v_exp_f32 v58, v58
    v_exp_f32 v59, v59
    v_exp_f32 v60, v60
    v_exp_f32 v61, v61
    v_pk_add_f32 v[58:59], v[58:59], v[52:53]
    v_pk_add_f32 v[60:61], v[60:61], v[52:53]
    v_rcp_f32 v58, v58
    v_rcp_f32 v59, v59
    v_rcp_f32 v60, v60
    v_rcp_f32 v61, v61
    v_pk_mul_f32 v[84:85], v[84:85], v[58:59]
    v_pk_mul_f32 v[86:87], v[86:87], v[60:61]
    v_cvt_pk_bf16_f32 v84, v84, v85
    v_cvt_pk_bf16_f32 v85, v86, v87
    ds_write_b64 v1, v[84:85] offset:12816
    v_lshlrev_b32 v54, 16, v28
    v_and_b32 v55, 0xffff0000, v28
    v_lshlrev_b32 v56, 16, v29
    v_and_b32 v57, 0xffff0000, v29
    v_pk_add_f32 v[72:73], v[72:73], v[54:55]
    v_pk_add_f32 v[74:75], v[74:75], v[56:57]
    v_pk_mul_f32 v[58:59], v[72:73], v[72:73]
    v_pk_mul_f32 v[60:61], v[74:75], v[74:75]
    v_pk_fma_f32 v[58:59], v[58:59], v[50:51], v[48:49]
    v_pk_fma_f32 v[60:61], v[60:61], v[50:51], v[48:49]
    v_pk_mul_f32 v[58:59], v[58:59], v[72:73]
    v_pk_mul_f32 v[60:61], v[60:61], v[74:75]
    v_exp_f32 v58, v58
    v_exp_f32 v59, v59
    v_exp_f32 v60, v60
    v_exp_f32 v61, v61
    v_pk_add_f32 v[58:59], v[58:59], v[52:53]
    v_pk_add_f32 v[60:61], v[60:61], v[52:53]
    v_rcp_f32 v58, v58
    v_rcp_f32 v59, v59
    v_rcp_f32 v60, v60
    v_rcp_f32 v61, v61
    v_pk_mul_f32 v[72:73], v[72:73], v[58:59]
    v_pk_mul_f32 v[74:75], v[74:75], v[60:61]
    v_cvt_pk_bf16_f32 v72, v72, v73
    v_cvt_pk_bf16_f32 v73, v74, v75
    ds_write_b64 v1, v[72:73] offset:32
    v_pk_add_f32 v[88:89], v[88:89], v[54:55]
    v_pk_add_f32 v[90:91], v[90:91], v[56:57]
    v_pk_mul_f32 v[58:59], v[88:89], v[88:89]
    v_pk_mul_f32 v[60:61], v[90:91], v[90:91]
    v_pk_fma_f32 v[58:59], v[58:59], v[50:51], v[48:49]
    v_pk_fma_f32 v[60:61], v[60:61], v[50:51], v[48:49]
    v_pk_mul_f32 v[58:59], v[58:59], v[88:89]
    v_pk_mul_f32 v[60:61], v[60:61], v[90:91]
    v_exp_f32 v58, v58
    v_exp_f32 v59, v59
    v_exp_f32 v60, v60
    v_exp_f32 v61, v61
    v_pk_add_f32 v[58:59], v[58:59], v[52:53]
    v_pk_add_f32 v[60:61], v[60:61], v[52:53]
    v_rcp_f32 v58, v58
    v_rcp_f32 v59, v59
    v_rcp_f32 v60, v60
    v_rcp_f32 v61, v61
    v_pk_mul_f32 v[88:89], v[88:89], v[58:59]
    v_pk_mul_f32 v[90:91], v[90:91], v[60:61]
    v_cvt_pk_bf16_f32 v88, v88, v89
    v_cvt_pk_bf16_f32 v89, v90, v91
    ds_write_b64 v1, v[88:89] offset:12832
    v_lshlrev_b32 v54, 16, v30
    v_and_b32 v55, 0xffff0000, v30
    v_lshlrev_b32 v56, 16, v31
    v_and_b32 v57, 0xffff0000, v31
    v_pk_add_f32 v[76:77], v[76:77], v[54:55]
    v_pk_add_f32 v[78:79], v[78:79], v[56:57]
    v_pk_mul_f32 v[58:59], v[76:77], v[76:77]
    v_pk_mul_f32 v[60:61], v[78:79], v[78:79]
    v_pk_fma_f32 v[58:59], v[58:59], v[50:51], v[48:49]
    v_pk_fma_f32 v[60:61], v[60:61], v[50:51], v[48:49]
    v_pk_mul_f32 v[58:59], v[58:59], v[76:77]
    v_pk_mul_f32 v[60:61], v[60:61], v[78:79]
    v_exp_f32 v58, v58
    v_exp_f32 v59, v59
    v_exp_f32 v60, v60
    v_exp_f32 v61, v61
    v_pk_add_f32 v[58:59], v[58:59], v[52:53]
    v_pk_add_f32 v[60:61], v[60:61], v[52:53]
    v_rcp_f32 v58, v58
    v_rcp_f32 v59, v59
    v_rcp_f32 v60, v60
    v_rcp_f32 v61, v61
    v_pk_mul_f32 v[76:77], v[76:77], v[58:59]
    v_pk_mul_f32 v[78:79], v[78:79], v[60:61]
    v_cvt_pk_bf16_f32 v76, v76, v77
    v_cvt_pk_bf16_f32 v77, v78, v79
    ds_write_b64 v1, v[76:77] offset:48
    v_pk_add_f32 v[92:93], v[92:93], v[54:55]
    v_pk_add_f32 v[94:95], v[94:95], v[56:57]
    v_pk_mul_f32 v[58:59], v[92:93], v[92:93]
    v_pk_mul_f32 v[60:61], v[94:95], v[94:95]
    v_pk_fma_f32 v[58:59], v[58:59], v[50:51], v[48:49]
    v_pk_fma_f32 v[60:61], v[60:61], v[50:51], v[48:49]
    v_pk_mul_f32 v[58:59], v[58:59], v[92:93]
    v_pk_mul_f32 v[60:61], v[60:61], v[94:95]
    v_exp_f32 v58, v58
    v_exp_f32 v59, v59
    v_exp_f32 v60, v60
    v_exp_f32 v61, v61
    v_pk_add_f32 v[58:59], v[58:59], v[52:53]
    v_pk_add_f32 v[60:61], v[60:61], v[52:53]
    v_rcp_f32 v58, v58
    v_rcp_f32 v59, v59
    v_rcp_f32 v60, v60
    v_rcp_f32 v61, v61
    v_pk_mul_f32 v[92:93], v[92:93], v[58:59]
    v_pk_mul_f32 v[94:95], v[94:95], v[60:61]
    v_cvt_pk_bf16_f32 v92, v92, v93
    v_cvt_pk_bf16_f32 v93, v94, v95
    ds_write_b64 v1, v[92:93] offset:12848
    v_lshlrev_b32 v54, 16, v32
    v_and_b32 v55, 0xffff0000, v32
    v_lshlrev_b32 v56, 16, v33
    v_and_b32 v57, 0xffff0000, v33
    v_pk_add_f32 v[96:97], v[96:97], v[54:55]
    v_pk_add_f32 v[98:99], v[98:99], v[56:57]
    v_pk_mul_f32 v[58:59], v[96:97], v[96:97]
    v_pk_mul_f32 v[60:61], v[98:99], v[98:99]
    v_pk_fma_f32 v[58:59], v[58:59], v[50:51], v[48:49]
    v_pk_fma_f32 v[60:61], v[60:61], v[50:51], v[48:49]
    v_pk_mul_f32 v[58:59], v[58:59], v[96:97]
    v_pk_mul_f32 v[60:61], v[60:61], v[98:99]
    v_exp_f32 v58, v58
    v_exp_f32 v59, v59
    v_exp_f32 v60, v60
    v_exp_f32 v61, v61
    v_pk_add_f32 v[58:59], v[58:59], v[52:53]
    v_pk_add_f32 v[60:61], v[60:61], v[52:53]
    v_rcp_f32 v58, v58
    v_rcp_f32 v59, v59
    v_rcp_f32 v60, v60
    v_rcp_f32 v61, v61
    v_pk_mul_f32 v[96:97], v[96:97], v[58:59]
    v_pk_mul_f32 v[98:99], v[98:99], v[60:61]
    v_cvt_pk_bf16_f32 v96, v96, v97
    v_cvt_pk_bf16_f32 v97, v98, v99
    ds_write_b64 v1, v[96:97] offset:64
    v_pk_add_f32 v[112:113], v[112:113], v[54:55]
    v_pk_add_f32 v[114:115], v[114:115], v[56:57]
    v_pk_mul_f32 v[58:59], v[112:113], v[112:113]
    v_pk_mul_f32 v[60:61], v[114:115], v[114:115]
    v_pk_fma_f32 v[58:59], v[58:59], v[50:51], v[48:49]
    v_pk_fma_f32 v[60:61], v[60:61], v[50:51], v[48:49]
    v_pk_mul_f32 v[58:59], v[58:59], v[112:113]
    v_pk_mul_f32 v[60:61], v[60:61], v[114:115]
    v_exp_f32 v58, v58
    v_exp_f32 v59, v59
    v_exp_f32 v60, v60
    v_exp_f32 v61, v61
    v_pk_add_f32 v[58:59], v[58:59], v[52:53]
    v_pk_add_f32 v[60:61], v[60:61], v[52:53]
    v_rcp_f32 v58, v58
    v_rcp_f32 v59, v59
    v_rcp_f32 v60, v60
    v_rcp_f32 v61, v61
    v_pk_mul_f32 v[112:113], v[112:113], v[58:59]
    v_pk_mul_f32 v[114:115], v[114:115], v[60:61]
    v_cvt_pk_bf16_f32 v112, v112, v113
    v_cvt_pk_bf16_f32 v113, v114, v115
    ds_write_b64 v1, v[112:113] offset:12864
    v_lshlrev_b32 v54, 16, v34
    v_and_b32 v55, 0xffff0000, v34
    v_lshlrev_b32 v56, 16, v35
    v_and_b32 v57, 0xffff0000, v35
    v_pk_add_f32 v[100:101], v[100:101], v[54:55]
    v_pk_add_f32 v[102:103], v[102:103], v[56:57]
    v_pk_mul_f32 v[58:59], v[100:101], v[100:101]
    v_pk_mul_f32 v[60:61], v[102:103], v[102:103]
    v_pk_fma_f32 v[58:59], v[58:59], v[50:51], v[48:49]
    v_pk_fma_f32 v[60:61], v[60:61], v[50:51], v[48:49]
    v_pk_mul_f32 v[58:59], v[58:59], v[100:101]
    v_pk_mul_f32 v[60:61], v[60:61], v[102:103]
    v_exp_f32 v58, v58
    v_exp_f32 v59, v59
    v_exp_f32 v60, v60
    v_exp_f32 v61, v61
    v_pk_add_f32 v[58:59], v[58:59], v[52:53]
    v_pk_add_f32 v[60:61], v[60:61], v[52:53]
    v_rcp_f32 v58, v58
    v_rcp_f32 v59, v59
    v_rcp_f32 v60, v60
    v_rcp_f32 v61, v61
    v_pk_mul_f32 v[100:101], v[100:101], v[58:59]
    v_pk_mul_f32 v[102:103], v[102:103], v[60:61]
    v_cvt_pk_bf16_f32 v100, v100, v101
    v_cvt_pk_bf16_f32 v101, v102, v103
    ds_write_b64 v1, v[100:101] offset:80
    v_pk_add_f32 v[116:117], v[116:117], v[54:55]
    v_pk_add_f32 v[118:119], v[118:119], v[56:57]
    v_pk_mul_f32 v[58:59], v[116:117], v[116:117]
    v_pk_mul_f32 v[60:61], v[118:119], v[118:119]
    v_pk_fma_f32 v[58:59], v[58:59], v[50:51], v[48:49]
    v_pk_fma_f32 v[60:61], v[60:61], v[50:51], v[48:49]
    v_pk_mul_f32 v[58:59], v[58:59], v[116:117]
    v_pk_mul_f32 v[60:61], v[60:61], v[118:119]
    v_exp_f32 v58, v58
    v_exp_f32 v59, v59
    v_exp_f32 v60, v60
    v_exp_f32 v61, v61
    v_pk_add_f32 v[58:59], v[58:59], v[52:53]
    v_pk_add_f32 v[60:61], v[60:61], v[52:53]
    v_rcp_f32 v58, v58
    v_rcp_f32 v59, v59
    v_rcp_f32 v60, v60
    v_rcp_f32 v61, v61
    v_pk_mul_f32 v[116:117], v[116:117], v[58:59]
    v_pk_mul_f32 v[118:119], v[118:119], v[60:61]
    v_cvt_pk_bf16_f32 v116, v116, v117
    v_cvt_pk_bf16_f32 v117, v118, v119
    ds_write_b64 v1, v[116:117] offset:12880
    v_lshlrev_b32 v54, 16, v36
    v_and_b32 v55, 0xffff0000, v36
    v_lshlrev_b32 v56, 16, v37
    v_and_b32 v57, 0xffff0000, v37
    v_pk_add_f32 v[104:105], v[104:105], v[54:55]
    v_pk_add_f32 v[106:107], v[106:107], v[56:57]
    v_pk_mul_f32 v[58:59], v[104:105], v[104:105]
    v_pk_mul_f32 v[60:61], v[106:107], v[106:107]
    v_pk_fma_f32 v[58:59], v[58:59], v[50:51], v[48:49]
    v_pk_fma_f32 v[60:61], v[60:61], v[50:51], v[48:49]
    v_pk_mul_f32 v[58:59], v[58:59], v[104:105]
    v_pk_mul_f32 v[60:61], v[60:61], v[106:107]
    v_exp_f32 v58, v58
    v_exp_f32 v59, v59
    v_exp_f32 v60, v60
    v_exp_f32 v61, v61
    v_pk_add_f32 v[58:59], v[58:59], v[52:53]
    v_pk_add_f32 v[60:61], v[60:61], v[52:53]
    v_rcp_f32 v58, v58
    v_rcp_f32 v59, v59
    v_rcp_f32 v60, v60
    v_rcp_f32 v61, v61
    v_pk_mul_f32 v[104:105], v[104:105], v[58:59]
    v_pk_mul_f32 v[106:107], v[106:107], v[60:61]
    v_cvt_pk_bf16_f32 v104, v104, v105
    v_cvt_pk_bf16_f32 v105, v106, v107
    ds_write_b64 v1, v[104:105] offset:96
    v_pk_add_f32 v[120:121], v[120:121], v[54:55]
    v_pk_add_f32 v[122:123], v[122:123], v[56:57]
    v_pk_mul_f32 v[58:59], v[120:121], v[120:121]
    v_pk_mul_f32 v[60:61], v[122:123], v[122:123]
    v_pk_fma_f32 v[58:59], v[58:59], v[50:51], v[48:49]
    v_pk_fma_f32 v[60:61], v[60:61], v[50:51], v[48:49]
    v_pk_mul_f32 v[58:59], v[58:59], v[120:121]
    v_pk_mul_f32 v[60:61], v[60:61], v[122:123]
    v_exp_f32 v58, v58
    v_exp_f32 v59, v59
    v_exp_f32 v60, v60
    v_exp_f32 v61, v61
    v_pk_add_f32 v[58:59], v[58:59], v[52:53]
    v_pk_add_f32 v[60:61], v[60:61], v[52:53]
    v_rcp_f32 v58, v58
    v_rcp_f32 v59, v59
    v_rcp_f32 v60, v60
    v_rcp_f32 v61, v61
    v_pk_mul_f32 v[120:121], v[120:121], v[58:59]
    v_pk_mul_f32 v[122:123], v[122:123], v[60:61]
    v_cvt_pk_bf16_f32 v120, v120, v121
    v_cvt_pk_bf16_f32 v121, v122, v123
    ds_write_b64 v1, v[120:121] offset:12896
    v_lshlrev_b32 v54, 16, v38
    v_and_b32 v55, 0xffff0000, v38
    v_lshlrev_b32 v56, 16, v39
    v_and_b32 v57, 0xffff0000, v39
    v_pk_add_f32 v[108:109], v[108:109], v[54:55]
    v_pk_add_f32 v[110:111], v[110:111], v[56:57]
    v_pk_mul_f32 v[58:59], v[108:109], v[108:109]
    v_pk_mul_f32 v[60:61], v[110:111], v[110:111]
    v_pk_fma_f32 v[58:59], v[58:59], v[50:51], v[48:49]
    v_pk_fma_f32 v[60:61], v[60:61], v[50:51], v[48:49]
    v_pk_mul_f32 v[58:59], v[58:59], v[108:109]
    v_pk_mul_f32 v[60:61], v[60:61], v[110:111]
    v_exp_f32 v58, v58
    v_exp_f32 v59, v59
    v_exp_f32 v60, v60
    v_exp_f32 v61, v61
    v_pk_add_f32 v[58:59], v[58:59], v[52:53]
    v_pk_add_f32 v[60:61], v[60:61], v[52:53]
    v_rcp_f32 v58, v58
    v_rcp_f32 v59, v59
    v_rcp_f32 v60, v60
    v_rcp_f32 v61, v61
    v_pk_mul_f32 v[108:109], v[108:109], v[58:59]
    v_pk_mul_f32 v[110:111], v[110:111], v[60:61]
    v_cvt_pk_bf16_f32 v108, v108, v109
    v_cvt_pk_bf16_f32 v109, v110, v111
    ds_write_b64 v1, v[108:109] offset:112
    v_pk_add_f32 v[124:125], v[124:125], v[54:55]
    v_pk_add_f32 v[126:127], v[126:127], v[56:57]
    v_pk_mul_f32 v[58:59], v[124:125], v[124:125]
    v_pk_mul_f32 v[60:61], v[126:127], v[126:127]
    v_pk_fma_f32 v[58:59], v[58:59], v[50:51], v[48:49]
    v_pk_fma_f32 v[60:61], v[60:61], v[50:51], v[48:49]
    v_pk_mul_f32 v[58:59], v[58:59], v[124:125]
    v_pk_mul_f32 v[60:61], v[60:61], v[126:127]
    v_exp_f32 v58, v58
    v_exp_f32 v59, v59
    v_exp_f32 v60, v60
    v_exp_f32 v61, v61
    v_pk_add_f32 v[58:59], v[58:59], v[52:53]
    v_pk_add_f32 v[60:61], v[60:61], v[52:53]
    v_rcp_f32 v58, v58
    v_rcp_f32 v59, v59
    v_rcp_f32 v60, v60
    v_rcp_f32 v61, v61
    v_pk_mul_f32 v[124:125], v[124:125], v[58:59]
    v_pk_mul_f32 v[126:127], v[126:127], v[60:61]
    v_cvt_pk_bf16_f32 v124, v124, v125
    v_cvt_pk_bf16_f32 v125, v126, v127
    ds_write_b64 v1, v[124:125] offset:12912
    v_lshlrev_b32 v54, 16, v40
    v_and_b32 v55, 0xffff0000, v40
    v_lshlrev_b32 v56, 16, v41
    v_and_b32 v57, 0xffff0000, v41
    v_pk_add_f32 v[128:129], v[128:129], v[54:55]
    v_pk_add_f32 v[130:131], v[130:131], v[56:57]
    v_pk_mul_f32 v[58:59], v[128:129], v[128:129]
    v_pk_mul_f32 v[60:61], v[130:131], v[130:131]
    v_pk_fma_f32 v[58:59], v[58:59], v[50:51], v[48:49]
    v_pk_fma_f32 v[60:61], v[60:61], v[50:51], v[48:49]
    v_pk_mul_f32 v[58:59], v[58:59], v[128:129]
    v_pk_mul_f32 v[60:61], v[60:61], v[130:131]
    v_exp_f32 v58, v58
    v_exp_f32 v59, v59
    v_exp_f32 v60, v60
    v_exp_f32 v61, v61
    v_pk_add_f32 v[58:59], v[58:59], v[52:53]
    v_pk_add_f32 v[60:61], v[60:61], v[52:53]
    v_rcp_f32 v58, v58
    v_rcp_f32 v59, v59
    v_rcp_f32 v60, v60
    v_rcp_f32 v61, v61
    v_pk_mul_f32 v[128:129], v[128:129], v[58:59]
    v_pk_mul_f32 v[130:131], v[130:131], v[60:61]
    v_cvt_pk_bf16_f32 v128, v128, v129
    v_cvt_pk_bf16_f32 v129, v130, v131
    ds_write_b64 v1, v[128:129] offset:128
    v_pk_add_f32 v[144:145], v[144:145], v[54:55]
    v_pk_add_f32 v[146:147], v[146:147], v[56:57]
    v_pk_mul_f32 v[58:59], v[144:145], v[144:145]
    v_pk_mul_f32 v[60:61], v[146:147], v[146:147]
    v_pk_fma_f32 v[58:59], v[58:59], v[50:51], v[48:49]
    v_pk_fma_f32 v[60:61], v[60:61], v[50:51], v[48:49]
    v_pk_mul_f32 v[58:59], v[58:59], v[144:145]
    v_pk_mul_f32 v[60:61], v[60:61], v[146:147]
    v_exp_f32 v58, v58
    v_exp_f32 v59, v59
    v_exp_f32 v60, v60
    v_exp_f32 v61, v61
    v_pk_add_f32 v[58:59], v[58:59], v[52:53]
    v_pk_add_f32 v[60:61], v[60:61], v[52:53]
    v_rcp_f32 v58, v58
    v_rcp_f32 v59, v59
    v_rcp_f32 v60, v60
    v_rcp_f32 v61, v61
    v_pk_mul_f32 v[144:145], v[144:145], v[58:59]
    v_pk_mul_f32 v[146:147], v[146:147], v[60:61]
    v_cvt_pk_bf16_f32 v144, v144, v145
    v_cvt_pk_bf16_f32 v145, v146, v147
    ds_write_b64 v1, v[144:145] offset:12928
    v_lshlrev_b32 v54, 16, v42
    v_and_b32 v55, 0xffff0000, v42
    v_lshlrev_b32 v56, 16, v43
    v_and_b32 v57, 0xffff0000, v43
    v_pk_add_f32 v[132:133], v[132:133], v[54:55]
    v_pk_add_f32 v[134:135], v[134:135], v[56:57]
    v_pk_mul_f32 v[58:59], v[132:133], v[132:133]
    v_pk_mul_f32 v[60:61], v[134:135], v[134:135]
    v_pk_fma_f32 v[58:59], v[58:59], v[50:51], v[48:49]
    v_pk_fma_f32 v[60:61], v[60:61], v[50:51], v[48:49]
    v_pk_mul_f32 v[58:59], v[58:59], v[132:133]
    v_pk_mul_f32 v[60:61], v[60:61], v[134:135]
    v_exp_f32 v58, v58
    v_exp_f32 v59, v59
    v_exp_f32 v60, v60
    v_exp_f32 v61, v61
    v_pk_add_f32 v[58:59], v[58:59], v[52:53]
    v_pk_add_f32 v[60:61], v[60:61], v[52:53]
    v_rcp_f32 v58, v58
    v_rcp_f32 v59, v59
    v_rcp_f32 v60, v60
    v_rcp_f32 v61, v61
    v_pk_mul_f32 v[132:133], v[132:133], v[58:59]
    v_pk_mul_f32 v[134:135], v[134:135], v[60:61]
    v_cvt_pk_bf16_f32 v132, v132, v133
    v_cvt_pk_bf16_f32 v133, v134, v135
    ds_write_b64 v1, v[132:133] offset:144
    v_pk_add_f32 v[148:149], v[148:149], v[54:55]
    v_pk_add_f32 v[150:151], v[150:151], v[56:57]
    v_pk_mul_f32 v[58:59], v[148:149], v[148:149]
    v_pk_mul_f32 v[60:61], v[150:151], v[150:151]
    v_pk_fma_f32 v[58:59], v[58:59], v[50:51], v[48:49]
    v_pk_fma_f32 v[60:61], v[60:61], v[50:51], v[48:49]
    v_pk_mul_f32 v[58:59], v[58:59], v[148:149]
    v_pk_mul_f32 v[60:61], v[60:61], v[150:151]
    v_exp_f32 v58, v58
    v_exp_f32 v59, v59
    v_exp_f32 v60, v60
    v_exp_f32 v61, v61
    v_pk_add_f32 v[58:59], v[58:59], v[52:53]
    v_pk_add_f32 v[60:61], v[60:61], v[52:53]
    v_rcp_f32 v58, v58
    v_rcp_f32 v59, v59
    v_rcp_f32 v60, v60
    v_rcp_f32 v61, v61
    v_pk_mul_f32 v[148:149], v[148:149], v[58:59]
    v_pk_mul_f32 v[150:151], v[150:151], v[60:61]
    v_cvt_pk_bf16_f32 v148, v148, v149
    v_cvt_pk_bf16_f32 v149, v150, v151
    ds_write_b64 v1, v[148:149] offset:12944
    v_lshlrev_b32 v54, 16, v44
    v_and_b32 v55, 0xffff0000, v44
    v_lshlrev_b32 v56, 16, v45
    v_and_b32 v57, 0xffff0000, v45
    v_pk_add_f32 v[136:137], v[136:137], v[54:55]
    v_pk_add_f32 v[138:139], v[138:139], v[56:57]
    v_pk_mul_f32 v[58:59], v[136:137], v[136:137]
    v_pk_mul_f32 v[60:61], v[138:139], v[138:139]
    v_pk_fma_f32 v[58:59], v[58:59], v[50:51], v[48:49]
    v_pk_fma_f32 v[60:61], v[60:61], v[50:51], v[48:49]
    v_pk_mul_f32 v[58:59], v[58:59], v[136:137]
    v_pk_mul_f32 v[60:61], v[60:61], v[138:139]
    v_exp_f32 v58, v58
    v_exp_f32 v59, v59
    v_exp_f32 v60, v60
    v_exp_f32 v61, v61
    v_pk_add_f32 v[58:59], v[58:59], v[52:53]
    v_pk_add_f32 v[60:61], v[60:61], v[52:53]
    v_rcp_f32 v58, v58
    v_rcp_f32 v59, v59
    v_rcp_f32 v60, v60
    v_rcp_f32 v61, v61
    v_pk_mul_f32 v[136:137], v[136:137], v[58:59]
    v_pk_mul_f32 v[138:139], v[138:139], v[60:61]
    v_cvt_pk_bf16_f32 v136, v136, v137
    v_cvt_pk_bf16_f32 v137, v138, v139
    ds_write_b64 v1, v[136:137] offset:160
    v_pk_add_f32 v[152:153], v[152:153], v[54:55]
    v_pk_add_f32 v[154:155], v[154:155], v[56:57]
    v_pk_mul_f32 v[58:59], v[152:153], v[152:153]
    v_pk_mul_f32 v[60:61], v[154:155], v[154:155]
    v_pk_fma_f32 v[58:59], v[58:59], v[50:51], v[48:49]
    v_pk_fma_f32 v[60:61], v[60:61], v[50:51], v[48:49]
    v_pk_mul_f32 v[58:59], v[58:59], v[152:153]
    v_pk_mul_f32 v[60:61], v[60:61], v[154:155]
    v_exp_f32 v58, v58
    v_exp_f32 v59, v59
    v_exp_f32 v60, v60
    v_exp_f32 v61, v61
    v_pk_add_f32 v[58:59], v[58:59], v[52:53]
    v_pk_add_f32 v[60:61], v[60:61], v[52:53]
    v_rcp_f32 v58, v58
    v_rcp_f32 v59, v59
    v_rcp_f32 v60, v60
    v_rcp_f32 v61, v61
    v_pk_mul_f32 v[152:153], v[152:153], v[58:59]
    v_pk_mul_f32 v[154:155], v[154:155], v[60:61]
    v_cvt_pk_bf16_f32 v152, v152, v153
    v_cvt_pk_bf16_f32 v153, v154, v155
    ds_write_b64 v1, v[152:153] offset:12960
    v_lshlrev_b32 v54, 16, v46
    v_and_b32 v55, 0xffff0000, v46
    v_lshlrev_b32 v56, 16, v47
    v_and_b32 v57, 0xffff0000, v47
    v_pk_add_f32 v[140:141], v[140:141], v[54:55]
    v_pk_add_f32 v[142:143], v[142:143], v[56:57]
    v_pk_mul_f32 v[58:59], v[140:141], v[140:141]
    v_pk_mul_f32 v[60:61], v[142:143], v[142:143]
    v_pk_fma_f32 v[58:59], v[58:59], v[50:51], v[48:49]
    v_pk_fma_f32 v[60:61], v[60:61], v[50:51], v[48:49]
    v_pk_mul_f32 v[58:59], v[58:59], v[140:141]
    v_pk_mul_f32 v[60:61], v[60:61], v[142:143]
    v_exp_f32 v58, v58
    v_exp_f32 v59, v59
    v_exp_f32 v60, v60
    v_exp_f32 v61, v61
    v_pk_add_f32 v[58:59], v[58:59], v[52:53]
    v_pk_add_f32 v[60:61], v[60:61], v[52:53]
    v_rcp_f32 v58, v58
    v_rcp_f32 v59, v59
    v_rcp_f32 v60, v60
    v_rcp_f32 v61, v61
    v_pk_mul_f32 v[140:141], v[140:141], v[58:59]
    v_pk_mul_f32 v[142:143], v[142:143], v[60:61]
    v_cvt_pk_bf16_f32 v140, v140, v141
    v_cvt_pk_bf16_f32 v141, v142, v143
    ds_write_b64 v1, v[140:141] offset:176
    v_pk_add_f32 v[156:157], v[156:157], v[54:55]
    v_pk_add_f32 v[158:159], v[158:159], v[56:57]
    v_pk_mul_f32 v[58:59], v[156:157], v[156:157]
    v_pk_mul_f32 v[60:61], v[158:159], v[158:159]
    v_pk_fma_f32 v[58:59], v[58:59], v[50:51], v[48:49]
    v_pk_fma_f32 v[60:61], v[60:61], v[50:51], v[48:49]
    v_pk_mul_f32 v[58:59], v[58:59], v[156:157]
    v_pk_mul_f32 v[60:61], v[60:61], v[158:159]
    v_exp_f32 v58, v58
    v_exp_f32 v59, v59
    v_exp_f32 v60, v60
    v_exp_f32 v61, v61
    v_pk_add_f32 v[58:59], v[58:59], v[52:53]
    v_pk_add_f32 v[60:61], v[60:61], v[52:53]
    v_rcp_f32 v58, v58
    v_rcp_f32 v59, v59
    v_rcp_f32 v60, v60
    v_rcp_f32 v61, v61
    v_pk_mul_f32 v[156:157], v[156:157], v[58:59]
    v_pk_mul_f32 v[158:159], v[158:159], v[60:61]
    v_cvt_pk_bf16_f32 v156, v156, v157
    v_cvt_pk_bf16_f32 v157, v158, v159
    ds_write_b64 v1, v[156:157] offset:12976
    s_waitcnt lgkmcnt(0)
    s_barrier
    s_mov_b32 s42, 178956971
    s_lshl_b32 s43, s41, 1
    v_add_u32 v17, 0, v0
    v_mul_hi_u32 v18, v17, s42
    v_mul_u32_u24 v19, 24, v18
    v_sub_u32 v19, v17, v19
    v_mul_u32_u24 v20, 400, v18
    v_lshl_add_u32 v20, v19, 4, v20
    ds_read_b128 v[24:27], v20
    v_add_u32 v18, s40, v18
    v_mul_u32_u24 v18, 9216, v18
    v_lshl_add_u32 v18, v19, 4, v18
    v_add_u32 v48, s43, v18
    v_add_u32 v17, 256, v0
    v_mul_hi_u32 v18, v17, s42
    v_mul_u32_u24 v19, 24, v18
    v_sub_u32 v19, v17, v19
    v_mul_u32_u24 v20, 400, v18
    v_lshl_add_u32 v20, v19, 4, v20
    ds_read_b128 v[28:31], v20
    v_add_u32 v18, s40, v18
    v_mul_u32_u24 v18, 9216, v18
    v_lshl_add_u32 v18, v19, 4, v18
    v_add_u32 v49, s43, v18
    v_add_u32 v17, 512, v0
    v_mul_hi_u32 v18, v17, s42
    v_mul_u32_u24 v19, 24, v18
    v_sub_u32 v19, v17, v19
    v_mul_u32_u24 v20, 400, v18
    v_lshl_add_u32 v20, v19, 4, v20
    ds_read_b128 v[32:35], v20
    v_add_u32 v18, s40, v18
    v_mul_u32_u24 v18, 9216, v18
    v_lshl_add_u32 v18, v19, 4, v18
    v_add_u32 v50, s43, v18
    v_add_u32 v17, 768, v0
    v_mul_hi_u32 v18, v17, s42
    v_mul_u32_u24 v19, 24, v18
    v_sub_u32 v19, v17, v19
    v_mul_u32_u24 v20, 400, v18
    v_lshl_add_u32 v20, v19, 4, v20
    ds_read_b128 v[36:39], v20
    v_add_u32 v18, s40, v18
    v_mul_u32_u24 v18, 9216, v18
    v_lshl_add_u32 v18, v19, 4, v18
    v_add_u32 v51, s43, v18
    v_add_u32 v17, 1024, v0
    v_mul_hi_u32 v18, v17, s42
    v_mul_u32_u24 v19, 24, v18
    v_sub_u32 v19, v17, v19
    v_mul_u32_u24 v20, 400, v18
    v_lshl_add_u32 v20, v19, 4, v20
    ds_read_b128 v[40:43], v20
    v_add_u32 v18, s40, v18
    v_mul_u32_u24 v18, 9216, v18
    v_lshl_add_u32 v18, v19, 4, v18
    v_add_u32 v52, s43, v18
    v_add_u32 v17, 1280, v0
    v_mul_hi_u32 v18, v17, s42
    v_mul_u32_u24 v19, 24, v18
    v_sub_u32 v19, v17, v19
    v_mul_u32_u24 v20, 400, v18
    v_lshl_add_u32 v20, v19, 4, v20
    ds_read_b128 v[44:47], v20
    v_add_u32 v18, s40, v18
    v_mul_u32_u24 v18, 9216, v18
    v_lshl_add_u32 v18, v19, 4, v18
    v_add_u32 v53, s43, v18
    s_waitcnt lgkmcnt(0)
    buffer_store_dwordx4 v[24:27], v48, s[24:27], 0 offen
    buffer_store_dwordx4 v[28:31], v49, s[24:27], 0 offen
    buffer_store_dwordx4 v[32:35], v50, s[24:27], 0 offen
    buffer_store_dwordx4 v[36:39], v51, s[24:27], 0 offen
    buffer_store_dwordx4 v[40:43], v52, s[24:27], 0 offen
    buffer_store_dwordx4 v[44:47], v53, s[24:27], 0 offen
    s_nop 1
    v_add_u32 v17, 1536, v0
    v_mul_hi_u32 v18, v17, s42
    v_mul_u32_u24 v19, 24, v18
    v_sub_u32 v19, v17, v19
    v_mul_u32_u24 v20, 400, v18
    v_lshl_add_u32 v20, v19, 4, v20
    ds_read_b128 v[24:27], v20
    v_add_u32 v18, s40, v18
    v_mul_u32_u24 v18, 9216, v18
    v_lshl_add_u32 v18, v19, 4, v18
    v_add_u32 v48, s43, v18
    v_add_u32 v17, 1792, v0
    v_mul_hi_u32 v18, v17, s42
    v_mul_u32_u24 v19, 24, v18
    v_sub_u32 v19, v17, v19
    v_mul_u32_u24 v20, 400, v18
    v_lshl_add_u32 v20, v19, 4, v20
    ds_read_b128 v[28:31], v20
    v_add_u32 v18, s40, v18
    v_mul_u32_u24 v18, 9216, v18
    v_lshl_add_u32 v18, v19, 4, v18
    v_add_u32 v49, s43, v18
    v_add_u32 v17, 2048, v0
    v_mul_hi_u32 v18, v17, s42
    v_mul_u32_u24 v19, 24, v18
    v_sub_u32 v19, v17, v19
    v_mul_u32_u24 v20, 400, v18
    v_lshl_add_u32 v20, v19, 4, v20
    ds_read_b128 v[32:35], v20
    v_add_u32 v18, s40, v18
    v_mul_u32_u24 v18, 9216, v18
    v_lshl_add_u32 v18, v19, 4, v18
    v_add_u32 v50, s43, v18
    v_add_u32 v17, 2304, v0
    v_mul_hi_u32 v18, v17, s42
    v_mul_u32_u24 v19, 24, v18
    v_sub_u32 v19, v17, v19
    v_mul_u32_u24 v20, 400, v18
    v_lshl_add_u32 v20, v19, 4, v20
    ds_read_b128 v[36:39], v20
    v_add_u32 v18, s40, v18
    v_mul_u32_u24 v18, 9216, v18
    v_lshl_add_u32 v18, v19, 4, v18
    v_add_u32 v51, s43, v18
    v_add_u32 v17, 2560, v0
    v_mul_hi_u32 v18, v17, s42
    v_mul_u32_u24 v19, 24, v18
    v_sub_u32 v19, v17, v19
    v_mul_u32_u24 v20, 400, v18
    v_lshl_add_u32 v20, v19, 4, v20
    ds_read_b128 v[40:43], v20
    v_add_u32 v18, s40, v18
    v_mul_u32_u24 v18, 9216, v18
    v_lshl_add_u32 v18, v19, 4, v18
    v_add_u32 v52, s43, v18
    v_add_u32 v17, 2816, v0
    v_mul_hi_u32 v18, v17, s42
    v_mul_u32_u24 v19, 24, v18
    v_sub_u32 v19, v17, v19
    v_mul_u32_u24 v20, 400, v18
    v_lshl_add_u32 v20, v19, 4, v20
    ds_read_b128 v[44:47], v20
    v_add_u32 v18, s40, v18
    v_mul_u32_u24 v18, 9216, v18
    v_lshl_add_u32 v18, v19, 4, v18
    v_add_u32 v53, s43, v18
    s_waitcnt lgkmcnt(0)
    buffer_store_dwordx4 v[24:27], v48, s[24:27], 0 offen
    buffer_store_dwordx4 v[28:31], v49, s[24:27], 0 offen
    buffer_store_dwordx4 v[32:35], v50, s[24:27], 0 offen
    buffer_store_dwordx4 v[36:39], v51, s[24:27], 0 offen
    buffer_store_dwordx4 v[40:43], v52, s[24:27], 0 offen
    buffer_store_dwordx4 v[44:47], v53, s[24:27], 0 offen
    s_nop 1
.g1_end:
    s_endpgm
.globl attna_kernel
.p2align 8
.type attna_kernel,@function
attna_kernel:
    s_cmp_ge_u32 s2, 256
    s_cbranch_scc1 .aa_end
    s_load_dwordx2 s[4:5], s[0:1], 16
    s_load_dwordx2 s[6:7], s[0:1], 88
    s_lshr_b32 s20, s2, 3
    s_and_b32 s21, s2, 7
    s_mul_i32 s22, s20, 648
    s_waitcnt lgkmcnt(0)
    s_mov_b32 s8, s4
    s_mov_b32 s9, s5
    s_mov_b32 s10, 20736
    s_mov_b32 s11, 0x00020000
    s_add_u32 s12, s6, 3145728
    s_addc_u32 s13, s7, 0
    s_mov_b32 s14, 7077888
    s_mov_b32 s15, 0x00020000
    s_add_u32 s16, s6, 33554432
    s_addc_u32 s17, s7, 0
    s_mov_b32 s18, 1572864
    s_mov_b32 s19, 0x00020000
    v_cmp_gt_u32 vcc, 162, v0
    s_and_saveexec_b64 s[40:41], vcc
    s_cbranch_execz .L140369560400032w
    v_lshlrev_b32 v1, 2, v0
    buffer_load_dword v2, v1, s[8:11], s22 offen
    s_waitcnt vmcnt(0)
    v_lshlrev_b32 v4, 16, v2
    v_and_b32 v5, 0xffff0000, v2
    v_lshlrev_b32 v1, 3, v0
    ds_write_b64 v1, v[4:5] offset:0
.L140369560400032w:
    s_mov_b64 exec, s[40:41]
    s_lshl_b32 s23, s21, 8
    v_add_u32 v1, s23, v0
    v_mul_u32_u24 v1, 3456, v1
    s_mul_i32 s24, s20, 36
    s_add_u32 s24, s24, 1152
    v_add_u32 v1, s24, v1
    buffer_load_dwordx4 v[4:7], v1, s[12:15], 0 offen
    buffer_load_dwordx4 v[8:11], v1, s[12:15], 0 offen offset:16
    buffer_load_dword v12, v1, s[12:15], 0 offen offset:32
    buffer_load_dwordx4 v[16:19], v1, s[12:15], 0 offen offset:1152
    buffer_load_dwordx4 v[20:23], v1, s[12:15], 0 offen offset:1168
    buffer_load_dword v24, v1, s[12:15], 0 offen offset:1184
    s_waitcnt vmcnt(0) lgkmcnt(0)
    s_barrier
    v_lshlrev_b32 v80, 16, v4
    v_and_b32 v81, 0xffff0000, v4
    v_lshlrev_b32 v82, 16, v5
    v_and_b32 v83, 0xffff0000, v5
    v_lshlrev_b32 v84, 16, v6
    v_and_b32 v85, 0xffff0000, v6
    v_lshlrev_b32 v86, 16, v7
    v_and_b32 v87, 0xffff0000, v7
    v_lshlrev_b32 v88, 16, v8
    v_and_b32 v89, 0xffff0000, v8
    v_lshlrev_b32 v90, 16, v9
    v_and_b32 v91, 0xffff0000, v9
    v_lshlrev_b32 v92, 16, v10
    v_and_b32 v93, 0xffff0000, v10
    v_lshlrev_b32 v94, 16, v11
    v_and_b32 v95, 0xffff0000, v11
    v_lshlrev_b32 v96, 16, v12
    v_and_b32 v97, 0xffff0000, v12
    v_mov_b32 v196, 0
    ds_read_b64 v[160:161], v196 offset:0
    ds_read_b64 v[162:163], v196 offset:8
    ds_read_b64 v[164:165], v196 offset:16
    ds_read_b64 v[166:167], v196 offset:24
    ds_read_b64 v[168:169], v196 offset:32
    ds_read_b64 v[170:171], v196 offset:40
    ds_read_b64 v[172:173], v196 offset:48
    ds_read_b64 v[174:175], v196 offset:56
    ds_read_b64 v[176:177], v196 offset:64
    ds_read_b64 v[178:179], v196 offset:72
    ds_read_b64 v[180:181], v196 offset:80
    ds_read_b64 v[182:183], v196 offset:88
    ds_read_b64 v[184:185], v196 offset:96
    ds_read_b64 v[186:187], v196 offset:104
    ds_read_b64 v[188:189], v196 offset:112
    ds_read_b64 v[190:191], v196 offset:120
    ds_read_b64 v[192:193], v196 offset:128
    ds_read_b64 v[194:195], v196 offset:136
    s_waitcnt lgkmcnt(9)
    v_mul_f32 v32, v80, v160
    v_mul_f32 v33, v80, v161
    v_mul_f32 v34, v80, v162
    v_mul_f32 v35, v80, v163
    v_mul_f32 v36, v80, v164
    v_mul_f32 v37, v80, v165
    v_mul_f32 v38, v80, v166
    v_mul_f32 v39, v80, v167
    v_mul_f32 v40, v80, v168
    v_mul_f32 v41, v80, v169
    v_mul_f32 v42, v80, v170
    v_mul_f32 v43, v80, v171
    v_mul_f32 v44, v80, v172
    v_mul_f32 v45, v80, v173
    v_mul_f32 v46, v80, v174
    v_mul_f32 v47, v80, v175
    v_mul_f32 v48, v80, v176
    v_mul_f32 v49, v80, v177
    ds_read_b64 v[160:161], v196 offset:144
    ds_read_b64 v[162:163], v196 offset:152
    ds_read_b64 v[164:165], v196 offset:160
    ds_read_b64 v[166:167], v196 offset:168
    ds_read_b64 v[168:169], v196 offset:176
    ds_read_b64 v[170:171], v196 offset:184
    ds_read_b64 v[172:173], v196 offset:192
    ds_read_b64 v[174:175], v196 offset:200
    ds_read_b64 v[176:177], v196 offset:208
    s_waitcnt lgkmcnt(9)
    v_fmac_f32 v32, v81, v178
    v_fmac_f32 v33, v81, v179
    v_fmac_f32 v34, v81, v180
    v_fmac_f32 v35, v81, v181
    v_fmac_f32 v36, v81, v182
    v_fmac_f32 v37, v81, v183
    v_fmac_f32 v38, v81, v184
    v_fmac_f32 v39, v81, v185
    v_fmac_f32 v40, v81, v186
    v_fmac_f32 v41, v81, v187
    v_fmac_f32 v42, v81, v188
    v_fmac_f32 v43, v81, v189
    v_fmac_f32 v44, v81, v190
    v_fmac_f32 v45, v81, v191
    v_fmac_f32 v46, v81, v192
    v_fmac_f32 v47, v81, v193
    v_fmac_f32 v48, v81, v194
    v_fmac_f32 v49, v81, v195
    ds_read_b64 v[178:179], v196 offset:216
    ds_read_b64 v[180:181], v196 offset:224
    ds_read_b64 v[182:183], v196 offset:232
    ds_read_b64 v[184:185], v196 offset:240
    ds_read_b64 v[186:187], v196 offset:248
    ds_read_b64 v[188:189], v196 offset:256
    ds_read_b64 v[190:191], v196 offset:264
    ds_read_b64 v[192:193], v196 offset:272
    ds_read_b64 v[194:195], v196 offset:280
    s_waitcnt lgkmcnt(9)
    v_fmac_f32 v32, v82, v160
    v_fmac_f32 v33, v82, v161
    v_fmac_f32 v34, v82, v162
    v_fmac_f32 v35, v82, v163
    v_fmac_f32 v36, v82, v164
    v_fmac_f32 v37, v82, v165
    v_fmac_f32 v38, v82, v166
    v_fmac_f32 v39, v82, v167
    v_fmac_f32 v40, v82, v168
    v_fmac_f32 v41, v82, v169
    v_fmac_f32 v42, v82, v170
    v_fmac_f32 v43, v82, v171
    v_fmac_f32 v44, v82, v172
    v_fmac_f32 v45, v82, v173
    v_fmac_f32 v46, v82, v174
    v_fmac_f32 v47, v82, v175
    v_fmac_f32 v48, v82, v176
    v_fmac_f32 v49, v82, v177
    ds_read_b64 v[160:161], v196 offset:288
    ds_read_b64 v[162:163], v196 offset:296
    ds_read_b64 v[164:165], v196 offset:304
    ds_read_b64 v[166:167], v196 offset:312
    ds_read_b64 v[168:169], v196 offset:320
    ds_read_b64 v[170:171], v196 offset:328
    ds_read_b64 v[172:173], v196 offset:336
    ds_read_b64 v[174:175], v196 offset:344
    ds_read_b64 v[176:177], v196 offset:352
    s_waitcnt lgkmcnt(9)
    v_fmac_f32 v32, v83, v178
    v_fmac_f32 v33, v83, v179
    v_fmac_f32 v34, v83, v180
    v_fmac_f32 v35, v83, v181
    v_fmac_f32 v36, v83, v182
    v_fmac_f32 v37, v83, v183
    v_fmac_f32 v38, v83, v184
    v_fmac_f32 v39, v83, v185
    v_fmac_f32 v40, v83, v186
    v_fmac_f32 v41, v83, v187
    v_fmac_f32 v42, v83, v188
    v_fmac_f32 v43, v83, v189
    v_fmac_f32 v44, v83, v190
    v_fmac_f32 v45, v83, v191
    v_fmac_f32 v46, v83, v192
    v_fmac_f32 v47, v83, v193
    v_fmac_f32 v48, v83, v194
    v_fmac_f32 v49, v83, v195
    ds_read_b64 v[178:179], v196 offset:360
    ds_read_b64 v[180:181], v196 offset:368
    ds_read_b64 v[182:183], v196 offset:376
    ds_read_b64 v[184:185], v196 offset:384
    ds_read_b64 v[186:187], v196 offset:392
    ds_read_b64 v[188:189], v196 offset:400
    ds_read_b64 v[190:191], v196 offset:408
    ds_read_b64 v[192:193], v196 offset:416
    ds_read_b64 v[194:195], v196 offset:424
    s_waitcnt lgkmcnt(9)
    v_fmac_f32 v32, v84, v160
    v_fmac_f32 v33, v84, v161
    v_fmac_f32 v34, v84, v162
    v_fmac_f32 v35, v84, v163
    v_fmac_f32 v36, v84, v164
    v_fmac_f32 v37, v84, v165
    v_fmac_f32 v38, v84, v166
    v_fmac_f32 v39, v84, v167
    v_fmac_f32 v40, v84, v168
    v_fmac_f32 v41, v84, v169
    v_fmac_f32 v42, v84, v170
    v_fmac_f32 v43, v84, v171
    v_fmac_f32 v44, v84, v172
    v_fmac_f32 v45, v84, v173
    v_fmac_f32 v46, v84, v174
    v_fmac_f32 v47, v84, v175
    v_fmac_f32 v48, v84, v176
    v_fmac_f32 v49, v84, v177
    ds_read_b64 v[160:161], v196 offset:432
    ds_read_b64 v[162:163], v196 offset:440
    ds_read_b64 v[164:165], v196 offset:448
    ds_read_b64 v[166:167], v196 offset:456
    ds_read_b64 v[168:169], v196 offset:464
    ds_read_b64 v[170:171], v196 offset:472
    ds_read_b64 v[172:173], v196 offset:480
    ds_read_b64 v[174:175], v196 offset:488
    ds_read_b64 v[176:177], v196 offset:496
    s_waitcnt lgkmcnt(9)
    v_fmac_f32 v32, v85, v178
    v_fmac_f32 v33, v85, v179
    v_fmac_f32 v34, v85, v180
    v_fmac_f32 v35, v85, v181
    v_fmac_f32 v36, v85, v182
    v_fmac_f32 v37, v85, v183
    v_fmac_f32 v38, v85, v184
    v_fmac_f32 v39, v85, v185
    v_fmac_f32 v40, v85, v186
    v_fmac_f32 v41, v85, v187
    v_fmac_f32 v42, v85, v188
    v_fmac_f32 v43, v85, v189
    v_fmac_f32 v44, v85, v190
    v_fmac_f32 v45, v85, v191
    v_fmac_f32 v46, v85, v192
    v_fmac_f32 v47, v85, v193
    v_fmac_f32 v48, v85, v194
    v_fmac_f32 v49, v85, v195
    ds_read_b64 v[178:179], v196 offset:504
    ds_read_b64 v[180:181], v196 offset:512
    ds_read_b64 v[182:183], v196 offset:520
    ds_read_b64 v[184:185], v196 offset:528
    ds_read_b64 v[186:187], v196 offset:536
    ds_read_b64 v[188:189], v196 offset:544
    ds_read_b64 v[190:191], v196 offset:552
    ds_read_b64 v[192:193], v196 offset:560
    ds_read_b64 v[194:195], v196 offset:568
    s_waitcnt lgkmcnt(9)
    v_fmac_f32 v32, v86, v160
    v_fmac_f32 v33, v86, v161
    v_fmac_f32 v34, v86, v162
    v_fmac_f32 v35, v86, v163
    v_fmac_f32 v36, v86, v164
    v_fmac_f32 v37, v86, v165
    v_fmac_f32 v38, v86, v166
    v_fmac_f32 v39, v86, v167
    v_fmac_f32 v40, v86, v168
    v_fmac_f32 v41, v86, v169
    v_fmac_f32 v42, v86, v170
    v_fmac_f32 v43, v86, v171
    v_fmac_f32 v44, v86, v172
    v_fmac_f32 v45, v86, v173
    v_fmac_f32 v46, v86, v174
    v_fmac_f32 v47, v86, v175
    v_fmac_f32 v48, v86, v176
    v_fmac_f32 v49, v86, v177
    ds_read_b64 v[160:161], v196 offset:576
    ds_read_b64 v[162:163], v196 offset:584
    ds_read_b64 v[164:165], v196 offset:592
    ds_read_b64 v[166:167], v196 offset:600
    ds_read_b64 v[168:169], v196 offset:608
    ds_read_b64 v[170:171], v196 offset:616
    ds_read_b64 v[172:173], v196 offset:624
    ds_read_b64 v[174:175], v196 offset:632
    ds_read_b64 v[176:177], v196 offset:640
    s_waitcnt lgkmcnt(9)
    v_fmac_f32 v32, v87, v178
    v_fmac_f32 v33, v87, v179
    v_fmac_f32 v34, v87, v180
    v_fmac_f32 v35, v87, v181
    v_fmac_f32 v36, v87, v182
    v_fmac_f32 v37, v87, v183
    v_fmac_f32 v38, v87, v184
    v_fmac_f32 v39, v87, v185
    v_fmac_f32 v40, v87, v186
    v_fmac_f32 v41, v87, v187
    v_fmac_f32 v42, v87, v188
    v_fmac_f32 v43, v87, v189
    v_fmac_f32 v44, v87, v190
    v_fmac_f32 v45, v87, v191
    v_fmac_f32 v46, v87, v192
    v_fmac_f32 v47, v87, v193
    v_fmac_f32 v48, v87, v194
    v_fmac_f32 v49, v87, v195
    ds_read_b64 v[178:179], v196 offset:648
    ds_read_b64 v[180:181], v196 offset:656
    ds_read_b64 v[182:183], v196 offset:664
    ds_read_b64 v[184:185], v196 offset:672
    ds_read_b64 v[186:187], v196 offset:680
    ds_read_b64 v[188:189], v196 offset:688
    ds_read_b64 v[190:191], v196 offset:696
    ds_read_b64 v[192:193], v196 offset:704
    ds_read_b64 v[194:195], v196 offset:712
    s_waitcnt lgkmcnt(9)
    v_fmac_f32 v32, v88, v160
    v_fmac_f32 v33, v88, v161
    v_fmac_f32 v34, v88, v162
    v_fmac_f32 v35, v88, v163
    v_fmac_f32 v36, v88, v164
    v_fmac_f32 v37, v88, v165
    v_fmac_f32 v38, v88, v166
    v_fmac_f32 v39, v88, v167
    v_fmac_f32 v40, v88, v168
    v_fmac_f32 v41, v88, v169
    v_fmac_f32 v42, v88, v170
    v_fmac_f32 v43, v88, v171
    v_fmac_f32 v44, v88, v172
    v_fmac_f32 v45, v88, v173
    v_fmac_f32 v46, v88, v174
    v_fmac_f32 v47, v88, v175
    v_fmac_f32 v48, v88, v176
    v_fmac_f32 v49, v88, v177
    ds_read_b64 v[160:161], v196 offset:720
    ds_read_b64 v[162:163], v196 offset:728
    ds_read_b64 v[164:165], v196 offset:736
    ds_read_b64 v[166:167], v196 offset:744
    ds_read_b64 v[168:169], v196 offset:752
    ds_read_b64 v[170:171], v196 offset:760
    ds_read_b64 v[172:173], v196 offset:768
    ds_read_b64 v[174:175], v196 offset:776
    ds_read_b64 v[176:177], v196 offset:784
    s_waitcnt lgkmcnt(9)
    v_fmac_f32 v32, v89, v178
    v_fmac_f32 v33, v89, v179
    v_fmac_f32 v34, v89, v180
    v_fmac_f32 v35, v89, v181
    v_fmac_f32 v36, v89, v182
    v_fmac_f32 v37, v89, v183
    v_fmac_f32 v38, v89, v184
    v_fmac_f32 v39, v89, v185
    v_fmac_f32 v40, v89, v186
    v_fmac_f32 v41, v89, v187
    v_fmac_f32 v42, v89, v188
    v_fmac_f32 v43, v89, v189
    v_fmac_f32 v44, v89, v190
    v_fmac_f32 v45, v89, v191
    v_fmac_f32 v46, v89, v192
    v_fmac_f32 v47, v89, v193
    v_fmac_f32 v48, v89, v194
    v_fmac_f32 v49, v89, v195
    ds_read_b64 v[178:179], v196 offset:792
    ds_read_b64 v[180:181], v196 offset:800
    ds_read_b64 v[182:183], v196 offset:808
    ds_read_b64 v[184:185], v196 offset:816
    ds_read_b64 v[186:187], v196 offset:824
    ds_read_b64 v[188:189], v196 offset:832
    ds_read_b64 v[190:191], v196 offset:840
    ds_read_b64 v[192:193], v196 offset:848
    ds_read_b64 v[194:195], v196 offset:856
    s_waitcnt lgkmcnt(9)
    v_fmac_f32 v32, v90, v160
    v_fmac_f32 v33, v90, v161
    v_fmac_f32 v34, v90, v162
    v_fmac_f32 v35, v90, v163
    v_fmac_f32 v36, v90, v164
    v_fmac_f32 v37, v90, v165
    v_fmac_f32 v38, v90, v166
    v_fmac_f32 v39, v90, v167
    v_fmac_f32 v40, v90, v168
    v_fmac_f32 v41, v90, v169
    v_fmac_f32 v42, v90, v170
    v_fmac_f32 v43, v90, v171
    v_fmac_f32 v44, v90, v172
    v_fmac_f32 v45, v90, v173
    v_fmac_f32 v46, v90, v174
    v_fmac_f32 v47, v90, v175
    v_fmac_f32 v48, v90, v176
    v_fmac_f32 v49, v90, v177
    ds_read_b64 v[160:161], v196 offset:864
    ds_read_b64 v[162:163], v196 offset:872
    ds_read_b64 v[164:165], v196 offset:880
    ds_read_b64 v[166:167], v196 offset:888
    ds_read_b64 v[168:169], v196 offset:896
    ds_read_b64 v[170:171], v196 offset:904
    ds_read_b64 v[172:173], v196 offset:912
    ds_read_b64 v[174:175], v196 offset:920
    ds_read_b64 v[176:177], v196 offset:928
    s_waitcnt lgkmcnt(9)
    v_fmac_f32 v32, v91, v178
    v_fmac_f32 v33, v91, v179
    v_fmac_f32 v34, v91, v180
    v_fmac_f32 v35, v91, v181
    v_fmac_f32 v36, v91, v182
    v_fmac_f32 v37, v91, v183
    v_fmac_f32 v38, v91, v184
    v_fmac_f32 v39, v91, v185
    v_fmac_f32 v40, v91, v186
    v_fmac_f32 v41, v91, v187
    v_fmac_f32 v42, v91, v188
    v_fmac_f32 v43, v91, v189
    v_fmac_f32 v44, v91, v190
    v_fmac_f32 v45, v91, v191
    v_fmac_f32 v46, v91, v192
    v_fmac_f32 v47, v91, v193
    v_fmac_f32 v48, v91, v194
    v_fmac_f32 v49, v91, v195
    ds_read_b64 v[178:179], v196 offset:936
    ds_read_b64 v[180:181], v196 offset:944
    ds_read_b64 v[182:183], v196 offset:952
    ds_read_b64 v[184:185], v196 offset:960
    ds_read_b64 v[186:187], v196 offset:968
    ds_read_b64 v[188:189], v196 offset:976
    ds_read_b64 v[190:191], v196 offset:984
    ds_read_b64 v[192:193], v196 offset:992
    ds_read_b64 v[194:195], v196 offset:1000
    s_waitcnt lgkmcnt(9)
    v_fmac_f32 v32, v92, v160
    v_fmac_f32 v33, v92, v161
    v_fmac_f32 v34, v92, v162
    v_fmac_f32 v35, v92, v163
    v_fmac_f32 v36, v92, v164
    v_fmac_f32 v37, v92, v165
    v_fmac_f32 v38, v92, v166
    v_fmac_f32 v39, v92, v167
    v_fmac_f32 v40, v92, v168
    v_fmac_f32 v41, v92, v169
    v_fmac_f32 v42, v92, v170
    v_fmac_f32 v43, v92, v171
    v_fmac_f32 v44, v92, v172
    v_fmac_f32 v45, v92, v173
    v_fmac_f32 v46, v92, v174
    v_fmac_f32 v47, v92, v175
    v_fmac_f32 v48, v92, v176
    v_fmac_f32 v49, v92, v177
    ds_read_b64 v[160:161], v196 offset:1008
    ds_read_b64 v[162:163], v196 offset:1016
    ds_read_b64 v[164:165], v196 offset:1024
    ds_read_b64 v[166:167], v196 offset:1032
    ds_read_b64 v[168:169], v196 offset:1040
    ds_read_b64 v[170:171], v196 offset:1048
    ds_read_b64 v[172:173], v196 offset:1056
    ds_read_b64 v[174:175], v196 offset:1064
    ds_read_b64 v[176:177], v196 offset:1072
    s_waitcnt lgkmcnt(9)
    v_fmac_f32 v32, v93, v178
    v_fmac_f32 v33, v93, v179
    v_fmac_f32 v34, v93, v180
    v_fmac_f32 v35, v93, v181
    v_fmac_f32 v36, v93, v182
    v_fmac_f32 v37, v93, v183
    v_fmac_f32 v38, v93, v184
    v_fmac_f32 v39, v93, v185
    v_fmac_f32 v40, v93, v186
    v_fmac_f32 v41, v93, v187
    v_fmac_f32 v42, v93, v188
    v_fmac_f32 v43, v93, v189
    v_fmac_f32 v44, v93, v190
    v_fmac_f32 v45, v93, v191
    v_fmac_f32 v46, v93, v192
    v_fmac_f32 v47, v93, v193
    v_fmac_f32 v48, v93, v194
    v_fmac_f32 v49, v93, v195
    ds_read_b64 v[178:179], v196 offset:1080
    ds_read_b64 v[180:181], v196 offset:1088
    ds_read_b64 v[182:183], v196 offset:1096
    ds_read_b64 v[184:185], v196 offset:1104
    ds_read_b64 v[186:187], v196 offset:1112
    ds_read_b64 v[188:189], v196 offset:1120
    ds_read_b64 v[190:191], v196 offset:1128
    ds_read_b64 v[192:193], v196 offset:1136
    ds_read_b64 v[194:195], v196 offset:1144
    s_waitcnt lgkmcnt(9)
    v_fmac_f32 v32, v94, v160
    v_fmac_f32 v33, v94, v161
    v_fmac_f32 v34, v94, v162
    v_fmac_f32 v35, v94, v163
    v_fmac_f32 v36, v94, v164
    v_fmac_f32 v37, v94, v165
    v_fmac_f32 v38, v94, v166
    v_fmac_f32 v39, v94, v167
    v_fmac_f32 v40, v94, v168
    v_fmac_f32 v41, v94, v169
    v_fmac_f32 v42, v94, v170
    v_fmac_f32 v43, v94, v171
    v_fmac_f32 v44, v94, v172
    v_fmac_f32 v45, v94, v173
    v_fmac_f32 v46, v94, v174
    v_fmac_f32 v47, v94, v175
    v_fmac_f32 v48, v94, v176
    v_fmac_f32 v49, v94, v177
    ds_read_b64 v[160:161], v196 offset:1152
    ds_read_b64 v[162:163], v196 offset:1160
    ds_read_b64 v[164:165], v196 offset:1168
    ds_read_b64 v[166:167], v196 offset:1176
    ds_read_b64 v[168:169], v196 offset:1184
    ds_read_b64 v[170:171], v196 offset:1192
    ds_read_b64 v[172:173], v196 offset:1200
    ds_read_b64 v[174:175], v196 offset:1208
    ds_read_b64 v[176:177], v196 offset:1216
    s_waitcnt lgkmcnt(9)
    v_fmac_f32 v32, v95, v178
    v_fmac_f32 v33, v95, v179
    v_fmac_f32 v34, v95, v180
    v_fmac_f32 v35, v95, v181
    v_fmac_f32 v36, v95, v182
    v_fmac_f32 v37, v95, v183
    v_fmac_f32 v38, v95, v184
    v_fmac_f32 v39, v95, v185
    v_fmac_f32 v40, v95, v186
    v_fmac_f32 v41, v95, v187
    v_fmac_f32 v42, v95, v188
    v_fmac_f32 v43, v95, v189
    v_fmac_f32 v44, v95, v190
    v_fmac_f32 v45, v95, v191
    v_fmac_f32 v46, v95, v192
    v_fmac_f32 v47, v95, v193
    v_fmac_f32 v48, v95, v194
    v_fmac_f32 v49, v95, v195
    ds_read_b64 v[178:179], v196 offset:1224
    ds_read_b64 v[180:181], v196 offset:1232
    ds_read_b64 v[182:183], v196 offset:1240
    ds_read_b64 v[184:185], v196 offset:1248
    ds_read_b64 v[186:187], v196 offset:1256
    ds_read_b64 v[188:189], v196 offset:1264
    ds_read_b64 v[190:191], v196 offset:1272
    ds_read_b64 v[192:193], v196 offset:1280
    ds_read_b64 v[194:195], v196 offset:1288
    s_waitcnt lgkmcnt(9)
    v_fmac_f32 v32, v96, v160
    v_fmac_f32 v33, v96, v161
    v_fmac_f32 v34, v96, v162
    v_fmac_f32 v35, v96, v163
    v_fmac_f32 v36, v96, v164
    v_fmac_f32 v37, v96, v165
    v_fmac_f32 v38, v96, v166
    v_fmac_f32 v39, v96, v167
    v_fmac_f32 v40, v96, v168
    v_fmac_f32 v41, v96, v169
    v_fmac_f32 v42, v96, v170
    v_fmac_f32 v43, v96, v171
    v_fmac_f32 v44, v96, v172
    v_fmac_f32 v45, v96, v173
    v_fmac_f32 v46, v96, v174
    v_fmac_f32 v47, v96, v175
    v_fmac_f32 v48, v96, v176
    v_fmac_f32 v49, v96, v177
    s_waitcnt lgkmcnt(0)
    v_fmac_f32 v32, v97, v178
    v_fmac_f32 v33, v97, v179
    v_fmac_f32 v34, v97, v180
    v_fmac_f32 v35, v97, v181
    v_fmac_f32 v36, v97, v182
    v_fmac_f32 v37, v97, v183
    v_fmac_f32 v38, v97, v184
    v_fmac_f32 v39, v97, v185
    v_fmac_f32 v40, v97, v186
    v_fmac_f32 v41, v97, v187
    v_fmac_f32 v42, v97, v188
    v_fmac_f32 v43, v97, v189
    v_fmac_f32 v44, v97, v190
    v_fmac_f32 v45, v97, v191
    v_fmac_f32 v46, v97, v192
    v_fmac_f32 v47, v97, v193
    v_fmac_f32 v48, v97, v194
    v_fmac_f32 v49, v97, v195
    v_cvt_pk_bf16_f32 v160, v32, v33
    v_lshlrev_b32 v32, 16, v160
    v_and_b32 v33, 0xffff0000, v160
    v_cvt_pk_bf16_f32 v160, v34, v35
    v_lshlrev_b32 v34, 16, v160
    v_and_b32 v35, 0xffff0000, v160
    v_cvt_pk_bf16_f32 v160, v36, v37
    v_lshlrev_b32 v36, 16, v160
    v_and_b32 v37, 0xffff0000, v160
    v_cvt_pk_bf16_f32 v160, v38, v39
    v_lshlrev_b32 v38, 16, v160
    v_and_b32 v39, 0xffff0000, v160
    v_cvt_pk_bf16_f32 v160, v40, v41
    v_lshlrev_b32 v40, 16, v160
    v_and_b32 v41, 0xffff0000, v160
    v_cvt_pk_bf16_f32 v160, v42, v43
    v_lshlrev_b32 v42, 16, v160
    v_and_b32 v43, 0xffff0000, v160
    v_cvt_pk_bf16_f32 v160, v44, v45
    v_lshlrev_b32 v44, 16, v160
    v_and_b32 v45, 0xffff0000, v160
    v_cvt_pk_bf16_f32 v160, v46, v47
    v_lshlrev_b32 v46, 16, v160
    v_and_b32 v47, 0xffff0000, v160
    v_cvt_pk_bf16_f32 v160, v48, v49
    v_lshlrev_b32 v48, 16, v160
    v_and_b32 v49, 0xffff0000, v160
    v_max_f32 v160, v32, v33
    v_min_f32 v161, v32, v33
    v_max_f32 v160, v160, v34
    v_min_f32 v161, v161, v34
    v_max_f32 v160, v160, v35
    v_min_f32 v161, v161, v35
    v_max_f32 v160, v160, v36
    v_min_f32 v161, v161, v36
    v_max_f32 v160, v160, v37
    v_min_f32 v161, v161, v37
    v_max_f32 v160, v160, v38
    v_min_f32 v161, v161, v38
    v_max_f32 v160, v160, v39
    v_min_f32 v161, v161, v39
    v_max_f32 v160, v160, v40
    v_min_f32 v161, v161, v40
    v_max_f32 v160, v160, v41
    v_min_f32 v161, v161, v41
    v_max_f32 v160, v160, v42
    v_min_f32 v161, v161, v42
    v_max_f32 v160, v160, v43
    v_min_f32 v161, v161, v43
    v_max_f32 v160, v160, v44
    v_min_f32 v161, v161, v44
    v_max_f32 v160, v160, v45
    v_min_f32 v161, v161, v45
    v_max_f32 v160, v160, v46
    v_min_f32 v161, v161, v46
    v_max_f32 v160, v160, v47
    v_min_f32 v161, v161, v47
    v_max_f32 v160, v160, v48
    v_min_f32 v161, v161, v48
    v_max_f32 v160, v160, v49
    v_min_f32 v161, v161, v49
    v_mul_f32 v160, 0x3fb8aa3b, v160
    v_mul_f32 v161, 0x3fb8aa3b, v161
    v_mov_b32 v162, 0x3fb8aa3b
    v_fma_f32 v80, v32, v162, -v160
    v_fma_f32 v98, -v32, v162, v161
    v_fma_f32 v81, v33, v162, -v160
    v_fma_f32 v99, -v33, v162, v161
    v_fma_f32 v82, v34, v162, -v160
    v_fma_f32 v100, -v34, v162, v161
    v_fma_f32 v83, v35, v162, -v160
    v_fma_f32 v101, -v35, v162, v161
    v_fma_f32 v84, v36, v162, -v160
    v_fma_f32 v102, -v36, v162, v161
    v_fma_f32 v85, v37, v162, -v160
    v_fma_f32 v103, -v37, v162, v161
    v_fma_f32 v86, v38, v162, -v160
    v_fma_f32 v104, -v38, v162, v161
    v_fma_f32 v87, v39, v162, -v160
    v_fma_f32 v105, -v39, v162, v161
    v_fma_f32 v88, v40, v162, -v160
    v_fma_f32 v106, -v40, v162, v161
    v_fma_f32 v89, v41, v162, -v160
    v_fma_f32 v107, -v41, v162, v161
    v_fma_f32 v90, v42, v162, -v160
    v_fma_f32 v108, -v42, v162, v161
    v_fma_f32 v91, v43, v162, -v160
    v_fma_f32 v109, -v43, v162, v161
    v_fma_f32 v92, v44, v162, -v160
    v_fma_f32 v110, -v44, v162, v161
    v_fma_f32 v93, v45, v162, -v160
    v_fma_f32 v111, -v45, v162, v161
    v_fma_f32 v94, v46, v162, -v160
    v_fma_f32 v112, -v46, v162, v161
    v_fma_f32 v95, v47, v162, -v160
    v_fma_f32 v113, -v47, v162, v161
    v_fma_f32 v96, v48, v162, -v160
    v_fma_f32 v114, -v48, v162, v161
    v_fma_f32 v97, v49, v162, -v160
    v_fma_f32 v115, -v49, v162, v161
    v_exp_f32 v80, v80
    v_exp_f32 v81, v81
    v_exp_f32 v82, v82
    v_exp_f32 v83, v83
    v_exp_f32 v84, v84
    v_exp_f32 v85, v85
    v_exp_f32 v86, v86
    v_exp_f32 v87, v87
    v_exp_f32 v88, v88
    v_exp_f32 v89, v89
    v_exp_f32 v90, v90
    v_exp_f32 v91, v91
    v_exp_f32 v92, v92
    v_exp_f32 v93, v93
    v_exp_f32 v94, v94
    v_exp_f32 v95, v95
    v_exp_f32 v96, v96
    v_exp_f32 v97, v97
    v_exp_f32 v98, v98
    v_exp_f32 v99, v99
    v_exp_f32 v100, v100
    v_exp_f32 v101, v101
    v_exp_f32 v102, v102
    v_exp_f32 v103, v103
    v_exp_f32 v104, v104
    v_exp_f32 v105, v105
    v_exp_f32 v106, v106
    v_exp_f32 v107, v107
    v_exp_f32 v108, v108
    v_exp_f32 v109, v109
    v_exp_f32 v110, v110
    v_exp_f32 v111, v111
    v_exp_f32 v112, v112
    v_exp_f32 v113, v113
    v_exp_f32 v114, v114
    v_exp_f32 v115, v115
    s_nop 0
    v_add_f32 v160, v80, v81
    v_add_f32 v161, v98, v99
    v_add_f32 v160, v160, v82
    v_add_f32 v161, v161, v100
    v_add_f32 v160, v160, v83
    v_add_f32 v161, v161, v101
    v_add_f32 v160, v160, v84
    v_add_f32 v161, v161, v102
    v_add_f32 v160, v160, v85
    v_add_f32 v161, v161, v103
    v_add_f32 v160, v160, v86
    v_add_f32 v161, v161, v104
    v_add_f32 v160, v160, v87
    v_add_f32 v161, v161, v105
    v_add_f32 v160, v160, v88
    v_add_f32 v161, v161, v106
    v_add_f32 v160, v160, v89
    v_add_f32 v161, v161, v107
    v_add_f32 v160, v160, v90
    v_add_f32 v161, v161, v108
    v_add_f32 v160, v160, v91
    v_add_f32 v161, v161, v109
    v_add_f32 v160, v160, v92
    v_add_f32 v161, v161, v110
    v_add_f32 v160, v160, v93
    v_add_f32 v161, v161, v111
    v_add_f32 v160, v160, v94
    v_add_f32 v161, v161, v112
    v_add_f32 v160, v160, v95
    v_add_f32 v161, v161, v113
    v_add_f32 v160, v160, v96
    v_add_f32 v161, v161, v114
    v_add_f32 v160, v160, v97
    v_add_f32 v161, v161, v115
    v_rcp_f32 v160, v160
    v_rcp_f32 v161, v161
    s_nop 0
    v_mul_f32 v80, v80, v160
    v_mul_f32 v98, v98, v161
    v_mul_f32 v81, v81, v160
    v_mul_f32 v99, v99, v161
    v_mul_f32 v82, v82, v160
    v_mul_f32 v100, v100, v161
    v_mul_f32 v83, v83, v160
    v_mul_f32 v101, v101, v161
    v_mul_f32 v84, v84, v160
    v_mul_f32 v102, v102, v161
    v_mul_f32 v85, v85, v160
    v_mul_f32 v103, v103, v161
    v_mul_f32 v86, v86, v160
    v_mul_f32 v104, v104, v161
    v_mul_f32 v87, v87, v160
    v_mul_f32 v105, v105, v161
    v_mul_f32 v88, v88, v160
    v_mul_f32 v106, v106, v161
    v_mul_f32 v89, v89, v160
    v_mul_f32 v107, v107, v161
    v_mul_f32 v90, v90, v160
    v_mul_f32 v108, v108, v161
    v_mul_f32 v91, v91, v160
    v_mul_f32 v109, v109, v161
    v_mul_f32 v92, v92, v160
    v_mul_f32 v110, v110, v161
    v_mul_f32 v93, v93, v160
    v_mul_f32 v111, v111, v161
    v_mul_f32 v94, v94, v160
    v_mul_f32 v112, v112, v161
    v_mul_f32 v95, v95, v160
    v_mul_f32 v113, v113, v161
    v_mul_f32 v96, v96, v160
    v_mul_f32 v114, v114, v161
    v_mul_f32 v97, v97, v160
    v_mul_f32 v115, v115, v161
    v_cvt_pk_bf16_f32 v32, v80, v81
    v_lshlrev_b32 v80, 16, v32
    v_and_b32 v81, 0xffff0000, v32
    v_cvt_pk_bf16_f32 v33, v82, v83
    v_lshlrev_b32 v82, 16, v33
    v_and_b32 v83, 0xffff0000, v33
    v_cvt_pk_bf16_f32 v34, v84, v85
    v_lshlrev_b32 v84, 16, v34
    v_and_b32 v85, 0xffff0000, v34
    v_cvt_pk_bf16_f32 v35, v86, v87
    v_lshlrev_b32 v86, 16, v35
    v_and_b32 v87, 0xffff0000, v35
    v_cvt_pk_bf16_f32 v36, v88, v89
    v_lshlrev_b32 v88, 16, v36
    v_and_b32 v89, 0xffff0000, v36
    v_cvt_pk_bf16_f32 v37, v90, v91
    v_lshlrev_b32 v90, 16, v37
    v_and_b32 v91, 0xffff0000, v37
    v_cvt_pk_bf16_f32 v38, v92, v93
    v_lshlrev_b32 v92, 16, v38
    v_and_b32 v93, 0xffff0000, v38
    v_cvt_pk_bf16_f32 v39, v94, v95
    v_lshlrev_b32 v94, 16, v39
    v_and_b32 v95, 0xffff0000, v39
    v_cvt_pk_bf16_f32 v40, v96, v97
    v_lshlrev_b32 v96, 16, v40
    v_and_b32 v97, 0xffff0000, v40
    v_cvt_pk_bf16_f32 v41, v98, v99
    v_lshlrev_b32 v98, 16, v41
    v_and_b32 v99, 0xffff0000, v41
    v_cvt_pk_bf16_f32 v42, v100, v101
    v_lshlrev_b32 v100, 16, v42
    v_and_b32 v101, 0xffff0000, v42
    v_cvt_pk_bf16_f32 v43, v102, v103
    v_lshlrev_b32 v102, 16, v43
    v_and_b32 v103, 0xffff0000, v43
    v_cvt_pk_bf16_f32 v44, v104, v105
    v_lshlrev_b32 v104, 16, v44
    v_and_b32 v105, 0xffff0000, v44
    v_cvt_pk_bf16_f32 v45, v106, v107
    v_lshlrev_b32 v106, 16, v45
    v_and_b32 v107, 0xffff0000, v45
    v_cvt_pk_bf16_f32 v46, v108, v109
    v_lshlrev_b32 v108, 16, v46
    v_and_b32 v109, 0xffff0000, v46
    v_cvt_pk_bf16_f32 v47, v110, v111
    v_lshlrev_b32 v110, 16, v47
    v_and_b32 v111, 0xffff0000, v47
    v_cvt_pk_bf16_f32 v48, v112, v113
    v_lshlrev_b32 v112, 16, v48
    v_and_b32 v113, 0xffff0000, v48
    v_cvt_pk_bf16_f32 v49, v114, v115
    v_lshlrev_b32 v114, 16, v49
    v_and_b32 v115, 0xffff0000, v49
    v_lshlrev_b32 v2, 1, v0
    ds_write_b16 v2, v32 offset:2048
    ds_write_b16_d16_hi v2, v32 offset:2576
    ds_write_b16 v2, v33 offset:3104
    ds_write_b16_d16_hi v2, v33 offset:3632
    ds_write_b16 v2, v34 offset:4160
    ds_write_b16_d16_hi v2, v34 offset:4688
    ds_write_b16 v2, v35 offset:5216
    ds_write_b16_d16_hi v2, v35 offset:5744
    ds_write_b16 v2, v36 offset:6272
    ds_write_b16_d16_hi v2, v36 offset:6800
    ds_write_b16 v2, v37 offset:7328
    ds_write_b16_d16_hi v2, v37 offset:7856
    ds_write_b16 v2, v38 offset:8384
    ds_write_b16_d16_hi v2, v38 offset:8912
    ds_write_b16 v2, v39 offset:9440
    ds_write_b16_d16_hi v2, v39 offset:9968
    ds_write_b16 v2, v40 offset:10496
    ds_write_b16_d16_hi v2, v40 offset:11024
    ds_write_b16 v2, v41 offset:11552
    ds_write_b16_d16_hi v2, v41 offset:12080
    ds_write_b16 v2, v42 offset:12608
    ds_write_b16_d16_hi v2, v42 offset:13136
    ds_write_b16 v2, v43 offset:13664
    ds_write_b16_d16_hi v2, v43 offset:14192
    ds_write_b16 v2, v44 offset:14720
    ds_write_b16_d16_hi v2, v44 offset:15248
    ds_write_b16 v2, v45 offset:15776
    ds_write_b16_d16_hi v2, v45 offset:16304
    ds_write_b16 v2, v46 offset:16832
    ds_write_b16_d16_hi v2, v46 offset:17360
    ds_write_b16 v2, v47 offset:17888
    ds_write_b16_d16_hi v2, v47 offset:18416
    ds_write_b16 v2, v48 offset:18944
    ds_write_b16_d16_hi v2, v48 offset:19472
    ds_write_b16 v2, v49 offset:20000
    ds_write_b16_d16_hi v2, v49 offset:20528
    ds_write_b16 v2, v16 offset:35840
    ds_write_b16_d16_hi v2, v16 offset:36368
    ds_write_b16 v2, v17 offset:36896
    ds_write_b16_d16_hi v2, v17 offset:37424
    ds_write_b16 v2, v18 offset:37952
    ds_write_b16_d16_hi v2, v18 offset:38480
    ds_write_b16 v2, v19 offset:39008
    ds_write_b16_d16_hi v2, v19 offset:39536
    ds_write_b16 v2, v20 offset:40064
    ds_write_b16_d16_hi v2, v20 offset:40592
    ds_write_b16 v2, v21 offset:41120
    ds_write_b16_d16_hi v2, v21 offset:41648
    ds_write_b16 v2, v22 offset:42176
    ds_write_b16_d16_hi v2, v22 offset:42704
    ds_write_b16 v2, v23 offset:43232
    ds_write_b16_d16_hi v2, v23 offset:43760
    ds_write_b16 v2, v24 offset:44288
    ds_write_b16_d16_hi v2, v24 offset:44816
    v_mov_b32 v3, 0x3f80
    ds_write_b16 v2, v3 offset:45344
    s_waitcnt lgkmcnt(0)
    s_barrier
    v_lshrrev_b32 v3, 6, v0
    s_nop 0
    v_readfirstlane_b32 s25, v3
    s_nop 1
    s_cmp_ge_u32 s25, 2
    s_cbranch_scc1 .aa_end
    v_and_b32 v4, 31, v0
    v_mul_u32_u24 v5, 528, v4
    v_bfe_u32 v6, v0, 5, 1
    v_lshl_add_u32 v5, v6, 4, v5
    s_mul_i32 s26, s25, 16896
    v_add_u32 v7, s26, v5
    v_mov_b32 v32, 0
    v_mov_b32 v33, 0
    v_mov_b32 v34, 0
    v_mov_b32 v35, 0
    v_mov_b32 v36, 0
    v_mov_b32 v37, 0
    v_mov_b32 v38, 0
    v_mov_b32 v39, 0
    v_mov_b32 v40, 0
    v_mov_b32 v41, 0
    v_mov_b32 v42, 0
    v_mov_b32 v43, 0
    v_mov_b32 v44, 0
    v_mov_b32 v45, 0
    v_mov_b32 v46, 0
    v_mov_b32 v47, 0
    ds_read_b128 v[64:67], v5 offset:35840
    ds_read_b128 v[68:71], v7 offset:2048
    ds_read_b128 v[72:75], v5 offset:35872
    ds_read_b128 v[76:79], v7 offset:2080
    ds_read_b128 v[80:83], v5 offset:35904
    ds_read_b128 v[84:87], v7 offset:2112
    ds_read_b128 v[88:91], v5 offset:35936
    ds_read_b128 v[92:95], v7 offset:2144
    s_waitcnt lgkmcnt(0)
    v_mfma_f32_32x32x16_bf16 v[32:47], v[64:67], v[68:71], v[32:47]
    v_mfma_f32_32x32x16_bf16 v[32:47], v[72:75], v[76:79], v[32:47]
    v_mfma_f32_32x32x16_bf16 v[32:47], v[80:83], v[84:87], v[32:47]
    v_mfma_f32_32x32x16_bf16 v[32:47], v[88:91], v[92:95], v[32:47]
    ds_read_b128 v[64:67], v5 offset:35968
    ds_read_b128 v[68:71], v7 offset:2176
    ds_read_b128 v[72:75], v5 offset:36000
    ds_read_b128 v[76:79], v7 offset:2208
    ds_read_b128 v[80:83], v5 offset:36032
    ds_read_b128 v[84:87], v7 offset:2240
    ds_read_b128 v[88:91], v5 offset:36064
    ds_read_b128 v[92:95], v7 offset:2272
    s_waitcnt lgkmcnt(0)
    v_mfma_f32_32x32x16_bf16 v[32:47], v[64:67], v[68:71], v[32:47]
    v_mfma_f32_32x32x16_bf16 v[32:47], v[72:75], v[76:79], v[32:47]
    v_mfma_f32_32x32x16_bf16 v[32:47], v[80:83], v[84:87], v[32:47]
    v_mfma_f32_32x32x16_bf16 v[32:47], v[88:91], v[92:95], v[32:47]
    ds_read_b128 v[64:67], v5 offset:36096
    ds_read_b128 v[68:71], v7 offset:2304
    ds_read_b128 v[72:75], v5 offset:36128
    ds_read_b128 v[76:79], v7 offset:2336
    ds_read_b128 v[80:83], v5 offset:36160
    ds_read_b128 v[84:87], v7 offset:2368
    ds_read_b128 v[88:91], v5 offset:36192
    ds_read_b128 v[92:95], v7 offset:2400
    s_waitcnt lgkmcnt(0)
    v_mfma_f32_32x32x16_bf16 v[32:47], v[64:67], v[68:71], v[32:47]
    v_mfma_f32_32x32x16_bf16 v[32:47], v[72:75], v[76:79], v[32:47]
    v_mfma_f32_32x32x16_bf16 v[32:47], v[80:83], v[84:87], v[32:47]
    v_mfma_f32_32x32x16_bf16 v[32:47], v[88:91], v[92:95], v[32:47]
    ds_read_b128 v[64:67], v5 offset:36224
    ds_read_b128 v[68:71], v7 offset:2432
    ds_read_b128 v[72:75], v5 offset:36256
    ds_read_b128 v[76:79], v7 offset:2464
    ds_read_b128 v[80:83], v5 offset:36288
    ds_read_b128 v[84:87], v7 offset:2496
    ds_read_b128 v[88:91], v5 offset:36320
    ds_read_b128 v[92:95], v7 offset:2528
    s_waitcnt lgkmcnt(0)
    v_mfma_f32_32x32x16_bf16 v[32:47], v[64:67], v[68:71], v[32:47]
    v_mfma_f32_32x32x16_bf16 v[32:47], v[72:75], v[76:79], v[32:47]
    v_mfma_f32_32x32x16_bf16 v[32:47], v[80:83], v[84:87], v[32:47]
    v_mfma_f32_32x32x16_bf16 v[32:47], v[88:91], v[92:95], v[32:47]
    s_nop 15
    s_mul_i32 s27, s2, 6144
    v_lshlrev_b32 v8, 2, v4
    v_lshl_add_u32 v8, v6, 10, v8
    s_lshl_b32 s26, s25, 7
    s_add_u32 s27, s27, s26
    v_add_u32 v8, s27, v8
    v_add_u32 v9, 4096, v8
    buffer_store_dword v32, v8, s[16:19], 0 offen offset:0
    buffer_store_dword v33, v8, s[16:19], 0 offen offset:256
    buffer_store_dword v34, v8, s[16:19], 0 offen offset:512
    buffer_store_dword v35, v8, s[16:19], 0 offen offset:768
    buffer_store_dword v36, v8, s[16:19], 0 offen offset:2048
    buffer_store_dword v37, v8, s[16:19], 0 offen offset:2304
    buffer_store_dword v38, v8, s[16:19], 0 offen offset:2560
    buffer_store_dword v39, v8, s[16:19], 0 offen offset:2816
    buffer_store_dword v40, v9, s[16:19], 0 offen offset:0
    buffer_store_dword v41, v9, s[16:19], 0 offen offset:256
    buffer_store_dword v42, v9, s[16:19], 0 offen offset:512
    buffer_store_dword v43, v9, s[16:19], 0 offen offset:768
.aa_end:
    s_endpgm
.globl attnb_kernel
.p2align 8
.type attnb_kernel,@function
attnb_kernel:
    s_cmp_ge_u32 s2, 256
    s_cbranch_scc1 .ab_end
    s_load_dwordx2 s[4:5], s[0:1], 16
    s_load_dwordx2 s[6:7], s[0:1], 88
    s_lshr_b32 s20, s2, 3
    s_and_b32 s21, s2, 7
    s_mul_i32 s22, s20, 648
    s_waitcnt lgkmcnt(0)
    s_mov_b32 s8, s4
    s_mov_b32 s9, s5
    s_mov_b32 s10, 20736
    s_mov_b32 s11, 0x00020000
    s_add_u32 s12, s6, 3145728
    s_addc_u32 s13, s7, 0
    s_mov_b32 s14, 7077888
    s_mov_b32 s15, 0x00020000
    s_add_u32 s16, s6, 33554432
    s_addc_u32 s17, s7, 0
    s_mov_b32 s18, 1572864
    s_mov_b32 s19, 0x00020000
    s_add_u32 s28, s6, 41943040
    s_addc_u32 s29, s7, 0
    s_mov_b32 s30, 2359296
    s_mov_b32 s31, 0x00020000
    v_cmp_gt_u32 vcc, 162, v0
    s_and_saveexec_b64 s[40:41], vcc
    s_cbranch_execz .L140369560399936w
    v_lshlrev_b32 v1, 2, v0
    buffer_load_dword v2, v1, s[8:11], s22 offen
    s_waitcnt vmcnt(0)
    v_lshlrev_b32 v4, 16, v2
    v_and_b32 v5, 0xffff0000, v2
    v_lshlrev_b32 v1, 3, v0
    ds_write_b64 v1, v[4:5] offset:0
.L140369560399936w:
    s_mov_b64 exec, s[40:41]
    s_lshl_b32 s23, s21, 8
    v_add_u32 v1, s23, v0
    v_mul_u32_u24 v1, 3456, v1
    s_mul_i32 s24, s20, 36
    v_add_u32 v1, s24, v1
    buffer_load_dwordx4 v[4:7], v1, s[12:15], 0 offen
    buffer_load_dwordx4 v[8:11], v1, s[12:15], 0 offen offset:16
    buffer_load_dword v12, v1, s[12:15], 0 offen offset:32
    s_mul_i32 s25, s20, 49152
    v_lshlrev_b32 v2, 2, v0
    s_add_u32 s26, s25, 0
    buffer_load_dword v16, v2, s[16:19], s26 offen
    s_add_u32 s26, s25, 6144
    buffer_load_dword v17, v2, s[16:19], s26 offen
    s_add_u32 s26, s25, 12288
    buffer_load_dword v18, v2, s[16:19], s26 offen
    s_add_u32 s26, s25, 18432
    buffer_load_dword v19, v2, s[16:19], s26 offen
    s_add_u32 s26, s25, 24576
    buffer_load_dword v20, v2, s[16:19], s26 offen
    s_add_u32 s26, s25, 30720
    buffer_load_dword v21, v2, s[16:19], s26 offen
    s_add_u32 s26, s25, 36864
    buffer_load_dword v22, v2, s[16:19], s26 offen
    s_add_u32 s26, s25, 43008
    buffer_load_dword v23, v2, s[16:19], s26 offen
    s_waitcnt vmcnt(0)
    v_add_f32 v16, v16, v17
    v_add_f32 v16, v16, v18
    v_add_f32 v16, v16, v19
    v_add_f32 v16, v16, v20
    v_add_f32 v16, v16, v21
    v_add_f32 v16, v16, v22
    v_add_f32 v16, v16, v23
    v_cvt_pk_bf16_f32 v17, v16, v16
    v_lshlrev_b32 v17, 16, v17
    ds_write_b32 v2, v17 offset:2048
    s_add_u32 s26, s25, 1024
    buffer_load_dword v16, v2, s[16:19], s26 offen
    s_add_u32 s26, s25, 7168
    buffer_load_dword v17, v2, s[16:19], s26 offen
    s_add_u32 s26, s25, 13312
    buffer_load_dword v18, v2, s[16:19], s26 offen
    s_add_u32 s26, s25, 19456
    buffer_load_dword v19, v2, s[16:19], s26 offen
    s_add_u32 s26, s25, 25600
    buffer_load_dword v20, v2, s[16:19], s26 offen
    s_add_u32 s26, s25, 31744
    buffer_load_dword v21, v2, s[16:19], s26 offen
    s_add_u32 s26, s25, 37888
    buffer_load_dword v22, v2, s[16:19], s26 offen
    s_add_u32 s26, s25, 44032
    buffer_load_dword v23, v2, s[16:19], s26 offen
    s_waitcnt vmcnt(0)
    v_add_f32 v16, v16, v17
    v_add_f32 v16, v16, v18
    v_add_f32 v16, v16, v19
    v_add_f32 v16, v16, v20
    v_add_f32 v16, v16, v21
    v_add_f32 v16, v16, v22
    v_add_f32 v16, v16, v23
    v_cvt_pk_bf16_f32 v17, v16, v16
    v_lshlrev_b32 v17, 16, v17
    ds_write_b32 v2, v17 offset:3072
    s_add_u32 s26, s25, 2048
    buffer_load_dword v16, v2, s[16:19], s26 offen
    s_add_u32 s26, s25, 8192
    buffer_load_dword v17, v2, s[16:19], s26 offen
    s_add_u32 s26, s25, 14336
    buffer_load_dword v18, v2, s[16:19], s26 offen
    s_add_u32 s26, s25, 20480
    buffer_load_dword v19, v2, s[16:19], s26 offen
    s_add_u32 s26, s25, 26624
    buffer_load_dword v20, v2, s[16:19], s26 offen
    s_add_u32 s26, s25, 32768
    buffer_load_dword v21, v2, s[16:19], s26 offen
    s_add_u32 s26, s25, 38912
    buffer_load_dword v22, v2, s[16:19], s26 offen
    s_add_u32 s26, s25, 45056
    buffer_load_dword v23, v2, s[16:19], s26 offen
    s_waitcnt vmcnt(0)
    v_add_f32 v16, v16, v17
    v_add_f32 v16, v16, v18
    v_add_f32 v16, v16, v19
    v_add_f32 v16, v16, v20
    v_add_f32 v16, v16, v21
    v_add_f32 v16, v16, v22
    v_add_f32 v16, v16, v23
    v_cvt_pk_bf16_f32 v17, v16, v16
    v_lshlrev_b32 v17, 16, v17
    ds_write_b32 v2, v17 offset:4096
    s_add_u32 s26, s25, 3072
    buffer_load_dword v16, v2, s[16:19], s26 offen
    s_add_u32 s26, s25, 9216
    buffer_load_dword v17, v2, s[16:19], s26 offen
    s_add_u32 s26, s25, 15360
    buffer_load_dword v18, v2, s[16:19], s26 offen
    s_add_u32 s26, s25, 21504
    buffer_load_dword v19, v2, s[16:19], s26 offen
    s_add_u32 s26, s25, 27648
    buffer_load_dword v20, v2, s[16:19], s26 offen
    s_add_u32 s26, s25, 33792
    buffer_load_dword v21, v2, s[16:19], s26 offen
    s_add_u32 s26, s25, 39936
    buffer_load_dword v22, v2, s[16:19], s26 offen
    s_add_u32 s26, s25, 46080
    buffer_load_dword v23, v2, s[16:19], s26 offen
    s_waitcnt vmcnt(0)
    v_add_f32 v16, v16, v17
    v_add_f32 v16, v16, v18
    v_add_f32 v16, v16, v19
    v_add_f32 v16, v16, v20
    v_add_f32 v16, v16, v21
    v_add_f32 v16, v16, v22
    v_add_f32 v16, v16, v23
    v_cvt_pk_bf16_f32 v17, v16, v16
    v_lshlrev_b32 v17, 16, v17
    ds_write_b32 v2, v17 offset:5120
    s_add_u32 s26, s25, 4096
    buffer_load_dword v16, v2, s[16:19], s26 offen
    s_add_u32 s26, s25, 10240
    buffer_load_dword v17, v2, s[16:19], s26 offen
    s_add_u32 s26, s25, 16384
    buffer_load_dword v18, v2, s[16:19], s26 offen
    s_add_u32 s26, s25, 22528
    buffer_load_dword v19, v2, s[16:19], s26 offen
    s_add_u32 s26, s25, 28672
    buffer_load_dword v20, v2, s[16:19], s26 offen
    s_add_u32 s26, s25, 34816
    buffer_load_dword v21, v2, s[16:19], s26 offen
    s_add_u32 s26, s25, 40960
    buffer_load_dword v22, v2, s[16:19], s26 offen
    s_add_u32 s26, s25, 47104
    buffer_load_dword v23, v2, s[16:19], s26 offen
    s_waitcnt vmcnt(0)
    v_add_f32 v16, v16, v17
    v_add_f32 v16, v16, v18
    v_add_f32 v16, v16, v19
    v_add_f32 v16, v16, v20
    v_add_f32 v16, v16, v21
    v_add_f32 v16, v16, v22
    v_add_f32 v16, v16, v23
    v_cvt_pk_bf16_f32 v17, v16, v16
    v_lshlrev_b32 v17, 16, v17
    ds_write_b32 v2, v17 offset:6144
    s_add_u32 s26, s25, 5120
    buffer_load_dword v16, v2, s[16:19], s26 offen
    s_add_u32 s26, s25, 11264
    buffer_load_dword v17, v2, s[16:19], s26 offen
    s_add_u32 s26, s25, 17408
    buffer_load_dword v18, v2, s[16:19], s26 offen
    s_add_u32 s26, s25, 23552
    buffer_load_dword v19, v2, s[16:19], s26 offen
    s_add_u32 s26, s25, 29696
    buffer_load_dword v20, v2, s[16:19], s26 offen
    s_add_u32 s26, s25, 35840
    buffer_load_dword v21, v2, s[16:19], s26 offen
    s_add_u32 s26, s25, 41984
    buffer_load_dword v22, v2, s[16:19], s26 offen
    s_add_u32 s26, s25, 48128
    buffer_load_dword v23, v2, s[16:19], s26 offen
    s_waitcnt vmcnt(0)
    v_add_f32 v16, v16, v17
    v_add_f32 v16, v16, v18
    v_add_f32 v16, v16, v19
    v_add_f32 v16, v16, v20
    v_add_f32 v16, v16, v21
    v_add_f32 v16, v16, v22
    v_add_f32 v16, v16, v23
    v_cvt_pk_bf16_f32 v17, v16, v16
    v_lshlrev_b32 v17, 16, v17
    ds_write_b32 v2, v17 offset:7168
    s_waitcnt vmcnt(0) lgkmcnt(0)
    s_barrier
    v_lshlrev_b32 v80, 16, v4
    v_and_b32 v81, 0xffff0000, v4
    v_lshlrev_b32 v82, 16, v5
    v_and_b32 v83, 0xffff0000, v5
    v_lshlrev_b32 v84, 16, v6
    v_and_b32 v85, 0xffff0000, v6
    v_lshlrev_b32 v86, 16, v7
    v_and_b32 v87, 0xffff0000, v7
    v_lshlrev_b32 v88, 16, v8
    v_and_b32 v89, 0xffff0000, v8
    v_lshlrev_b32 v90, 16, v9
    v_and_b32 v91, 0xffff0000, v9
    v_lshlrev_b32 v92, 16, v10
    v_and_b32 v93, 0xffff0000, v10
    v_lshlrev_b32 v94, 16, v11
    v_and_b32 v95, 0xffff0000, v11
    v_lshlrev_b32 v96, 16, v12
    v_and_b32 v97, 0xffff0000, v12
    v_mov_b32 v196, 0
    ds_read_b64 v[160:161], v196 offset:0
    ds_read_b64 v[162:163], v196 offset:8
    ds_read_b64 v[164:165], v196 offset:16
    ds_read_b64 v[166:167], v196 offset:24
    ds_read_b64 v[168:169], v196 offset:32
    ds_read_b64 v[170:171], v196 offset:40
    ds_read_b64 v[172:173], v196 offset:48
    ds_read_b64 v[174:175], v196 offset:56
    ds_read_b64 v[176:177], v196 offset:64
    ds_read_b64 v[178:179], v196 offset:72
    ds_read_b64 v[180:181], v196 offset:80
    ds_read_b64 v[182:183], v196 offset:88
    ds_read_b64 v[184:185], v196 offset:96
    ds_read_b64 v[186:187], v196 offset:104
    ds_read_b64 v[188:189], v196 offset:112
    ds_read_b64 v[190:191], v196 offset:120
    ds_read_b64 v[192:193], v196 offset:128
    ds_read_b64 v[194:195], v196 offset:136
    s_waitcnt lgkmcnt(9)
    v_mul_f32 v32, v80, v160
    v_mul_f32 v33, v80, v161
    v_mul_f32 v34, v80, v162
    v_mul_f32 v35, v80, v163
    v_mul_f32 v36, v80, v164
    v_mul_f32 v37, v80, v165
    v_mul_f32 v38, v80, v166
    v_mul_f32 v39, v80, v167
    v_mul_f32 v40, v80, v168
    v_mul_f32 v41, v80, v169
    v_mul_f32 v42, v80, v170
    v_mul_f32 v43, v80, v171
    v_mul_f32 v44, v80, v172
    v_mul_f32 v45, v80, v173
    v_mul_f32 v46, v80, v174
    v_mul_f32 v47, v80, v175
    v_mul_f32 v48, v80, v176
    v_mul_f32 v49, v80, v177
    ds_read_b64 v[160:161], v196 offset:144
    ds_read_b64 v[162:163], v196 offset:152
    ds_read_b64 v[164:165], v196 offset:160
    ds_read_b64 v[166:167], v196 offset:168
    ds_read_b64 v[168:169], v196 offset:176
    ds_read_b64 v[170:171], v196 offset:184
    ds_read_b64 v[172:173], v196 offset:192
    ds_read_b64 v[174:175], v196 offset:200
    ds_read_b64 v[176:177], v196 offset:208
    s_waitcnt lgkmcnt(9)
    v_fmac_f32 v32, v81, v178
    v_fmac_f32 v33, v81, v179
    v_fmac_f32 v34, v81, v180
    v_fmac_f32 v35, v81, v181
    v_fmac_f32 v36, v81, v182
    v_fmac_f32 v37, v81, v183
    v_fmac_f32 v38, v81, v184
    v_fmac_f32 v39, v81, v185
    v_fmac_f32 v40, v81, v186
    v_fmac_f32 v41, v81, v187
    v_fmac_f32 v42, v81, v188
    v_fmac_f32 v43, v81, v189
    v_fmac_f32 v44, v81, v190
    v_fmac_f32 v45, v81, v191
    v_fmac_f32 v46, v81, v192
    v_fmac_f32 v47, v81, v193
    v_fmac_f32 v48, v81, v194
    v_fmac_f32 v49, v81, v195
    ds_read_b64 v[178:179], v196 offset:216
    ds_read_b64 v[180:181], v196 offset:224
    ds_read_b64 v[182:183], v196 offset:232
    ds_read_b64 v[184:185], v196 offset:240
    ds_read_b64 v[186:187], v196 offset:248
    ds_read_b64 v[188:189], v196 offset:256
    ds_read_b64 v[190:191], v196 offset:264
    ds_read_b64 v[192:193], v196 offset:272
    ds_read_b64 v[194:195], v196 offset:280
    s_waitcnt lgkmcnt(9)
    v_fmac_f32 v32, v82, v160
    v_fmac_f32 v33, v82, v161
    v_fmac_f32 v34, v82, v162
    v_fmac_f32 v35, v82, v163
    v_fmac_f32 v36, v82, v164
    v_fmac_f32 v37, v82, v165
    v_fmac_f32 v38, v82, v166
    v_fmac_f32 v39, v82, v167
    v_fmac_f32 v40, v82, v168
    v_fmac_f32 v41, v82, v169
    v_fmac_f32 v42, v82, v170
    v_fmac_f32 v43, v82, v171
    v_fmac_f32 v44, v82, v172
    v_fmac_f32 v45, v82, v173
    v_fmac_f32 v46, v82, v174
    v_fmac_f32 v47, v82, v175
    v_fmac_f32 v48, v82, v176
    v_fmac_f32 v49, v82, v177
    ds_read_b64 v[160:161], v196 offset:288
    ds_read_b64 v[162:163], v196 offset:296
    ds_read_b64 v[164:165], v196 offset:304
    ds_read_b64 v[166:167], v196 offset:312
    ds_read_b64 v[168:169], v196 offset:320
    ds_read_b64 v[170:171], v196 offset:328
    ds_read_b64 v[172:173], v196 offset:336
    ds_read_b64 v[174:175], v196 offset:344
    ds_read_b64 v[176:177], v196 offset:352
    s_waitcnt lgkmcnt(9)
    v_fmac_f32 v32, v83, v178
    v_fmac_f32 v33, v83, v179
    v_fmac_f32 v34, v83, v180
    v_fmac_f32 v35, v83, v181
    v_fmac_f32 v36, v83, v182
    v_fmac_f32 v37, v83, v183
    v_fmac_f32 v38, v83, v184
    v_fmac_f32 v39, v83, v185
    v_fmac_f32 v40, v83, v186
    v_fmac_f32 v41, v83, v187
    v_fmac_f32 v42, v83, v188
    v_fmac_f32 v43, v83, v189
    v_fmac_f32 v44, v83, v190
    v_fmac_f32 v45, v83, v191
    v_fmac_f32 v46, v83, v192
    v_fmac_f32 v47, v83, v193
    v_fmac_f32 v48, v83, v194
    v_fmac_f32 v49, v83, v195
    ds_read_b64 v[178:179], v196 offset:360
    ds_read_b64 v[180:181], v196 offset:368
    ds_read_b64 v[182:183], v196 offset:376
    ds_read_b64 v[184:185], v196 offset:384
    ds_read_b64 v[186:187], v196 offset:392
    ds_read_b64 v[188:189], v196 offset:400
    ds_read_b64 v[190:191], v196 offset:408
    ds_read_b64 v[192:193], v196 offset:416
    ds_read_b64 v[194:195], v196 offset:424
    s_waitcnt lgkmcnt(9)
    v_fmac_f32 v32, v84, v160
    v_fmac_f32 v33, v84, v161
    v_fmac_f32 v34, v84, v162
    v_fmac_f32 v35, v84, v163
    v_fmac_f32 v36, v84, v164
    v_fmac_f32 v37, v84, v165
    v_fmac_f32 v38, v84, v166
    v_fmac_f32 v39, v84, v167
    v_fmac_f32 v40, v84, v168
    v_fmac_f32 v41, v84, v169
    v_fmac_f32 v42, v84, v170
    v_fmac_f32 v43, v84, v171
    v_fmac_f32 v44, v84, v172
    v_fmac_f32 v45, v84, v173
    v_fmac_f32 v46, v84, v174
    v_fmac_f32 v47, v84, v175
    v_fmac_f32 v48, v84, v176
    v_fmac_f32 v49, v84, v177
    ds_read_b64 v[160:161], v196 offset:432
    ds_read_b64 v[162:163], v196 offset:440
    ds_read_b64 v[164:165], v196 offset:448
    ds_read_b64 v[166:167], v196 offset:456
    ds_read_b64 v[168:169], v196 offset:464
    ds_read_b64 v[170:171], v196 offset:472
    ds_read_b64 v[172:173], v196 offset:480
    ds_read_b64 v[174:175], v196 offset:488
    ds_read_b64 v[176:177], v196 offset:496
    s_waitcnt lgkmcnt(9)
    v_fmac_f32 v32, v85, v178
    v_fmac_f32 v33, v85, v179
    v_fmac_f32 v34, v85, v180
    v_fmac_f32 v35, v85, v181
    v_fmac_f32 v36, v85, v182
    v_fmac_f32 v37, v85, v183
    v_fmac_f32 v38, v85, v184
    v_fmac_f32 v39, v85, v185
    v_fmac_f32 v40, v85, v186
    v_fmac_f32 v41, v85, v187
    v_fmac_f32 v42, v85, v188
    v_fmac_f32 v43, v85, v189
    v_fmac_f32 v44, v85, v190
    v_fmac_f32 v45, v85, v191
    v_fmac_f32 v46, v85, v192
    v_fmac_f32 v47, v85, v193
    v_fmac_f32 v48, v85, v194
    v_fmac_f32 v49, v85, v195
    ds_read_b64 v[178:179], v196 offset:504
    ds_read_b64 v[180:181], v196 offset:512
    ds_read_b64 v[182:183], v196 offset:520
    ds_read_b64 v[184:185], v196 offset:528
    ds_read_b64 v[186:187], v196 offset:536
    ds_read_b64 v[188:189], v196 offset:544
    ds_read_b64 v[190:191], v196 offset:552
    ds_read_b64 v[192:193], v196 offset:560
    ds_read_b64 v[194:195], v196 offset:568
    s_waitcnt lgkmcnt(9)
    v_fmac_f32 v32, v86, v160
    v_fmac_f32 v33, v86, v161
    v_fmac_f32 v34, v86, v162
    v_fmac_f32 v35, v86, v163
    v_fmac_f32 v36, v86, v164
    v_fmac_f32 v37, v86, v165
    v_fmac_f32 v38, v86, v166
    v_fmac_f32 v39, v86, v167
    v_fmac_f32 v40, v86, v168
    v_fmac_f32 v41, v86, v169
    v_fmac_f32 v42, v86, v170
    v_fmac_f32 v43, v86, v171
    v_fmac_f32 v44, v86, v172
    v_fmac_f32 v45, v86, v173
    v_fmac_f32 v46, v86, v174
    v_fmac_f32 v47, v86, v175
    v_fmac_f32 v48, v86, v176
    v_fmac_f32 v49, v86, v177
    ds_read_b64 v[160:161], v196 offset:576
    ds_read_b64 v[162:163], v196 offset:584
    ds_read_b64 v[164:165], v196 offset:592
    ds_read_b64 v[166:167], v196 offset:600
    ds_read_b64 v[168:169], v196 offset:608
    ds_read_b64 v[170:171], v196 offset:616
    ds_read_b64 v[172:173], v196 offset:624
    ds_read_b64 v[174:175], v196 offset:632
    ds_read_b64 v[176:177], v196 offset:640
    s_waitcnt lgkmcnt(9)
    v_fmac_f32 v32, v87, v178
    v_fmac_f32 v33, v87, v179
    v_fmac_f32 v34, v87, v180
    v_fmac_f32 v35, v87, v181
    v_fmac_f32 v36, v87, v182
    v_fmac_f32 v37, v87, v183
    v_fmac_f32 v38, v87, v184
    v_fmac_f32 v39, v87, v185
    v_fmac_f32 v40, v87, v186
    v_fmac_f32 v41, v87, v187
    v_fmac_f32 v42, v87, v188
    v_fmac_f32 v43, v87, v189
    v_fmac_f32 v44, v87, v190
    v_fmac_f32 v45, v87, v191
    v_fmac_f32 v46, v87, v192
    v_fmac_f32 v47, v87, v193
    v_fmac_f32 v48, v87, v194
    v_fmac_f32 v49, v87, v195
    ds_read_b64 v[178:179], v196 offset:648
    ds_read_b64 v[180:181], v196 offset:656
    ds_read_b64 v[182:183], v196 offset:664
    ds_read_b64 v[184:185], v196 offset:672
    ds_read_b64 v[186:187], v196 offset:680
    ds_read_b64 v[188:189], v196 offset:688
    ds_read_b64 v[190:191], v196 offset:696
    ds_read_b64 v[192:193], v196 offset:704
    ds_read_b64 v[194:195], v196 offset:712
    s_waitcnt lgkmcnt(9)
    v_fmac_f32 v32, v88, v160
    v_fmac_f32 v33, v88, v161
    v_fmac_f32 v34, v88, v162
    v_fmac_f32 v35, v88, v163
    v_fmac_f32 v36, v88, v164
    v_fmac_f32 v37, v88, v165
    v_fmac_f32 v38, v88, v166
    v_fmac_f32 v39, v88, v167
    v_fmac_f32 v40, v88, v168
    v_fmac_f32 v41, v88, v169
    v_fmac_f32 v42, v88, v170
    v_fmac_f32 v43, v88, v171
    v_fmac_f32 v44, v88, v172
    v_fmac_f32 v45, v88, v173
    v_fmac_f32 v46, v88, v174
    v_fmac_f32 v47, v88, v175
    v_fmac_f32 v48, v88, v176
    v_fmac_f32 v49, v88, v177
    ds_read_b64 v[160:161], v196 offset:720
    ds_read_b64 v[162:163], v196 offset:728
    ds_read_b64 v[164:165], v196 offset:736
    ds_read_b64 v[166:167], v196 offset:744
    ds_read_b64 v[168:169], v196 offset:752
    ds_read_b64 v[170:171], v196 offset:760
    ds_read_b64 v[172:173], v196 offset:768
    ds_read_b64 v[174:175], v196 offset:776
    ds_read_b64 v[176:177], v196 offset:784
    s_waitcnt lgkmcnt(9)
    v_fmac_f32 v32, v89, v178
    v_fmac_f32 v33, v89, v179
    v_fmac_f32 v34, v89, v180
    v_fmac_f32 v35, v89, v181
    v_fmac_f32 v36, v89, v182
    v_fmac_f32 v37, v89, v183
    v_fmac_f32 v38, v89, v184
    v_fmac_f32 v39, v89, v185
    v_fmac_f32 v40, v89, v186
    v_fmac_f32 v41, v89, v187
    v_fmac_f32 v42, v89, v188
    v_fmac_f32 v43, v89, v189
    v_fmac_f32 v44, v89, v190
    v_fmac_f32 v45, v89, v191
    v_fmac_f32 v46, v89, v192
    v_fmac_f32 v47, v89, v193
    v_fmac_f32 v48, v89, v194
    v_fmac_f32 v49, v89, v195
    ds_read_b64 v[178:179], v196 offset:792
    ds_read_b64 v[180:181], v196 offset:800
    ds_read_b64 v[182:183], v196 offset:808
    ds_read_b64 v[184:185], v196 offset:816
    ds_read_b64 v[186:187], v196 offset:824
    ds_read_b64 v[188:189], v196 offset:832
    ds_read_b64 v[190:191], v196 offset:840
    ds_read_b64 v[192:193], v196 offset:848
    ds_read_b64 v[194:195], v196 offset:856
    s_waitcnt lgkmcnt(9)
    v_fmac_f32 v32, v90, v160
    v_fmac_f32 v33, v90, v161
    v_fmac_f32 v34, v90, v162
    v_fmac_f32 v35, v90, v163
    v_fmac_f32 v36, v90, v164
    v_fmac_f32 v37, v90, v165
    v_fmac_f32 v38, v90, v166
    v_fmac_f32 v39, v90, v167
    v_fmac_f32 v40, v90, v168
    v_fmac_f32 v41, v90, v169
    v_fmac_f32 v42, v90, v170
    v_fmac_f32 v43, v90, v171
    v_fmac_f32 v44, v90, v172
    v_fmac_f32 v45, v90, v173
    v_fmac_f32 v46, v90, v174
    v_fmac_f32 v47, v90, v175
    v_fmac_f32 v48, v90, v176
    v_fmac_f32 v49, v90, v177
    ds_read_b64 v[160:161], v196 offset:864
    ds_read_b64 v[162:163], v196 offset:872
    ds_read_b64 v[164:165], v196 offset:880
    ds_read_b64 v[166:167], v196 offset:888
    ds_read_b64 v[168:169], v196 offset:896
    ds_read_b64 v[170:171], v196 offset:904
    ds_read_b64 v[172:173], v196 offset:912
    ds_read_b64 v[174:175], v196 offset:920
    ds_read_b64 v[176:177], v196 offset:928
    s_waitcnt lgkmcnt(9)
    v_fmac_f32 v32, v91, v178
    v_fmac_f32 v33, v91, v179
    v_fmac_f32 v34, v91, v180
    v_fmac_f32 v35, v91, v181
    v_fmac_f32 v36, v91, v182
    v_fmac_f32 v37, v91, v183
    v_fmac_f32 v38, v91, v184
    v_fmac_f32 v39, v91, v185
    v_fmac_f32 v40, v91, v186
    v_fmac_f32 v41, v91, v187
    v_fmac_f32 v42, v91, v188
    v_fmac_f32 v43, v91, v189
    v_fmac_f32 v44, v91, v190
    v_fmac_f32 v45, v91, v191
    v_fmac_f32 v46, v91, v192
    v_fmac_f32 v47, v91, v193
    v_fmac_f32 v48, v91, v194
    v_fmac_f32 v49, v91, v195
    ds_read_b64 v[178:179], v196 offset:936
    ds_read_b64 v[180:181], v196 offset:944
    ds_read_b64 v[182:183], v196 offset:952
    ds_read_b64 v[184:185], v196 offset:960
    ds_read_b64 v[186:187], v196 offset:968
    ds_read_b64 v[188:189], v196 offset:976
    ds_read_b64 v[190:191], v196 offset:984
    ds_read_b64 v[192:193], v196 offset:992
    ds_read_b64 v[194:195], v196 offset:1000
    s_waitcnt lgkmcnt(9)
    v_fmac_f32 v32, v92, v160
    v_fmac_f32 v33, v92, v161
    v_fmac_f32 v34, v92, v162
    v_fmac_f32 v35, v92, v163
    v_fmac_f32 v36, v92, v164
    v_fmac_f32 v37, v92, v165
    v_fmac_f32 v38, v92, v166
    v_fmac_f32 v39, v92, v167
    v_fmac_f32 v40, v92, v168
    v_fmac_f32 v41, v92, v169
    v_fmac_f32 v42, v92, v170
    v_fmac_f32 v43, v92, v171
    v_fmac_f32 v44, v92, v172
    v_fmac_f32 v45, v92, v173
    v_fmac_f32 v46, v92, v174
    v_fmac_f32 v47, v92, v175
    v_fmac_f32 v48, v92, v176
    v_fmac_f32 v49, v92, v177
    ds_read_b64 v[160:161], v196 offset:1008
    ds_read_b64 v[162:163], v196 offset:1016
    ds_read_b64 v[164:165], v196 offset:1024
    ds_read_b64 v[166:167], v196 offset:1032
    ds_read_b64 v[168:169], v196 offset:1040
    ds_read_b64 v[170:171], v196 offset:1048
    ds_read_b64 v[172:173], v196 offset:1056
    ds_read_b64 v[174:175], v196 offset:1064
    ds_read_b64 v[176:177], v196 offset:1072
    s_waitcnt lgkmcnt(9)
    v_fmac_f32 v32, v93, v178
    v_fmac_f32 v33, v93, v179
    v_fmac_f32 v34, v93, v180
    v_fmac_f32 v35, v93, v181
    v_fmac_f32 v36, v93, v182
    v_fmac_f32 v37, v93, v183
    v_fmac_f32 v38, v93, v184
    v_fmac_f32 v39, v93, v185
    v_fmac_f32 v40, v93, v186
    v_fmac_f32 v41, v93, v187
    v_fmac_f32 v42, v93, v188
    v_fmac_f32 v43, v93, v189
    v_fmac_f32 v44, v93, v190
    v_fmac_f32 v45, v93, v191
    v_fmac_f32 v46, v93, v192
    v_fmac_f32 v47, v93, v193
    v_fmac_f32 v48, v93, v194
    v_fmac_f32 v49, v93, v195
    ds_read_b64 v[178:179], v196 offset:1080
    ds_read_b64 v[180:181], v196 offset:1088
    ds_read_b64 v[182:183], v196 offset:1096
    ds_read_b64 v[184:185], v196 offset:1104
    ds_read_b64 v[186:187], v196 offset:1112
    ds_read_b64 v[188:189], v196 offset:1120
    ds_read_b64 v[190:191], v196 offset:1128
    ds_read_b64 v[192:193], v196 offset:1136
    ds_read_b64 v[194:195], v196 offset:1144
    s_waitcnt lgkmcnt(9)
    v_fmac_f32 v32, v94, v160
    v_fmac_f32 v33, v94, v161
    v_fmac_f32 v34, v94, v162
    v_fmac_f32 v35, v94, v163
    v_fmac_f32 v36, v94, v164
    v_fmac_f32 v37, v94, v165
    v_fmac_f32 v38, v94, v166
    v_fmac_f32 v39, v94, v167
    v_fmac_f32 v40, v94, v168
    v_fmac_f32 v41, v94, v169
    v_fmac_f32 v42, v94, v170
    v_fmac_f32 v43, v94, v171
    v_fmac_f32 v44, v94, v172
    v_fmac_f32 v45, v94, v173
    v_fmac_f32 v46, v94, v174
    v_fmac_f32 v47, v94, v175
    v_fmac_f32 v48, v94, v176
    v_fmac_f32 v49, v94, v177
    ds_read_b64 v[160:161], v196 offset:1152
    ds_read_b64 v[162:163], v196 offset:1160
    ds_read_b64 v[164:165], v196 offset:1168
    ds_read_b64 v[166:167], v196 offset:1176
    ds_read_b64 v[168:169], v196 offset:1184
    ds_read_b64 v[170:171], v196 offset:1192
    ds_read_b64 v[172:173], v196 offset:1200
    ds_read_b64 v[174:175], v196 offset:1208
    ds_read_b64 v[176:177], v196 offset:1216
    s_waitcnt lgkmcnt(9)
    v_fmac_f32 v32, v95, v178
    v_fmac_f32 v33, v95, v179
    v_fmac_f32 v34, v95, v180
    v_fmac_f32 v35, v95, v181
    v_fmac_f32 v36, v95, v182
    v_fmac_f32 v37, v95, v183
    v_fmac_f32 v38, v95, v184
    v_fmac_f32 v39, v95, v185
    v_fmac_f32 v40, v95, v186
    v_fmac_f32 v41, v95, v187
    v_fmac_f32 v42, v95, v188
    v_fmac_f32 v43, v95, v189
    v_fmac_f32 v44, v95, v190
    v_fmac_f32 v45, v95, v191
    v_fmac_f32 v46, v95, v192
    v_fmac_f32 v47, v95, v193
    v_fmac_f32 v48, v95, v194
    v_fmac_f32 v49, v95, v195
    ds_read_b64 v[178:179], v196 offset:1224
    ds_read_b64 v[180:181], v196 offset:1232
    ds_read_b64 v[182:183], v196 offset:1240
    ds_read_b64 v[184:185], v196 offset:1248
    ds_read_b64 v[186:187], v196 offset:1256
    ds_read_b64 v[188:189], v196 offset:1264
    ds_read_b64 v[190:191], v196 offset:1272
    ds_read_b64 v[192:193], v196 offset:1280
    ds_read_b64 v[194:195], v196 offset:1288
    s_waitcnt lgkmcnt(9)
    v_fmac_f32 v32, v96, v160
    v_fmac_f32 v33, v96, v161
    v_fmac_f32 v34, v96, v162
    v_fmac_f32 v35, v96, v163
    v_fmac_f32 v36, v96, v164
    v_fmac_f32 v37, v96, v165
    v_fmac_f32 v38, v96, v166
    v_fmac_f32 v39, v96, v167
    v_fmac_f32 v40, v96, v168
    v_fmac_f32 v41, v96, v169
    v_fmac_f32 v42, v96, v170
    v_fmac_f32 v43, v96, v171
    v_fmac_f32 v44, v96, v172
    v_fmac_f32 v45, v96, v173
    v_fmac_f32 v46, v96, v174
    v_fmac_f32 v47, v96, v175
    v_fmac_f32 v48, v96, v176
    v_fmac_f32 v49, v96, v177
    s_waitcnt lgkmcnt(0)
    v_fmac_f32 v32, v97, v178
    v_fmac_f32 v33, v97, v179
    v_fmac_f32 v34, v97, v180
    v_fmac_f32 v35, v97, v181
    v_fmac_f32 v36, v97, v182
    v_fmac_f32 v37, v97, v183
    v_fmac_f32 v38, v97, v184
    v_fmac_f32 v39, v97, v185
    v_fmac_f32 v40, v97, v186
    v_fmac_f32 v41, v97, v187
    v_fmac_f32 v42, v97, v188
    v_fmac_f32 v43, v97, v189
    v_fmac_f32 v44, v97, v190
    v_fmac_f32 v45, v97, v191
    v_fmac_f32 v46, v97, v192
    v_fmac_f32 v47, v97, v193
    v_fmac_f32 v48, v97, v194
    v_fmac_f32 v49, v97, v195
    v_cvt_pk_bf16_f32 v160, v32, v33
    v_lshlrev_b32 v32, 16, v160
    v_and_b32 v33, 0xffff0000, v160
    v_cvt_pk_bf16_f32 v160, v34, v35
    v_lshlrev_b32 v34, 16, v160
    v_and_b32 v35, 0xffff0000, v160
    v_cvt_pk_bf16_f32 v160, v36, v37
    v_lshlrev_b32 v36, 16, v160
    v_and_b32 v37, 0xffff0000, v160
    v_cvt_pk_bf16_f32 v160, v38, v39
    v_lshlrev_b32 v38, 16, v160
    v_and_b32 v39, 0xffff0000, v160
    v_cvt_pk_bf16_f32 v160, v40, v41
    v_lshlrev_b32 v40, 16, v160
    v_and_b32 v41, 0xffff0000, v160
    v_cvt_pk_bf16_f32 v160, v42, v43
    v_lshlrev_b32 v42, 16, v160
    v_and_b32 v43, 0xffff0000, v160
    v_cvt_pk_bf16_f32 v160, v44, v45
    v_lshlrev_b32 v44, 16, v160
    v_and_b32 v45, 0xffff0000, v160
    v_cvt_pk_bf16_f32 v160, v46, v47
    v_lshlrev_b32 v46, 16, v160
    v_and_b32 v47, 0xffff0000, v160
    v_cvt_pk_bf16_f32 v160, v48, v49
    v_lshlrev_b32 v48, 16, v160
    v_and_b32 v49, 0xffff0000, v160
    v_max_f32 v160, v32, v33
    v_min_f32 v161, v32, v33
    v_max_f32 v160, v160, v34
    v_min_f32 v161, v161, v34
    v_max_f32 v160, v160, v35
    v_min_f32 v161, v161, v35
    v_max_f32 v160, v160, v36
    v_min_f32 v161, v161, v36
    v_max_f32 v160, v160, v37
    v_min_f32 v161, v161, v37
    v_max_f32 v160, v160, v38
    v_min_f32 v161, v161, v38
    v_max_f32 v160, v160, v39
    v_min_f32 v161, v161, v39
    v_max_f32 v160, v160, v40
    v_min_f32 v161, v161, v40
    v_max_f32 v160, v160, v41
    v_min_f32 v161, v161, v41
    v_max_f32 v160, v160, v42
    v_min_f32 v161, v161, v42
    v_max_f32 v160, v160, v43
    v_min_f32 v161, v161, v43
    v_max_f32 v160, v160, v44
    v_min_f32 v161, v161, v44
    v_max_f32 v160, v160, v45
    v_min_f32 v161, v161, v45
    v_max_f32 v160, v160, v46
    v_min_f32 v161, v161, v46
    v_max_f32 v160, v160, v47
    v_min_f32 v161, v161, v47
    v_max_f32 v160, v160, v48
    v_min_f32 v161, v161, v48
    v_max_f32 v160, v160, v49
    v_min_f32 v161, v161, v49
    v_mul_f32 v160, 0x3fb8aa3b, v160
    v_mul_f32 v161, 0x3fb8aa3b, v161
    v_mov_b32 v162, 0x3fb8aa3b
    v_fma_f32 v80, v32, v162, -v160
    v_fma_f32 v98, -v32, v162, v161
    v_fma_f32 v81, v33, v162, -v160
    v_fma_f32 v99, -v33, v162, v161
    v_fma_f32 v82, v34, v162, -v160
    v_fma_f32 v100, -v34, v162, v161
    v_fma_f32 v83, v35, v162, -v160
    v_fma_f32 v101, -v35, v162, v161
    v_fma_f32 v84, v36, v162, -v160
    v_fma_f32 v102, -v36, v162, v161
    v_fma_f32 v85, v37, v162, -v160
    v_fma_f32 v103, -v37, v162, v161
    v_fma_f32 v86, v38, v162, -v160
    v_fma_f32 v104, -v38, v162, v161
    v_fma_f32 v87, v39, v162, -v160
    v_fma_f32 v105, -v39, v162, v161
    v_fma_f32 v88, v40, v162, -v160
    v_fma_f32 v106, -v40, v162, v161
    v_fma_f32 v89, v41, v162, -v160
    v_fma_f32 v107, -v41, v162, v161
    v_fma_f32 v90, v42, v162, -v160
    v_fma_f32 v108, -v42, v162, v161
    v_fma_f32 v91, v43, v162, -v160
    v_fma_f32 v109, -v43, v162, v161
    v_fma_f32 v92, v44, v162, -v160
    v_fma_f32 v110, -v44, v162, v161
    v_fma_f32 v93, v45, v162, -v160
    v_fma_f32 v111, -v45, v162, v161
    v_fma_f32 v94, v46, v162, -v160
    v_fma_f32 v112, -v46, v162, v161
    v_fma_f32 v95, v47, v162, -v160
    v_fma_f32 v113, -v47, v162, v161
    v_fma_f32 v96, v48, v162, -v160
    v_fma_f32 v114, -v48, v162, v161
    v_fma_f32 v97, v49, v162, -v160
    v_fma_f32 v115, -v49, v162, v161
    v_exp_f32 v80, v80
    v_exp_f32 v81, v81
    v_exp_f32 v82, v82
    v_exp_f32 v83, v83
    v_exp_f32 v84, v84
    v_exp_f32 v85, v85
    v_exp_f32 v86, v86
    v_exp_f32 v87, v87
    v_exp_f32 v88, v88
    v_exp_f32 v89, v89
    v_exp_f32 v90, v90
    v_exp_f32 v91, v91
    v_exp_f32 v92, v92
    v_exp_f32 v93, v93
    v_exp_f32 v94, v94
    v_exp_f32 v95, v95
    v_exp_f32 v96, v96
    v_exp_f32 v97, v97
    v_exp_f32 v98, v98
    v_exp_f32 v99, v99
    v_exp_f32 v100, v100
    v_exp_f32 v101, v101
    v_exp_f32 v102, v102
    v_exp_f32 v103, v103
    v_exp_f32 v104, v104
    v_exp_f32 v105, v105
    v_exp_f32 v106, v106
    v_exp_f32 v107, v107
    v_exp_f32 v108, v108
    v_exp_f32 v109, v109
    v_exp_f32 v110, v110
    v_exp_f32 v111, v111
    v_exp_f32 v112, v112
    v_exp_f32 v113, v113
    v_exp_f32 v114, v114
    v_exp_f32 v115, v115
    s_nop 0
    v_add_f32 v160, v80, v81
    v_add_f32 v161, v98, v99
    v_add_f32 v160, v160, v82
    v_add_f32 v161, v161, v100
    v_add_f32 v160, v160, v83
    v_add_f32 v161, v161, v101
    v_add_f32 v160, v160, v84
    v_add_f32 v161, v161, v102
    v_add_f32 v160, v160, v85
    v_add_f32 v161, v161, v103
    v_add_f32 v160, v160, v86
    v_add_f32 v161, v161, v104
    v_add_f32 v160, v160, v87
    v_add_f32 v161, v161, v105
    v_add_f32 v160, v160, v88
    v_add_f32 v161, v161, v106
    v_add_f32 v160, v160, v89
    v_add_f32 v161, v161, v107
    v_add_f32 v160, v160, v90
    v_add_f32 v161, v161, v108
    v_add_f32 v160, v160, v91
    v_add_f32 v161, v161, v109
    v_add_f32 v160, v160, v92
    v_add_f32 v161, v161, v110
    v_add_f32 v160, v160, v93
    v_add_f32 v161, v161, v111
    v_add_f32 v160, v160, v94
    v_add_f32 v161, v161, v112
    v_add_f32 v160, v160, v95
    v_add_f32 v161, v161, v113
    v_add_f32 v160, v160, v96
    v_add_f32 v161, v161, v114
    v_add_f32 v160, v160, v97
    v_add_f32 v161, v161, v115
    v_rcp_f32 v160, v160
    v_rcp_f32 v161, v161
    s_nop 0
    v_mul_f32 v80, v80, v160
    v_mul_f32 v98, v98, v161
    v_mul_f32 v81, v81, v160
    v_mul_f32 v99, v99, v161
    v_mul_f32 v82, v82, v160
    v_mul_f32 v100, v100, v161
    v_mul_f32 v83, v83, v160
    v_mul_f32 v101, v101, v161
    v_mul_f32 v84, v84, v160
    v_mul_f32 v102, v102, v161
    v_mul_f32 v85, v85, v160
    v_mul_f32 v103, v103, v161
    v_mul_f32 v86, v86, v160
    v_mul_f32 v104, v104, v161
    v_mul_f32 v87, v87, v160
    v_mul_f32 v105, v105, v161
    v_mul_f32 v88, v88, v160
    v_mul_f32 v106, v106, v161
    v_mul_f32 v89, v89, v160
    v_mul_f32 v107, v107, v161
    v_mul_f32 v90, v90, v160
    v_mul_f32 v108, v108, v161
    v_mul_f32 v91, v91, v160
    v_mul_f32 v109, v109, v161
    v_mul_f32 v92, v92, v160
    v_mul_f32 v110, v110, v161
    v_mul_f32 v93, v93, v160
    v_mul_f32 v111, v111, v161
    v_mul_f32 v94, v94, v160
    v_mul_f32 v112, v112, v161
    v_mul_f32 v95, v95, v160
    v_mul_f32 v113, v113, v161
    v_mul_f32 v96, v96, v160
    v_mul_f32 v114, v114, v161
    v_mul_f32 v97, v97, v160
    v_mul_f32 v115, v115, v161
    v_cvt_pk_bf16_f32 v32, v80, v81
    v_lshlrev_b32 v80, 16, v32
    v_and_b32 v81, 0xffff0000, v32
    v_cvt_pk_bf16_f32 v33, v82, v83
    v_lshlrev_b32 v82, 16, v33
    v_and_b32 v83, 0xffff0000, v33
    v_cvt_pk_bf16_f32 v34, v84, v85
    v_lshlrev_b32 v84, 16, v34
    v_and_b32 v85, 0xffff0000, v34
    v_cvt_pk_bf16_f32 v35, v86, v87
    v_lshlrev_b32 v86, 16, v35
    v_and_b32 v87, 0xffff0000, v35
    v_cvt_pk_bf16_f32 v36, v88, v89
    v_lshlrev_b32 v88, 16, v36
    v_and_b32 v89, 0xffff0000, v36
    v_cvt_pk_bf16_f32 v37, v90, v91
    v_lshlrev_b32 v90, 16, v37
    v_and_b32 v91, 0xffff0000, v37
    v_cvt_pk_bf16_f32 v38, v92, v93
    v_lshlrev_b32 v92, 16, v38
    v_and_b32 v93, 0xffff0000, v38
    v_cvt_pk_bf16_f32 v39, v94, v95
    v_lshlrev_b32 v94, 16, v39
    v_and_b32 v95, 0xffff0000, v39
    v_cvt_pk_bf16_f32 v40, v96, v97
    v_lshlrev_b32 v96, 16, v40
    v_and_b32 v97, 0xffff0000, v40
    v_cvt_pk_bf16_f32 v41, v98, v99
    v_lshlrev_b32 v98, 16, v41
    v_and_b32 v99, 0xffff0000, v41
    v_cvt_pk_bf16_f32 v42, v100, v101
    v_lshlrev_b32 v100, 16, v42
    v_and_b32 v101, 0xffff0000, v42
    v_cvt_pk_bf16_f32 v43, v102, v103
    v_lshlrev_b32 v102, 16, v43
    v_and_b32 v103, 0xffff0000, v43
    v_cvt_pk_bf16_f32 v44, v104, v105
    v_lshlrev_b32 v104, 16, v44
    v_and_b32 v105, 0xffff0000, v44
    v_cvt_pk_bf16_f32 v45, v106, v107
    v_lshlrev_b32 v106, 16, v45
    v_and_b32 v107, 0xffff0000, v45
    v_cvt_pk_bf16_f32 v46, v108, v109
    v_lshlrev_b32 v108, 16, v46
    v_and_b32 v109, 0xffff0000, v46
    v_cvt_pk_bf16_f32 v47, v110, v111
    v_lshlrev_b32 v110, 16, v47
    v_and_b32 v111, 0xffff0000, v47
    v_cvt_pk_bf16_f32 v48, v112, v113
    v_lshlrev_b32 v112, 16, v48
    v_and_b32 v113, 0xffff0000, v48
    v_cvt_pk_bf16_f32 v49, v114, v115
    v_lshlrev_b32 v114, 16, v49
    v_and_b32 v115, 0xffff0000, v49
    v_mov_b32 v3, 0
    ds_read_b128 v[120:123], v3 offset:2048
    ds_read_b128 v[124:127], v3 offset:2064
    ds_read_b128 v[128:131], v3 offset:2080
    ds_read_b128 v[132:135], v3 offset:2096
    ds_read_b128 v[136:139], v3 offset:2112
    ds_read_b128 v[140:143], v3 offset:2128
    ds_read_b128 v[144:147], v3 offset:2144
    ds_read_b128 v[148:151], v3 offset:2160
    ds_read_b128 v[152:155], v3 offset:2176
    ds_read_b128 v[156:159], v3 offset:2304
    ds_read_b128 v[160:163], v3 offset:2320
    ds_read_b128 v[164:167], v3 offset:2336
    ds_read_b128 v[168:171], v3 offset:2352
    ds_read_b128 v[172:175], v3 offset:2368
    ds_read_b128 v[176:179], v3 offset:2384
    ds_read_b128 v[180:183], v3 offset:2400
    ds_read_b128 v[184:187], v3 offset:2416
    ds_read_b128 v[188:191], v3 offset:2432
    s_waitcnt lgkmcnt(9)
    v_mul_f32 v32, v80, v120
    v_fmac_f32 v32, v81, v121
    v_fmac_f32 v32, v82, v122
    v_fmac_f32 v32, v83, v123
    v_fmac_f32 v32, v84, v124
    v_fmac_f32 v32, v85, v125
    v_fmac_f32 v32, v86, v126
    v_fmac_f32 v32, v87, v127
    v_fmac_f32 v32, v88, v128
    v_fmac_f32 v32, v89, v129
    v_fmac_f32 v32, v90, v130
    v_fmac_f32 v32, v91, v131
    v_fmac_f32 v32, v92, v132
    v_fmac_f32 v32, v93, v133
    v_fmac_f32 v32, v94, v134
    v_fmac_f32 v32, v95, v135
    v_fmac_f32 v32, v96, v136
    v_fmac_f32 v32, v97, v137
    v_fmac_f32 v32, v98, v138
    v_fmac_f32 v32, v99, v139
    v_fmac_f32 v32, v100, v140
    v_fmac_f32 v32, v101, v141
    v_fmac_f32 v32, v102, v142
    v_fmac_f32 v32, v103, v143
    v_fmac_f32 v32, v104, v144
    v_fmac_f32 v32, v105, v145
    v_fmac_f32 v32, v106, v146
    v_fmac_f32 v32, v107, v147
    v_fmac_f32 v32, v108, v148
    v_fmac_f32 v32, v109, v149
    v_fmac_f32 v32, v110, v150
    v_fmac_f32 v32, v111, v151
    v_fmac_f32 v32, v112, v152
    v_fmac_f32 v32, v113, v153
    v_fmac_f32 v32, v114, v154
    v_fmac_f32 v32, v115, v155
    ds_read_b128 v[120:123], v3 offset:2560
    ds_read_b128 v[124:127], v3 offset:2576
    ds_read_b128 v[128:131], v3 offset:2592
    ds_read_b128 v[132:135], v3 offset:2608
    ds_read_b128 v[136:139], v3 offset:2624
    ds_read_b128 v[140:143], v3 offset:2640
    ds_read_b128 v[144:147], v3 offset:2656
    ds_read_b128 v[148:151], v3 offset:2672
    ds_read_b128 v[152:155], v3 offset:2688
    s_waitcnt lgkmcnt(9)
    v_mul_f32 v33, v80, v156
    v_fmac_f32 v33, v81, v157
    v_fmac_f32 v33, v82, v158
    v_fmac_f32 v33, v83, v159
    v_fmac_f32 v33, v84, v160
    v_fmac_f32 v33, v85, v161
    v_fmac_f32 v33, v86, v162
    v_fmac_f32 v33, v87, v163
    v_fmac_f32 v33, v88, v164
    v_fmac_f32 v33, v89, v165
    v_fmac_f32 v33, v90, v166
    v_fmac_f32 v33, v91, v167
    v_fmac_f32 v33, v92, v168
    v_fmac_f32 v33, v93, v169
    v_fmac_f32 v33, v94, v170
    v_fmac_f32 v33, v95, v171
    v_fmac_f32 v33, v96, v172
    v_fmac_f32 v33, v97, v173
    v_fmac_f32 v33, v98, v174
    v_fmac_f32 v33, v99, v175
    v_fmac_f32 v33, v100, v176
    v_fmac_f32 v33, v101, v177
    v_fmac_f32 v33, v102, v178
    v_fmac_f32 v33, v103, v179
    v_fmac_f32 v33, v104, v180
    v_fmac_f32 v33, v105, v181
    v_fmac_f32 v33, v106, v182
    v_fmac_f32 v33, v107, v183
    v_fmac_f32 v33, v108, v184
    v_fmac_f32 v33, v109, v185
    v_fmac_f32 v33, v110, v186
    v_fmac_f32 v33, v111, v187
    v_fmac_f32 v33, v112, v188
    v_fmac_f32 v33, v113, v189
    v_fmac_f32 v33, v114, v190
    v_fmac_f32 v33, v115, v191
    ds_read_b128 v[156:159], v3 offset:2816
    ds_read_b128 v[160:163], v3 offset:2832
    ds_read_b128 v[164:167], v3 offset:2848
    ds_read_b128 v[168:171], v3 offset:2864
    ds_read_b128 v[172:175], v3 offset:2880
    ds_read_b128 v[176:179], v3 offset:2896
    ds_read_b128 v[180:183], v3 offset:2912
    ds_read_b128 v[184:187], v3 offset:2928
    ds_read_b128 v[188:191], v3 offset:2944
    s_waitcnt lgkmcnt(9)
    v_mul_f32 v34, v80, v120
    v_fmac_f32 v34, v81, v121
    v_fmac_f32 v34, v82, v122
    v_fmac_f32 v34, v83, v123
    v_fmac_f32 v34, v84, v124
    v_fmac_f32 v34, v85, v125
    v_fmac_f32 v34, v86, v126
    v_fmac_f32 v34, v87, v127
    v_fmac_f32 v34, v88, v128
    v_fmac_f32 v34, v89, v129
    v_fmac_f32 v34, v90, v130
    v_fmac_f32 v34, v91, v131
    v_fmac_f32 v34, v92, v132
    v_fmac_f32 v34, v93, v133
    v_fmac_f32 v34, v94, v134
    v_fmac_f32 v34, v95, v135
    v_fmac_f32 v34, v96, v136
    v_fmac_f32 v34, v97, v137
    v_fmac_f32 v34, v98, v138
    v_fmac_f32 v34, v99, v139
    v_fmac_f32 v34, v100, v140
    v_fmac_f32 v34, v101, v141
    v_fmac_f32 v34, v102, v142
    v_fmac_f32 v34, v103, v143
    v_fmac_f32 v34, v104, v144
    v_fmac_f32 v34, v105, v145
    v_fmac_f32 v34, v106, v146
    v_fmac_f32 v34, v107, v147
    v_fmac_f32 v34, v108, v148
    v_fmac_f32 v34, v109, v149
    v_fmac_f32 v34, v110, v150
    v_fmac_f32 v34, v111, v151
    v_fmac_f32 v34, v112, v152
    v_fmac_f32 v34, v113, v153
    v_fmac_f32 v34, v114, v154
    v_fmac_f32 v34, v115, v155
    ds_read_b128 v[120:123], v3 offset:3072
    ds_read_b128 v[124:127], v3 offset:3088
    ds_read_b128 v[128:131], v3 offset:3104
    ds_read_b128 v[132:135], v3 offset:3120
    ds_read_b128 v[136:139], v3 offset:3136
    ds_read_b128 v[140:143], v3 offset:3152
    ds_read_b128 v[144:147], v3 offset:3168
    ds_read_b128 v[148:151], v3 offset:3184
    ds_read_b128 v[152:155], v3 offset:3200
    s_waitcnt lgkmcnt(9)
    v_mul_f32 v35, v80, v156
    v_fmac_f32 v35, v81, v157
    v_fmac_f32 v35, v82, v158
    v_fmac_f32 v35, v83, v159
    v_fmac_f32 v35, v84, v160
    v_fmac_f32 v35, v85, v161
    v_fmac_f32 v35, v86, v162
    v_fmac_f32 v35, v87, v163
    v_fmac_f32 v35, v88, v164
    v_fmac_f32 v35, v89, v165
    v_fmac_f32 v35, v90, v166
    v_fmac_f32 v35, v91, v167
    v_fmac_f32 v35, v92, v168
    v_fmac_f32 v35, v93, v169
    v_fmac_f32 v35, v94, v170
    v_fmac_f32 v35, v95, v171
    v_fmac_f32 v35, v96, v172
    v_fmac_f32 v35, v97, v173
    v_fmac_f32 v35, v98, v174
    v_fmac_f32 v35, v99, v175
    v_fmac_f32 v35, v100, v176
    v_fmac_f32 v35, v101, v177
    v_fmac_f32 v35, v102, v178
    v_fmac_f32 v35, v103, v179
    v_fmac_f32 v35, v104, v180
    v_fmac_f32 v35, v105, v181
    v_fmac_f32 v35, v106, v182
    v_fmac_f32 v35, v107, v183
    v_fmac_f32 v35, v108, v184
    v_fmac_f32 v35, v109, v185
    v_fmac_f32 v35, v110, v186
    v_fmac_f32 v35, v111, v187
    v_fmac_f32 v35, v112, v188
    v_fmac_f32 v35, v113, v189
    v_fmac_f32 v35, v114, v190
    v_fmac_f32 v35, v115, v191
    ds_read_b128 v[156:159], v3 offset:3328
    ds_read_b128 v[160:163], v3 offset:3344
    ds_read_b128 v[164:167], v3 offset:3360
    ds_read_b128 v[168:171], v3 offset:3376
    ds_read_b128 v[172:175], v3 offset:3392
    ds_read_b128 v[176:179], v3 offset:3408
    ds_read_b128 v[180:183], v3 offset:3424
    ds_read_b128 v[184:187], v3 offset:3440
    ds_read_b128 v[188:191], v3 offset:3456
    s_waitcnt lgkmcnt(9)
    v_mul_f32 v36, v80, v120
    v_fmac_f32 v36, v81, v121
    v_fmac_f32 v36, v82, v122
    v_fmac_f32 v36, v83, v123
    v_fmac_f32 v36, v84, v124
    v_fmac_f32 v36, v85, v125
    v_fmac_f32 v36, v86, v126
    v_fmac_f32 v36, v87, v127
    v_fmac_f32 v36, v88, v128
    v_fmac_f32 v36, v89, v129
    v_fmac_f32 v36, v90, v130
    v_fmac_f32 v36, v91, v131
    v_fmac_f32 v36, v92, v132
    v_fmac_f32 v36, v93, v133
    v_fmac_f32 v36, v94, v134
    v_fmac_f32 v36, v95, v135
    v_fmac_f32 v36, v96, v136
    v_fmac_f32 v36, v97, v137
    v_fmac_f32 v36, v98, v138
    v_fmac_f32 v36, v99, v139
    v_fmac_f32 v36, v100, v140
    v_fmac_f32 v36, v101, v141
    v_fmac_f32 v36, v102, v142
    v_fmac_f32 v36, v103, v143
    v_fmac_f32 v36, v104, v144
    v_fmac_f32 v36, v105, v145
    v_fmac_f32 v36, v106, v146
    v_fmac_f32 v36, v107, v147
    v_fmac_f32 v36, v108, v148
    v_fmac_f32 v36, v109, v149
    v_fmac_f32 v36, v110, v150
    v_fmac_f32 v36, v111, v151
    v_fmac_f32 v36, v112, v152
    v_fmac_f32 v36, v113, v153
    v_fmac_f32 v36, v114, v154
    v_fmac_f32 v36, v115, v155
    ds_read_b128 v[120:123], v3 offset:3584
    ds_read_b128 v[124:127], v3 offset:3600
    ds_read_b128 v[128:131], v3 offset:3616
    ds_read_b128 v[132:135], v3 offset:3632
    ds_read_b128 v[136:139], v3 offset:3648
    ds_read_b128 v[140:143], v3 offset:3664
    ds_read_b128 v[144:147], v3 offset:3680
    ds_read_b128 v[148:151], v3 offset:3696
    ds_read_b128 v[152:155], v3 offset:3712
    s_waitcnt lgkmcnt(9)
    v_mul_f32 v37, v80, v156
    v_fmac_f32 v37, v81, v157
    v_fmac_f32 v37, v82, v158
    v_fmac_f32 v37, v83, v159
    v_fmac_f32 v37, v84, v160
    v_fmac_f32 v37, v85, v161
    v_fmac_f32 v37, v86, v162
    v_fmac_f32 v37, v87, v163
    v_fmac_f32 v37, v88, v164
    v_fmac_f32 v37, v89, v165
    v_fmac_f32 v37, v90, v166
    v_fmac_f32 v37, v91, v167
    v_fmac_f32 v37, v92, v168
    v_fmac_f32 v37, v93, v169
    v_fmac_f32 v37, v94, v170
    v_fmac_f32 v37, v95, v171
    v_fmac_f32 v37, v96, v172
    v_fmac_f32 v37, v97, v173
    v_fmac_f32 v37, v98, v174
    v_fmac_f32 v37, v99, v175
    v_fmac_f32 v37, v100, v176
    v_fmac_f32 v37, v101, v177
    v_fmac_f32 v37, v102, v178
    v_fmac_f32 v37, v103, v179
    v_fmac_f32 v37, v104, v180
    v_fmac_f32 v37, v105, v181
    v_fmac_f32 v37, v106, v182
    v_fmac_f32 v37, v107, v183
    v_fmac_f32 v37, v108, v184
    v_fmac_f32 v37, v109, v185
    v_fmac_f32 v37, v110, v186
    v_fmac_f32 v37, v111, v187
    v_fmac_f32 v37, v112, v188
    v_fmac_f32 v37, v113, v189
    v_fmac_f32 v37, v114, v190
    v_fmac_f32 v37, v115, v191
    ds_read_b128 v[156:159], v3 offset:3840
    ds_read_b128 v[160:163], v3 offset:3856
    ds_read_b128 v[164:167], v3 offset:3872
    ds_read_b128 v[168:171], v3 offset:3888
    ds_read_b128 v[172:175], v3 offset:3904
    ds_read_b128 v[176:179], v3 offset:3920
    ds_read_b128 v[180:183], v3 offset:3936
    ds_read_b128 v[184:187], v3 offset:3952
    ds_read_b128 v[188:191], v3 offset:3968
    s_waitcnt lgkmcnt(9)
    v_mul_f32 v38, v80, v120
    v_fmac_f32 v38, v81, v121
    v_fmac_f32 v38, v82, v122
    v_fmac_f32 v38, v83, v123
    v_fmac_f32 v38, v84, v124
    v_fmac_f32 v38, v85, v125
    v_fmac_f32 v38, v86, v126
    v_fmac_f32 v38, v87, v127
    v_fmac_f32 v38, v88, v128
    v_fmac_f32 v38, v89, v129
    v_fmac_f32 v38, v90, v130
    v_fmac_f32 v38, v91, v131
    v_fmac_f32 v38, v92, v132
    v_fmac_f32 v38, v93, v133
    v_fmac_f32 v38, v94, v134
    v_fmac_f32 v38, v95, v135
    v_fmac_f32 v38, v96, v136
    v_fmac_f32 v38, v97, v137
    v_fmac_f32 v38, v98, v138
    v_fmac_f32 v38, v99, v139
    v_fmac_f32 v38, v100, v140
    v_fmac_f32 v38, v101, v141
    v_fmac_f32 v38, v102, v142
    v_fmac_f32 v38, v103, v143
    v_fmac_f32 v38, v104, v144
    v_fmac_f32 v38, v105, v145
    v_fmac_f32 v38, v106, v146
    v_fmac_f32 v38, v107, v147
    v_fmac_f32 v38, v108, v148
    v_fmac_f32 v38, v109, v149
    v_fmac_f32 v38, v110, v150
    v_fmac_f32 v38, v111, v151
    v_fmac_f32 v38, v112, v152
    v_fmac_f32 v38, v113, v153
    v_fmac_f32 v38, v114, v154
    v_fmac_f32 v38, v115, v155
    ds_read_b128 v[120:123], v3 offset:4096
    ds_read_b128 v[124:127], v3 offset:4112
    ds_read_b128 v[128:131], v3 offset:4128
    ds_read_b128 v[132:135], v3 offset:4144
    ds_read_b128 v[136:139], v3 offset:4160
    ds_read_b128 v[140:143], v3 offset:4176
    ds_read_b128 v[144:147], v3 offset:4192
    ds_read_b128 v[148:151], v3 offset:4208
    ds_read_b128 v[152:155], v3 offset:4224
    s_waitcnt lgkmcnt(9)
    v_mul_f32 v39, v80, v156
    v_fmac_f32 v39, v81, v157
    v_fmac_f32 v39, v82, v158
    v_fmac_f32 v39, v83, v159
    v_fmac_f32 v39, v84, v160
    v_fmac_f32 v39, v85, v161
    v_fmac_f32 v39, v86, v162
    v_fmac_f32 v39, v87, v163
    v_fmac_f32 v39, v88, v164
    v_fmac_f32 v39, v89, v165
    v_fmac_f32 v39, v90, v166
    v_fmac_f32 v39, v91, v167
    v_fmac_f32 v39, v92, v168
    v_fmac_f32 v39, v93, v169
    v_fmac_f32 v39, v94, v170
    v_fmac_f32 v39, v95, v171
    v_fmac_f32 v39, v96, v172
    v_fmac_f32 v39, v97, v173
    v_fmac_f32 v39, v98, v174
    v_fmac_f32 v39, v99, v175
    v_fmac_f32 v39, v100, v176
    v_fmac_f32 v39, v101, v177
    v_fmac_f32 v39, v102, v178
    v_fmac_f32 v39, v103, v179
    v_fmac_f32 v39, v104, v180
    v_fmac_f32 v39, v105, v181
    v_fmac_f32 v39, v106, v182
    v_fmac_f32 v39, v107, v183
    v_fmac_f32 v39, v108, v184
    v_fmac_f32 v39, v109, v185
    v_fmac_f32 v39, v110, v186
    v_fmac_f32 v39, v111, v187
    v_fmac_f32 v39, v112, v188
    v_fmac_f32 v39, v113, v189
    v_fmac_f32 v39, v114, v190
    v_fmac_f32 v39, v115, v191
    ds_read_b128 v[156:159], v3 offset:4352
    ds_read_b128 v[160:163], v3 offset:4368
    ds_read_b128 v[164:167], v3 offset:4384
    ds_read_b128 v[168:171], v3 offset:4400
    ds_read_b128 v[172:175], v3 offset:4416
    ds_read_b128 v[176:179], v3 offset:4432
    ds_read_b128 v[180:183], v3 offset:4448
    ds_read_b128 v[184:187], v3 offset:4464
    ds_read_b128 v[188:191], v3 offset:4480
    s_waitcnt lgkmcnt(9)
    v_mul_f32 v40, v80, v120
    v_fmac_f32 v40, v81, v121
    v_fmac_f32 v40, v82, v122
    v_fmac_f32 v40, v83, v123
    v_fmac_f32 v40, v84, v124
    v_fmac_f32 v40, v85, v125
    v_fmac_f32 v40, v86, v126
    v_fmac_f32 v40, v87, v127
    v_fmac_f32 v40, v88, v128
    v_fmac_f32 v40, v89, v129
    v_fmac_f32 v40, v90, v130
    v_fmac_f32 v40, v91, v131
    v_fmac_f32 v40, v92, v132
    v_fmac_f32 v40, v93, v133
    v_fmac_f32 v40, v94, v134
    v_fmac_f32 v40, v95, v135
    v_fmac_f32 v40, v96, v136
    v_fmac_f32 v40, v97, v137
    v_fmac_f32 v40, v98, v138
    v_fmac_f32 v40, v99, v139
    v_fmac_f32 v40, v100, v140
    v_fmac_f32 v40, v101, v141
    v_fmac_f32 v40, v102, v142
    v_fmac_f32 v40, v103, v143
    v_fmac_f32 v40, v104, v144
    v_fmac_f32 v40, v105, v145
    v_fmac_f32 v40, v106, v146
    v_fmac_f32 v40, v107, v147
    v_fmac_f32 v40, v108, v148
    v_fmac_f32 v40, v109, v149
    v_fmac_f32 v40, v110, v150
    v_fmac_f32 v40, v111, v151
    v_fmac_f32 v40, v112, v152
    v_fmac_f32 v40, v113, v153
    v_fmac_f32 v40, v114, v154
    v_fmac_f32 v40, v115, v155
    ds_read_b128 v[120:123], v3 offset:4608
    ds_read_b128 v[124:127], v3 offset:4624
    ds_read_b128 v[128:131], v3 offset:4640
    ds_read_b128 v[132:135], v3 offset:4656
    ds_read_b128 v[136:139], v3 offset:4672
    ds_read_b128 v[140:143], v3 offset:4688
    ds_read_b128 v[144:147], v3 offset:4704
    ds_read_b128 v[148:151], v3 offset:4720
    ds_read_b128 v[152:155], v3 offset:4736
    s_waitcnt lgkmcnt(9)
    v_mul_f32 v41, v80, v156
    v_fmac_f32 v41, v81, v157
    v_fmac_f32 v41, v82, v158
    v_fmac_f32 v41, v83, v159
    v_fmac_f32 v41, v84, v160
    v_fmac_f32 v41, v85, v161
    v_fmac_f32 v41, v86, v162
    v_fmac_f32 v41, v87, v163
    v_fmac_f32 v41, v88, v164
    v_fmac_f32 v41, v89, v165
    v_fmac_f32 v41, v90, v166
    v_fmac_f32 v41, v91, v167
    v_fmac_f32 v41, v92, v168
    v_fmac_f32 v41, v93, v169
    v_fmac_f32 v41, v94, v170
    v_fmac_f32 v41, v95, v171
    v_fmac_f32 v41, v96, v172
    v_fmac_f32 v41, v97, v173
    v_fmac_f32 v41, v98, v174
    v_fmac_f32 v41, v99, v175
    v_fmac_f32 v41, v100, v176
    v_fmac_f32 v41, v101, v177
    v_fmac_f32 v41, v102, v178
    v_fmac_f32 v41, v103, v179
    v_fmac_f32 v41, v104, v180
    v_fmac_f32 v41, v105, v181
    v_fmac_f32 v41, v106, v182
    v_fmac_f32 v41, v107, v183
    v_fmac_f32 v41, v108, v184
    v_fmac_f32 v41, v109, v185
    v_fmac_f32 v41, v110, v186
    v_fmac_f32 v41, v111, v187
    v_fmac_f32 v41, v112, v188
    v_fmac_f32 v41, v113, v189
    v_fmac_f32 v41, v114, v190
    v_fmac_f32 v41, v115, v191
    ds_read_b128 v[156:159], v3 offset:4864
    ds_read_b128 v[160:163], v3 offset:4880
    ds_read_b128 v[164:167], v3 offset:4896
    ds_read_b128 v[168:171], v3 offset:4912
    ds_read_b128 v[172:175], v3 offset:4928
    ds_read_b128 v[176:179], v3 offset:4944
    ds_read_b128 v[180:183], v3 offset:4960
    ds_read_b128 v[184:187], v3 offset:4976
    ds_read_b128 v[188:191], v3 offset:4992
    s_waitcnt lgkmcnt(9)
    v_mul_f32 v42, v80, v120
    v_fmac_f32 v42, v81, v121
    v_fmac_f32 v42, v82, v122
    v_fmac_f32 v42, v83, v123
    v_fmac_f32 v42, v84, v124
    v_fmac_f32 v42, v85, v125
    v_fmac_f32 v42, v86, v126
    v_fmac_f32 v42, v87, v127
    v_fmac_f32 v42, v88, v128
    v_fmac_f32 v42, v89, v129
    v_fmac_f32 v42, v90, v130
    v_fmac_f32 v42, v91, v131
    v_fmac_f32 v42, v92, v132
    v_fmac_f32 v42, v93, v133
    v_fmac_f32 v42, v94, v134
    v_fmac_f32 v42, v95, v135
    v_fmac_f32 v42, v96, v136
    v_fmac_f32 v42, v97, v137
    v_fmac_f32 v42, v98, v138
    v_fmac_f32 v42, v99, v139
    v_fmac_f32 v42, v100, v140
    v_fmac_f32 v42, v101, v141
    v_fmac_f32 v42, v102, v142
    v_fmac_f32 v42, v103, v143
    v_fmac_f32 v42, v104, v144
    v_fmac_f32 v42, v105, v145
    v_fmac_f32 v42, v106, v146
    v_fmac_f32 v42, v107, v147
    v_fmac_f32 v42, v108, v148
    v_fmac_f32 v42, v109, v149
    v_fmac_f32 v42, v110, v150
    v_fmac_f32 v42, v111, v151
    v_fmac_f32 v42, v112, v152
    v_fmac_f32 v42, v113, v153
    v_fmac_f32 v42, v114, v154
    v_fmac_f32 v42, v115, v155
    ds_read_b128 v[120:123], v3 offset:5120
    ds_read_b128 v[124:127], v3 offset:5136
    ds_read_b128 v[128:131], v3 offset:5152
    ds_read_b128 v[132:135], v3 offset:5168
    ds_read_b128 v[136:139], v3 offset:5184
    ds_read_b128 v[140:143], v3 offset:5200
    ds_read_b128 v[144:147], v3 offset:5216
    ds_read_b128 v[148:151], v3 offset:5232
    ds_read_b128 v[152:155], v3 offset:5248
    s_waitcnt lgkmcnt(9)
    v_mul_f32 v43, v80, v156
    v_fmac_f32 v43, v81, v157
    v_fmac_f32 v43, v82, v158
    v_fmac_f32 v43, v83, v159
    v_fmac_f32 v43, v84, v160
    v_fmac_f32 v43, v85, v161
    v_fmac_f32 v43, v86, v162
    v_fmac_f32 v43, v87, v163
    v_fmac_f32 v43, v88, v164
    v_fmac_f32 v43, v89, v165
    v_fmac_f32 v43, v90, v166
    v_fmac_f32 v43, v91, v167
    v_fmac_f32 v43, v92, v168
    v_fmac_f32 v43, v93, v169
    v_fmac_f32 v43, v94, v170
    v_fmac_f32 v43, v95, v171
    v_fmac_f32 v43, v96, v172
    v_fmac_f32 v43, v97, v173
    v_fmac_f32 v43, v98, v174
    v_fmac_f32 v43, v99, v175
    v_fmac_f32 v43, v100, v176
    v_fmac_f32 v43, v101, v177
    v_fmac_f32 v43, v102, v178
    v_fmac_f32 v43, v103, v179
    v_fmac_f32 v43, v104, v180
    v_fmac_f32 v43, v105, v181
    v_fmac_f32 v43, v106, v182
    v_fmac_f32 v43, v107, v183
    v_fmac_f32 v43, v108, v184
    v_fmac_f32 v43, v109, v185
    v_fmac_f32 v43, v110, v186
    v_fmac_f32 v43, v111, v187
    v_fmac_f32 v43, v112, v188
    v_fmac_f32 v43, v113, v189
    v_fmac_f32 v43, v114, v190
    v_fmac_f32 v43, v115, v191
    ds_read_b128 v[156:159], v3 offset:5376
    ds_read_b128 v[160:163], v3 offset:5392
    ds_read_b128 v[164:167], v3 offset:5408
    ds_read_b128 v[168:171], v3 offset:5424
    ds_read_b128 v[172:175], v3 offset:5440
    ds_read_b128 v[176:179], v3 offset:5456
    ds_read_b128 v[180:183], v3 offset:5472
    ds_read_b128 v[184:187], v3 offset:5488
    ds_read_b128 v[188:191], v3 offset:5504
    s_waitcnt lgkmcnt(9)
    v_mul_f32 v44, v80, v120
    v_fmac_f32 v44, v81, v121
    v_fmac_f32 v44, v82, v122
    v_fmac_f32 v44, v83, v123
    v_fmac_f32 v44, v84, v124
    v_fmac_f32 v44, v85, v125
    v_fmac_f32 v44, v86, v126
    v_fmac_f32 v44, v87, v127
    v_fmac_f32 v44, v88, v128
    v_fmac_f32 v44, v89, v129
    v_fmac_f32 v44, v90, v130
    v_fmac_f32 v44, v91, v131
    v_fmac_f32 v44, v92, v132
    v_fmac_f32 v44, v93, v133
    v_fmac_f32 v44, v94, v134
    v_fmac_f32 v44, v95, v135
    v_fmac_f32 v44, v96, v136
    v_fmac_f32 v44, v97, v137
    v_fmac_f32 v44, v98, v138
    v_fmac_f32 v44, v99, v139
    v_fmac_f32 v44, v100, v140
    v_fmac_f32 v44, v101, v141
    v_fmac_f32 v44, v102, v142
    v_fmac_f32 v44, v103, v143
    v_fmac_f32 v44, v104, v144
    v_fmac_f32 v44, v105, v145
    v_fmac_f32 v44, v106, v146
    v_fmac_f32 v44, v107, v147
    v_fmac_f32 v44, v108, v148
    v_fmac_f32 v44, v109, v149
    v_fmac_f32 v44, v110, v150
    v_fmac_f32 v44, v111, v151
    v_fmac_f32 v44, v112, v152
    v_fmac_f32 v44, v113, v153
    v_fmac_f32 v44, v114, v154
    v_fmac_f32 v44, v115, v155
    ds_read_b128 v[120:123], v3 offset:5632
    ds_read_b128 v[124:127], v3 offset:5648
    ds_read_b128 v[128:131], v3 offset:5664
    ds_read_b128 v[132:135], v3 offset:5680
    ds_read_b128 v[136:139], v3 offset:5696
    ds_read_b128 v[140:143], v3 offset:5712
    ds_read_b128 v[144:147], v3 offset:5728
    ds_read_b128 v[148:151], v3 offset:5744
    ds_read_b128 v[152:155], v3 offset:5760
    s_waitcnt lgkmcnt(9)
    v_mul_f32 v45, v80, v156
    v_fmac_f32 v45, v81, v157
    v_fmac_f32 v45, v82, v158
    v_fmac_f32 v45, v83, v159
    v_fmac_f32 v45, v84, v160
    v_fmac_f32 v45, v85, v161
    v_fmac_f32 v45, v86, v162
    v_fmac_f32 v45, v87, v163
    v_fmac_f32 v45, v88, v164
    v_fmac_f32 v45, v89, v165
    v_fmac_f32 v45, v90, v166
    v_fmac_f32 v45, v91, v167
    v_fmac_f32 v45, v92, v168
    v_fmac_f32 v45, v93, v169
    v_fmac_f32 v45, v94, v170
    v_fmac_f32 v45, v95, v171
    v_fmac_f32 v45, v96, v172
    v_fmac_f32 v45, v97, v173
    v_fmac_f32 v45, v98, v174
    v_fmac_f32 v45, v99, v175
    v_fmac_f32 v45, v100, v176
    v_fmac_f32 v45, v101, v177
    v_fmac_f32 v45, v102, v178
    v_fmac_f32 v45, v103, v179
    v_fmac_f32 v45, v104, v180
    v_fmac_f32 v45, v105, v181
    v_fmac_f32 v45, v106, v182
    v_fmac_f32 v45, v107, v183
    v_fmac_f32 v45, v108, v184
    v_fmac_f32 v45, v109, v185
    v_fmac_f32 v45, v110, v186
    v_fmac_f32 v45, v111, v187
    v_fmac_f32 v45, v112, v188
    v_fmac_f32 v45, v113, v189
    v_fmac_f32 v45, v114, v190
    v_fmac_f32 v45, v115, v191
    ds_read_b128 v[156:159], v3 offset:5888
    ds_read_b128 v[160:163], v3 offset:5904
    ds_read_b128 v[164:167], v3 offset:5920
    ds_read_b128 v[168:171], v3 offset:5936
    ds_read_b128 v[172:175], v3 offset:5952
    ds_read_b128 v[176:179], v3 offset:5968
    ds_read_b128 v[180:183], v3 offset:5984
    ds_read_b128 v[184:187], v3 offset:6000
    ds_read_b128 v[188:191], v3 offset:6016
    s_waitcnt lgkmcnt(9)
    v_mul_f32 v46, v80, v120
    v_fmac_f32 v46, v81, v121
    v_fmac_f32 v46, v82, v122
    v_fmac_f32 v46, v83, v123
    v_fmac_f32 v46, v84, v124
    v_fmac_f32 v46, v85, v125
    v_fmac_f32 v46, v86, v126
    v_fmac_f32 v46, v87, v127
    v_fmac_f32 v46, v88, v128
    v_fmac_f32 v46, v89, v129
    v_fmac_f32 v46, v90, v130
    v_fmac_f32 v46, v91, v131
    v_fmac_f32 v46, v92, v132
    v_fmac_f32 v46, v93, v133
    v_fmac_f32 v46, v94, v134
    v_fmac_f32 v46, v95, v135
    v_fmac_f32 v46, v96, v136
    v_fmac_f32 v46, v97, v137
    v_fmac_f32 v46, v98, v138
    v_fmac_f32 v46, v99, v139
    v_fmac_f32 v46, v100, v140
    v_fmac_f32 v46, v101, v141
    v_fmac_f32 v46, v102, v142
    v_fmac_f32 v46, v103, v143
    v_fmac_f32 v46, v104, v144
    v_fmac_f32 v46, v105, v145
    v_fmac_f32 v46, v106, v146
    v_fmac_f32 v46, v107, v147
    v_fmac_f32 v46, v108, v148
    v_fmac_f32 v46, v109, v149
    v_fmac_f32 v46, v110, v150
    v_fmac_f32 v46, v111, v151
    v_fmac_f32 v46, v112, v152
    v_fmac_f32 v46, v113, v153
    v_fmac_f32 v46, v114, v154
    v_fmac_f32 v46, v115, v155
    ds_read_b128 v[120:123], v3 offset:6144
    ds_read_b128 v[124:127], v3 offset:6160
    ds_read_b128 v[128:131], v3 offset:6176
    ds_read_b128 v[132:135], v3 offset:6192
    ds_read_b128 v[136:139], v3 offset:6208
    ds_read_b128 v[140:143], v3 offset:6224
    ds_read_b128 v[144:147], v3 offset:6240
    ds_read_b128 v[148:151], v3 offset:6256
    ds_read_b128 v[152:155], v3 offset:6272
    s_waitcnt lgkmcnt(9)
    v_mul_f32 v47, v80, v156
    v_fmac_f32 v47, v81, v157
    v_fmac_f32 v47, v82, v158
    v_fmac_f32 v47, v83, v159
    v_fmac_f32 v47, v84, v160
    v_fmac_f32 v47, v85, v161
    v_fmac_f32 v47, v86, v162
    v_fmac_f32 v47, v87, v163
    v_fmac_f32 v47, v88, v164
    v_fmac_f32 v47, v89, v165
    v_fmac_f32 v47, v90, v166
    v_fmac_f32 v47, v91, v167
    v_fmac_f32 v47, v92, v168
    v_fmac_f32 v47, v93, v169
    v_fmac_f32 v47, v94, v170
    v_fmac_f32 v47, v95, v171
    v_fmac_f32 v47, v96, v172
    v_fmac_f32 v47, v97, v173
    v_fmac_f32 v47, v98, v174
    v_fmac_f32 v47, v99, v175
    v_fmac_f32 v47, v100, v176
    v_fmac_f32 v47, v101, v177
    v_fmac_f32 v47, v102, v178
    v_fmac_f32 v47, v103, v179
    v_fmac_f32 v47, v104, v180
    v_fmac_f32 v47, v105, v181
    v_fmac_f32 v47, v106, v182
    v_fmac_f32 v47, v107, v183
    v_fmac_f32 v47, v108, v184
    v_fmac_f32 v47, v109, v185
    v_fmac_f32 v47, v110, v186
    v_fmac_f32 v47, v111, v187
    v_fmac_f32 v47, v112, v188
    v_fmac_f32 v47, v113, v189
    v_fmac_f32 v47, v114, v190
    v_fmac_f32 v47, v115, v191
    ds_read_b128 v[156:159], v3 offset:6400
    ds_read_b128 v[160:163], v3 offset:6416
    ds_read_b128 v[164:167], v3 offset:6432
    ds_read_b128 v[168:171], v3 offset:6448
    ds_read_b128 v[172:175], v3 offset:6464
    ds_read_b128 v[176:179], v3 offset:6480
    ds_read_b128 v[180:183], v3 offset:6496
    ds_read_b128 v[184:187], v3 offset:6512
    ds_read_b128 v[188:191], v3 offset:6528
    s_waitcnt lgkmcnt(9)
    v_mul_f32 v48, v80, v120
    v_fmac_f32 v48, v81, v121
    v_fmac_f32 v48, v82, v122
    v_fmac_f32 v48, v83, v123
    v_fmac_f32 v48, v84, v124
    v_fmac_f32 v48, v85, v125
    v_fmac_f32 v48, v86, v126
    v_fmac_f32 v48, v87, v127
    v_fmac_f32 v48, v88, v128
    v_fmac_f32 v48, v89, v129
    v_fmac_f32 v48, v90, v130
    v_fmac_f32 v48, v91, v131
    v_fmac_f32 v48, v92, v132
    v_fmac_f32 v48, v93, v133
    v_fmac_f32 v48, v94, v134
    v_fmac_f32 v48, v95, v135
    v_fmac_f32 v48, v96, v136
    v_fmac_f32 v48, v97, v137
    v_fmac_f32 v48, v98, v138
    v_fmac_f32 v48, v99, v139
    v_fmac_f32 v48, v100, v140
    v_fmac_f32 v48, v101, v141
    v_fmac_f32 v48, v102, v142
    v_fmac_f32 v48, v103, v143
    v_fmac_f32 v48, v104, v144
    v_fmac_f32 v48, v105, v145
    v_fmac_f32 v48, v106, v146
    v_fmac_f32 v48, v107, v147
    v_fmac_f32 v48, v108, v148
    v_fmac_f32 v48, v109, v149
    v_fmac_f32 v48, v110, v150
    v_fmac_f32 v48, v111, v151
    v_fmac_f32 v48, v112, v152
    v_fmac_f32 v48, v113, v153
    v_fmac_f32 v48, v114, v154
    v_fmac_f32 v48, v115, v155
    ds_read_b128 v[120:123], v3 offset:6656
    ds_read_b128 v[124:127], v3 offset:6672
    ds_read_b128 v[128:131], v3 offset:6688
    ds_read_b128 v[132:135], v3 offset:6704
    ds_read_b128 v[136:139], v3 offset:6720
    ds_read_b128 v[140:143], v3 offset:6736
    ds_read_b128 v[144:147], v3 offset:6752
    ds_read_b128 v[148:151], v3 offset:6768
    ds_read_b128 v[152:155], v3 offset:6784
    s_waitcnt lgkmcnt(9)
    v_mul_f32 v49, v80, v156
    v_fmac_f32 v49, v81, v157
    v_fmac_f32 v49, v82, v158
    v_fmac_f32 v49, v83, v159
    v_fmac_f32 v49, v84, v160
    v_fmac_f32 v49, v85, v161
    v_fmac_f32 v49, v86, v162
    v_fmac_f32 v49, v87, v163
    v_fmac_f32 v49, v88, v164
    v_fmac_f32 v49, v89, v165
    v_fmac_f32 v49, v90, v166
    v_fmac_f32 v49, v91, v167
    v_fmac_f32 v49, v92, v168
    v_fmac_f32 v49, v93, v169
    v_fmac_f32 v49, v94, v170
    v_fmac_f32 v49, v95, v171
    v_fmac_f32 v49, v96, v172
    v_fmac_f32 v49, v97, v173
    v_fmac_f32 v49, v98, v174
    v_fmac_f32 v49, v99, v175
    v_fmac_f32 v49, v100, v176
    v_fmac_f32 v49, v101, v177
    v_fmac_f32 v49, v102, v178
    v_fmac_f32 v49, v103, v179
    v_fmac_f32 v49, v104, v180
    v_fmac_f32 v49, v105, v181
    v_fmac_f32 v49, v106, v182
    v_fmac_f32 v49, v107, v183
    v_fmac_f32 v49, v108, v184
    v_fmac_f32 v49, v109, v185
    v_fmac_f32 v49, v110, v186
    v_fmac_f32 v49, v111, v187
    v_fmac_f32 v49, v112, v188
    v_fmac_f32 v49, v113, v189
    v_fmac_f32 v49, v114, v190
    v_fmac_f32 v49, v115, v191
    s_waitcnt lgkmcnt(0)
    v_mul_f32 v50, v80, v120
    v_fmac_f32 v50, v81, v121
    v_fmac_f32 v50, v82, v122
    v_fmac_f32 v50, v83, v123
    v_fmac_f32 v50, v84, v124
    v_fmac_f32 v50, v85, v125
    v_fmac_f32 v50, v86, v126
    v_fmac_f32 v50, v87, v127
    v_fmac_f32 v50, v88, v128
    v_fmac_f32 v50, v89, v129
    v_fmac_f32 v50, v90, v130
    v_fmac_f32 v50, v91, v131
    v_fmac_f32 v50, v92, v132
    v_fmac_f32 v50, v93, v133
    v_fmac_f32 v50, v94, v134
    v_fmac_f32 v50, v95, v135
    v_fmac_f32 v50, v96, v136
    v_fmac_f32 v50, v97, v137
    v_fmac_f32 v50, v98, v138
    v_fmac_f32 v50, v99, v139
    v_fmac_f32 v50, v100, v140
    v_fmac_f32 v50, v101, v141
    v_fmac_f32 v50, v102, v142
    v_fmac_f32 v50, v103, v143
    v_fmac_f32 v50, v104, v144
    v_fmac_f32 v50, v105, v145
    v_fmac_f32 v50, v106, v146
    v_fmac_f32 v50, v107, v147
    v_fmac_f32 v50, v108, v148
    v_fmac_f32 v50, v109, v149
    v_fmac_f32 v50, v110, v150
    v_fmac_f32 v50, v111, v151
    v_fmac_f32 v50, v112, v152
    v_fmac_f32 v50, v113, v153
    v_fmac_f32 v50, v114, v154
    v_fmac_f32 v50, v115, v155
    v_cvt_pk_bf16_f32 v52, v50, v50
    v_lshlrev_b32 v52, 16, v52
    v_add_f32 v52, 0x358637bd, v52
    v_cvt_pk_bf16_f32 v52, v52, v52
    v_lshlrev_b32 v52, 16, v52
    v_rcp_f32 v52, v52
    s_nop 0
    v_cvt_pk_bf16_f32 v53, v32, v33
    v_lshlrev_b32 v32, 16, v53
    v_and_b32 v33, 0xffff0000, v53
    v_mul_f32 v32, v32, v52
    v_mul_f32 v33, v33, v52
    v_cvt_pk_bf16_f32 v60, v32, v33
    v_cvt_pk_bf16_f32 v53, v34, v35
    v_lshlrev_b32 v34, 16, v53
    v_and_b32 v35, 0xffff0000, v53
    v_mul_f32 v34, v34, v52
    v_mul_f32 v35, v35, v52
    v_cvt_pk_bf16_f32 v61, v34, v35
    v_cvt_pk_bf16_f32 v53, v36, v37
    v_lshlrev_b32 v36, 16, v53
    v_and_b32 v37, 0xffff0000, v53
    v_mul_f32 v36, v36, v52
    v_mul_f32 v37, v37, v52
    v_cvt_pk_bf16_f32 v62, v36, v37
    v_cvt_pk_bf16_f32 v53, v38, v39
    v_lshlrev_b32 v38, 16, v53
    v_and_b32 v39, 0xffff0000, v53
    v_mul_f32 v38, v38, v52
    v_mul_f32 v39, v39, v52
    v_cvt_pk_bf16_f32 v63, v38, v39
    v_cvt_pk_bf16_f32 v53, v40, v41
    v_lshlrev_b32 v40, 16, v53
    v_and_b32 v41, 0xffff0000, v53
    v_mul_f32 v40, v40, v52
    v_mul_f32 v41, v41, v52
    v_cvt_pk_bf16_f32 v64, v40, v41
    v_cvt_pk_bf16_f32 v53, v42, v43
    v_lshlrev_b32 v42, 16, v53
    v_and_b32 v43, 0xffff0000, v53
    v_mul_f32 v42, v42, v52
    v_mul_f32 v43, v43, v52
    v_cvt_pk_bf16_f32 v65, v42, v43
    v_cvt_pk_bf16_f32 v53, v44, v45
    v_lshlrev_b32 v44, 16, v53
    v_and_b32 v45, 0xffff0000, v53
    v_mul_f32 v44, v44, v52
    v_mul_f32 v45, v45, v52
    v_cvt_pk_bf16_f32 v66, v44, v45
    v_cvt_pk_bf16_f32 v53, v46, v47
    v_lshlrev_b32 v46, 16, v53
    v_and_b32 v47, 0xffff0000, v53
    v_mul_f32 v46, v46, v52
    v_mul_f32 v47, v47, v52
    v_cvt_pk_bf16_f32 v67, v46, v47
    v_cvt_pk_bf16_f32 v53, v48, v49
    v_lshlrev_b32 v48, 16, v53
    v_and_b32 v49, 0xffff0000, v53
    v_mul_f32 v48, v48, v52
    v_mul_f32 v49, v49, v52
    v_cvt_pk_bf16_f32 v68, v48, v49
    v_add_u32 v1, s23, v0
    v_mul_u32_u24 v1, 1152, v1
    v_add_u32 v1, s24, v1
    buffer_store_dwordx4 v[60:63], v1, s[28:31], 0 offen
    buffer_store_dwordx4 v[64:67], v1, s[28:31], 0 offen offset:16
    buffer_store_dword v68, v1, s[28:31], 0 offen offset:32
.ab_end:
    s_endpgm
.globl gemm5_kernel
.p2align 8
.type gemm5_kernel,@function
gemm5_kernel:
    s_cmp_ge_u32 s2, 240
    s_cbranch_scc1 .g5_end
    s_load_dwordx2 s[4:5], s[0:1], 56
    s_load_dwordx2 s[6:7], s[0:1], 24
    s_load_dwordx2 s[8:9], s[0:1], 88
    s_and_b32 s3, s2, 7
    s_mul_i32 s3, s3, 30
    s_lshr_b32 s12, s2, 3
    s_add_u32 s3, s3, s12
    s_mul_i32 s12, s3, 171
    s_lshr_b32 s12, s12, 13
    s_mul_i32 s13, s12, 48
    s_sub_u32 s13, s3, s13
    s_mul_i32 s14, s13, 86
    s_lshr_b32 s14, s14, 8
    s_mul_i32 s15, s14, 3
    s_sub_u32 s15, s13, s15
    s_lshl_b32 s40, s14, 7
    s_mul_i32 s41, s15, 192
    s_waitcnt lgkmcnt(0)
    s_mul_i32 s50, s12, 4718592
    s_cmp_ge_u32 s12, 4
    s_cbranch_scc1 .g5_wo
    s_add_u32 s16, s8, 10485760
    s_addc_u32 s17, s9, 0
    s_mov_b32 s18, 18874368
    s_mov_b32 s19, 0x00020000
    s_mov_b32 s20, s4
    s_mov_b32 s21, s5
    s_mov_b32 s22, 5308416
    s_mov_b32 s23, 0x00020000
    s_mul_i32 s44, s12, 2304
    s_mul_i32 s45, s12, 1327104
    v_and_b32 v17, 63, v0
    v_lshrrev_b32 v18, 6, v0
    v_mul_u32_u24 v19, 128, v18
    v_add_u32 v19, v19, v17
    v_lshrrev_b32 v20, 2, v19
    v_and_b32 v19, 3, v19
    v_bfe_u32 v21, v20, 2, 2
    v_xor_b32 v19, v19, v21
    v_add_u32 v20, s40, v20
    s_mov_b32 s42, 9216
    v_mul_lo_u32 v20, v20, s42
    v_lshl_add_u32 v1, v19, 4, v20
    v_mul_u32_u24 v19, 128, v18
    v_add_u32 v19, v19, v17
    v_add_u32 v19, 64, v19
    v_lshrrev_b32 v20, 2, v19
    v_and_b32 v19, 3, v19
    v_bfe_u32 v21, v20, 2, 2
    v_xor_b32 v19, v19, v21
    v_add_u32 v20, s40, v20
    s_mov_b32 s42, 9216
    v_mul_lo_u32 v20, v20, s42
    v_lshl_add_u32 v2, v19, 4, v20
    v_mul_u32_u24 v19, 192, v18
    v_add_u32 v19, v19, v17
    s_mov_b32 s42, 683
    v_mul_lo_u32 v20, v19, s42
    v_lshrrev_b32 v20, 14, v20
    v_mul_u32_u24 v21, 24, v20
    v_sub_u32 v19, v19, v21
    v_bfe_u32 v21, v20, 1, 1
    v_lshlrev_b32 v21, 2, v21
    v_xor_b32 v19, v19, v21
    s_mov_b32 s42, 1152
    v_mul_lo_u32 v20, v20, s42
    v_lshl_add_u32 v20, v19, 4, v20
    s_lshl_b32 s42, s41, 1
    v_add_u32 v4, s42, v20
    v_mul_u32_u24 v19, 192, v18
    v_add_u32 v19, v19, v17
    v_add_u32 v19, 64, v19
    s_mov_b32 s42, 683
    v_mul_lo_u32 v20, v19, s42
    v_lshrrev_b32 v20, 14, v20
    v_mul_u32_u24 v21, 24, v20
    v_sub_u32 v19, v19, v21
    v_bfe_u32 v21, v20, 1, 1
    v_lshlrev_b32 v21, 2, v21
    v_xor_b32 v19, v19, v21
    s_mov_b32 s42, 1152
    v_mul_lo_u32 v20, v20, s42
    v_lshl_add_u32 v20, v19, 4, v20
    s_lshl_b32 s42, s41, 1
    v_add_u32 v5, s42, v20
    v_mul_u32_u24 v19, 192, v18
    v_add_u32 v19, v19, v17
    v_add_u32 v19, 128, v19
    s_mov_b32 s42, 683
    v_mul_lo_u32 v20, v19, s42
    v_lshrrev_b32 v20, 14, v20
    v_mul_u32_u24 v21, 24, v20
    v_sub_u32 v19, v19, v21
    v_bfe_u32 v21, v20, 1, 1
    v_lshlrev_b32 v21, 2, v21
    v_xor_b32 v19, v19, v21
    s_mov_b32 s42, 1152
    v_mul_lo_u32 v20, v20, s42
    v_lshl_add_u32 v20, v19, 4, v20
    s_lshl_b32 s42, s41, 1
    v_add_u32 v6, s42, v20
    s_nop 0
    v_readfirstlane_b32 s47, v18
    s_mul_i32 s48, s47, 2048
    s_mul_i32 s49, s47, 3072
    s_add_u32 s49, s49, 8192
    v_lshrrev_b32 v19, 1, v18
    v_mul_u32_u24 v19, 64, v19
    v_and_b32 v20, 31, v17
    v_add_u32 v19, v19, v20
    v_bfe_u32 v20, v19, 2, 2
    v_lshrrev_b32 v21, 5, v17
    v_add_u32 v22, 0, v21
    v_xor_b32 v22, v22, v20
    v_lshlrev_b32 v22, 4, v22
    v_mul_u32_u24 v7, 64, v19
    v_add_u32 v7, v7, v22
    v_add_u32 v22, 2, v21
    v_xor_b32 v22, v22, v20
    v_lshlrev_b32 v22, 4, v22
    v_mul_u32_u24 v8, 64, v19
    v_add_u32 v8, v8, v22
    v_lshrrev_b32 v19, 5, v17
    v_lshlrev_b32 v19, 3, v19
    v_bfe_u32 v20, v17, 2, 2
    v_add_u32 v19, v19, v20
    v_mul_u32_u24 v19, 384, v19
    v_bfe_u32 v20, v17, 4, 1
    v_lshl_add_u32 v19, v20, 5, v19
    v_and_b32 v20, 3, v17
    v_lshl_add_u32 v19, v20, 3, v19
    v_add_u32 v19, 8192, v19
    v_and_b32 v20, 1, v18
    v_mul_u32_u24 v20, 3, v20
    v_bfe_u32 v21, v17, 3, 1
    v_add_u32 v22, 0, v20
    v_xor_b32 v22, v22, v21
    v_lshl_add_u32 v9, v22, 6, v19
    v_add_u32 v22, 1, v20
    v_xor_b32 v22, v22, v21
    v_lshl_add_u32 v10, v22, 6, v19
    v_add_u32 v22, 2, v20
    v_xor_b32 v22, v22, v21
    v_lshl_add_u32 v11, v22, 6, v19
    v_add_u32 v160, 32768, v7
    v_add_u32 v161, 32768, v8
    v_add_u32 v162, 32768, v9
    v_add_u32 v163, 32768, v10
    v_add_u32 v164, 32768, v11
    v_add_u32 v165, 65536, v7
    v_add_u32 v166, 65536, v8
    v_add_u32 v167, 65536, v9
    v_add_u32 v168, 65536, v10
    v_add_u32 v169, 65536, v11
    v_add_u32 v170, 98304, v7
    v_add_u32 v171, 98304, v8
    v_add_u32 v172, 98304, v9
    v_add_u32 v173, 98304, v10
    v_add_u32 v174, 98304, v11
    v_mov_b32 v64, 0
    v_mov_b32 v65, 0
    v_mov_b32 v66, 0
    v_mov_b32 v67, 0
    v_mov_b32 v68, 0
    v_mov_b32 v69, 0
    v_mov_b32 v70, 0
    v_mov_b32 v71, 0
    v_mov_b32 v72, 0
    v_mov_b32 v73, 0
    v_mov_b32 v74, 0
    v_mov_b32 v75, 0
    v_mov_b32 v76, 0
    v_mov_b32 v77, 0
    v_mov_b32 v78, 0
    v_mov_b32 v79, 0
    v_mov_b32 v80, 0
    v_mov_b32 v81, 0
    v_mov_b32 v82, 0
    v_mov_b32 v83, 0
    v_mov_b32 v84, 0
    v_mov_b32 v85, 0
    v_mov_b32 v86, 0
    v_mov_b32 v87, 0
    v_mov_b32 v88, 0
    v_mov_b32 v89, 0
    v_mov_b32 v90, 0
    v_mov_b32 v91, 0
    v_mov_b32 v92, 0
    v_mov_b32 v93, 0
    v_mov_b32 v94, 0
    v_mov_b32 v95, 0
    v_mov_b32 v96, 0
    v_mov_b32 v97, 0
    v_mov_b32 v98, 0
    v_mov_b32 v99, 0
    v_mov_b32 v100, 0
    v_mov_b32 v101, 0
    v_mov_b32 v102, 0
    v_mov_b32 v103, 0
    v_mov_b32 v104, 0
    v_mov_b32 v105, 0
    v_mov_b32 v106, 0
    v_mov_b32 v107, 0
    v_mov_b32 v108, 0
    v_mov_b32 v109, 0
    v_mov_b32 v110, 0
    v_mov_b32 v111, 0
    v_mov_b32 v112, 0
    v_mov_b32 v113, 0
    v_mov_b32 v114, 0
    v_mov_b32 v115, 0
    v_mov_b32 v116, 0
    v_mov_b32 v117, 0
    v_mov_b32 v118, 0
    v_mov_b32 v119, 0
    v_mov_b32 v120, 0
    v_mov_b32 v121, 0
    v_mov_b32 v122, 0
    v_mov_b32 v123, 0
    v_mov_b32 v124, 0
    v_mov_b32 v125, 0
    v_mov_b32 v126, 0
    v_mov_b32 v127, 0
    v_mov_b32 v128, 0
    v_mov_b32 v129, 0
    v_mov_b32 v130, 0
    v_mov_b32 v131, 0
    v_mov_b32 v132, 0
    v_mov_b32 v133, 0
    v_mov_b32 v134, 0
    v_mov_b32 v135, 0
    v_mov_b32 v136, 0
    v_mov_b32 v137, 0
    v_mov_b32 v138, 0
    v_mov_b32 v139, 0
    v_mov_b32 v140, 0
    v_mov_b32 v141, 0
    v_mov_b32 v142, 0
    v_mov_b32 v143, 0
    v_mov_b32 v144, 0
    v_mov_b32 v145, 0
    v_mov_b32 v146, 0
    v_mov_b32 v147, 0
    v_mov_b32 v148, 0
    v_mov_b32 v149, 0
    v_mov_b32 v150, 0
    v_mov_b32 v151, 0
    v_mov_b32 v152, 0
    v_mov_b32 v153, 0
    v_mov_b32 v154, 0
    v_mov_b32 v155, 0
    v_mov_b32 v156, 0
    v_mov_b32 v157, 0
    v_mov_b32 v158, 0
    v_mov_b32 v159, 0
    s_add_u32 m0, s48, 0
    s_nop 0
    buffer_load_dwordx4 v1, s[16:19], s44 offen lds
    s_add_u32 m0, s48, 1024
    s_nop 0
    buffer_load_dwordx4 v2, s[16:19], s44 offen lds
    s_add_u32 m0, s49, 0
    s_nop 0
    buffer_load_dwordx4 v4, s[20:23], s45 offen lds
    s_add_u32 m0, s49, 1024
    s_nop 0
    buffer_load_dwordx4 v5, s[20:23], s45 offen lds
    s_add_u32 m0, s49, 2048
    s_nop 0
    buffer_load_dwordx4 v6, s[20:23], s45 offen lds
    s_add_u32 s44, s44, 64
    s_add_u32 s45, s45, 36864
    s_add_u32 m0, s48, 20480
    s_nop 0
    buffer_load_dwordx4 v1, s[16:19], s44 offen lds
    s_add_u32 m0, s48, 21504
    s_nop 0
    buffer_load_dwordx4 v2, s[16:19], s44 offen lds
    s_add_u32 m0, s49, 20480
    s_nop 0
    buffer_load_dwordx4 v4, s[20:23], s45 offen lds
    s_add_u32 m0, s49, 21504
    s_nop 0
    buffer_load_dwordx4 v5, s[20:23], s45 offen lds
    s_add_u32 m0, s49, 22528
    s_nop 0
    buffer_load_dwordx4 v6, s[20:23], s45 offen lds
    s_add_u32 s44, s44, 64
    s_add_u32 s45, s45, 36864
    s_add_u32 m0, s48, 40960
    s_nop 0
    buffer_load_dwordx4 v1, s[16:19], s44 offen lds
    s_add_u32 m0, s48, 41984
    s_nop 0
    buffer_load_dwordx4 v2, s[16:19], s44 offen lds
    s_add_u32 m0, s49, 40960
    s_nop 0
    buffer_load_dwordx4 v4, s[20:23], s45 offen lds
    s_add_u32 m0, s49, 41984
    s_nop 0
    buffer_load_dwordx4 v5, s[20:23], s45 offen lds
    s_add_u32 m0, s49, 43008
    s_nop 0
    buffer_load_dwordx4 v6, s[20:23], s45 offen lds
    s_add_u32 s44, s44, 64
    s_add_u32 s45, s45, 36864
    s_add_u32 m0, s48, 61440
    s_nop 0
    buffer_load_dwordx4 v1, s[16:19], s44 offen lds
    s_add_u32 m0, s48, 62464
    s_nop 0
    buffer_load_dwordx4 v2, s[16:19], s44 offen lds
    s_add_u32 m0, s49, 61440
    s_nop 0
    buffer_load_dwordx4 v4, s[20:23], s45 offen lds
    s_add_u32 m0, s49, 62464
    s_nop 0
    buffer_load_dwordx4 v5, s[20:23], s45 offen lds
    s_add_u32 m0, s49, 63488
    s_nop 0
    buffer_load_dwordx4 v6, s[20:23], s45 offen lds
    s_add_u32 s44, s44, 64
    s_add_u32 s45, s45, 36864
    s_add_u32 m0, s48, 81920
    s_nop 0
    buffer_load_dwordx4 v1, s[16:19], s44 offen lds
    s_add_u32 m0, s48, 82944
    s_nop 0
    buffer_load_dwordx4 v2, s[16:19], s44 offen lds
    s_add_u32 m0, s49, 81920
    s_nop 0
    buffer_load_dwordx4 v4, s[20:23], s45 offen lds
    s_add_u32 m0, s49, 82944
    s_nop 0
    buffer_load_dwordx4 v5, s[20:23], s45 offen lds
    s_add_u32 m0, s49, 83968
    s_nop 0
    buffer_load_dwordx4 v6, s[20:23], s45 offen lds
    s_add_u32 s44, s44, 64
    s_add_u32 s45, s45, 36864
    s_add_u32 m0, s48, 102400
    s_nop 0
    buffer_load_dwordx4 v1, s[16:19], s44 offen lds
    s_add_u32 m0, s48, 103424
    s_nop 0
    buffer_load_dwordx4 v2, s[16:19], s44 offen lds
    s_add_u32 m0, s49, 102400
    s_nop 0
    buffer_load_dwordx4 v4, s[20:23], s45 offen lds
    s_add_u32 m0, s49, 103424
    s_nop 0
    buffer_load_dwordx4 v5, s[20:23], s45 offen lds
    s_add_u32 m0, s49, 104448
    s_nop 0
    buffer_load_dwordx4 v6, s[20:23], s45 offen lds
    s_add_u32 s44, s44, 64
    s_add_u32 s45, s45, 36864
    s_waitcnt vmcnt(25)
    s_barrier
    ds_read_b128 v[24:27], v7 offset:0
    ds_read_b128 v[28:31], v7 offset:2048
    ds_read_b64_tr_b16 v[32:33], v9 offset:0
    ds_read_b64_tr_b16 v[34:35], v9 offset:1536
    ds_read_b64_tr_b16 v[36:37], v10 offset:0
    ds_read_b64_tr_b16 v[38:39], v10 offset:1536
    ds_read_b64_tr_b16 v[40:41], v11 offset:0
    ds_read_b64_tr_b16 v[42:43], v11 offset:1536
    s_mov_b32 s46, 4
.g5a_loop:
    s_waitcnt lgkmcnt(0)
    v_mfma_f32_32x32x16_bf16 v[64:79], v[32:35], v[24:27], v[64:79]
    ds_read_b128 v[44:47], v8 offset:0
    ds_read_b128 v[48:51], v8 offset:2048
    v_mfma_f32_32x32x16_bf16 v[80:95], v[32:35], v[28:31], v[80:95]
    ds_read_b64_tr_b16 v[52:53], v9 offset:6144
    ds_read_b64_tr_b16 v[54:55], v9 offset:7680
    v_mfma_f32_32x32x16_bf16 v[96:111], v[36:39], v[24:27], v[96:111]
    ds_read_b64_tr_b16 v[56:57], v10 offset:6144
    ds_read_b64_tr_b16 v[58:59], v10 offset:7680
    v_mfma_f32_32x32x16_bf16 v[112:127], v[36:39], v[28:31], v[112:127]
    ds_read_b64_tr_b16 v[60:61], v11 offset:6144
    ds_read_b64_tr_b16 v[62:63], v11 offset:7680
    v_mfma_f32_32x32x16_bf16 v[128:143], v[40:43], v[24:27], v[128:143]
    v_mfma_f32_32x32x16_bf16 v[144:159], v[40:43], v[28:31], v[144:159]
    s_waitcnt lgkmcnt(0)
    s_waitcnt vmcnt(20)
    s_barrier
    v_mfma_f32_32x32x16_bf16 v[64:79], v[52:55], v[44:47], v[64:79]
    s_add_u32 m0, s48, 122880
    s_nop 0
    buffer_load_dwordx4 v1, s[16:19], s44 offen lds
    s_add_u32 m0, s48, 123904
    s_nop 0
    buffer_load_dwordx4 v2, s[16:19], s44 offen lds
    s_add_u32 m0, s49, 122880
    s_nop 0
    buffer_load_dwordx4 v4, s[20:23], s45 offen lds
    v_mfma_f32_32x32x16_bf16 v[80:95], v[52:55], v[48:51], v[80:95]
    s_add_u32 m0, s49, 123904
    s_nop 0
    buffer_load_dwordx4 v5, s[20:23], s45 offen lds
    s_add_u32 m0, s49, 124928
    s_nop 0
    buffer_load_dwordx4 v6, s[20:23], s45 offen lds
    s_add_u32 s44, s44, 64
    v_mfma_f32_32x32x16_bf16 v[96:111], v[56:59], v[44:47], v[96:111]
    s_add_u32 s45, s45, 36864
    ds_read_b128 v[24:27], v7 offset:20480
    ds_read_b128 v[28:31], v7 offset:22528
    v_mfma_f32_32x32x16_bf16 v[112:127], v[56:59], v[48:51], v[112:127]
    ds_read_b64_tr_b16 v[32:33], v9 offset:20480
    ds_read_b64_tr_b16 v[34:35], v9 offset:22016
    ds_read_b64_tr_b16 v[36:37], v10 offset:20480
    v_mfma_f32_32x32x16_bf16 v[128:143], v[60:63], v[44:47], v[128:143]
    ds_read_b64_tr_b16 v[38:39], v10 offset:22016
    ds_read_b64_tr_b16 v[40:41], v11 offset:20480
    ds_read_b64_tr_b16 v[42:43], v11 offset:22016
    v_mfma_f32_32x32x16_bf16 v[144:159], v[60:63], v[48:51], v[144:159]
    s_waitcnt lgkmcnt(0)
    v_mfma_f32_32x32x16_bf16 v[64:79], v[32:35], v[24:27], v[64:79]
    ds_read_b128 v[44:47], v8 offset:20480
    ds_read_b128 v[48:51], v8 offset:22528
    v_mfma_f32_32x32x16_bf16 v[80:95], v[32:35], v[28:31], v[80:95]
    ds_read_b64_tr_b16 v[52:53], v9 offset:26624
    ds_read_b64_tr_b16 v[54:55], v9 offset:28160
    v_mfma_f32_32x32x16_bf16 v[96:111], v[36:39], v[24:27], v[96:111]
    ds_read_b64_tr_b16 v[56:57], v10 offset:26624
    ds_read_b64_tr_b16 v[58:59], v10 offset:28160
    v_mfma_f32_32x32x16_bf16 v[112:127], v[36:39], v[28:31], v[112:127]
    ds_read_b64_tr_b16 v[60:61], v11 offset:26624
    ds_read_b64_tr_b16 v[62:63], v11 offset:28160
    v_mfma_f32_32x32x16_bf16 v[128:143], v[40:43], v[24:27], v[128:143]
    v_mfma_f32_32x32x16_bf16 v[144:159], v[40:43], v[28:31], v[144:159]
    s_waitcnt lgkmcnt(0)
    s_waitcnt vmcnt(20)
    s_barrier
    v_mfma_f32_32x32x16_bf16 v[64:79], v[52:55], v[44:47], v[64:79]
    s_add_u32 m0, s48, 0
    s_nop 0
    buffer_load_dwordx4 v1, s[16:19], s44 offen lds
    s_add_u32 m0, s48, 1024
    s_nop 0
    buffer_load_dwordx4 v2, s[16:19], s44 offen lds
    s_add_u32 m0, s49, 0
    s_nop 0
    buffer_load_dwordx4 v4, s[20:23], s45 offen lds
    v_mfma_f32_32x32x16_bf16 v[80:95], v[52:55], v[48:51], v[80:95]
    s_add_u32 m0, s49, 1024
    s_nop 0
    buffer_load_dwordx4 v5, s[20:23], s45 offen lds
    s_add_u32 m0, s49, 2048
    s_nop 0
    buffer_load_dwordx4 v6, s[20:23], s45 offen lds
    s_add_u32 s44, s44, 64
    v_mfma_f32_32x32x16_bf16 v[96:111], v[56:59], v[44:47], v[96:111]
    s_add_u32 s45, s45, 36864
    ds_read_b128 v[24:27], v160 offset:8192
    ds_read_b128 v[28:31], v160 offset:10240
    v_mfma_f32_32x32x16_bf16 v[112:127], v[56:59], v[48:51], v[112:127]
    ds_read_b64_tr_b16 v[32:33], v162 offset:8192
    ds_read_b64_tr_b16 v[34:35], v162 offset:9728
    ds_read_b64_tr_b16 v[36:37], v163 offset:8192
    v_mfma_f32_32x32x16_bf16 v[128:143], v[60:63], v[44:47], v[128:143]
    ds_read_b64_tr_b16 v[38:39], v163 offset:9728
    ds_read_b64_tr_b16 v[40:41], v164 offset:8192
    ds_read_b64_tr_b16 v[42:43], v164 offset:9728
    v_mfma_f32_32x32x16_bf16 v[144:159], v[60:63], v[48:51], v[144:159]
    s_waitcnt lgkmcnt(0)
    v_mfma_f32_32x32x16_bf16 v[64:79], v[32:35], v[24:27], v[64:79]
    ds_read_b128 v[44:47], v161 offset:8192
    ds_read_b128 v[48:51], v161 offset:10240
    v_mfma_f32_32x32x16_bf16 v[80:95], v[32:35], v[28:31], v[80:95]
    ds_read_b64_tr_b16 v[52:53], v162 offset:14336
    ds_read_b64_tr_b16 v[54:55], v162 offset:15872
    v_mfma_f32_32x32x16_bf16 v[96:111], v[36:39], v[24:27], v[96:111]
    ds_read_b64_tr_b16 v[56:57], v163 offset:14336
    ds_read_b64_tr_b16 v[58:59], v163 offset:15872
    v_mfma_f32_32x32x16_bf16 v[112:127], v[36:39], v[28:31], v[112:127]
    ds_read_b64_tr_b16 v[60:61], v164 offset:14336
    ds_read_b64_tr_b16 v[62:63], v164 offset:15872
    v_mfma_f32_32x32x16_bf16 v[128:143], v[40:43], v[24:27], v[128:143]
    v_mfma_f32_32x32x16_bf16 v[144:159], v[40:43], v[28:31], v[144:159]
    s_waitcnt lgkmcnt(0)
    s_waitcnt vmcnt(20)
    s_barrier
    v_mfma_f32_32x32x16_bf16 v[64:79], v[52:55], v[44:47], v[64:79]
    s_add_u32 m0, s48, 20480
    s_nop 0
    buffer_load_dwordx4 v1, s[16:19], s44 offen lds
    s_add_u32 m0, s48, 21504
    s_nop 0
    buffer_load_dwordx4 v2, s[16:19], s44 offen lds
    s_add_u32 m0, s49, 20480
    s_nop 0
    buffer_load_dwordx4 v4, s[20:23], s45 offen lds
    v_mfma_f32_32x32x16_bf16 v[80:95], v[52:55], v[48:51], v[80:95]
    s_add_u32 m0, s49, 21504
    s_nop 0
    buffer_load_dwordx4 v5, s[20:23], s45 offen lds
    s_add_u32 m0, s49, 22528
    s_nop 0
    buffer_load_dwordx4 v6, s[20:23], s45 offen lds
    s_add_u32 s44, s44, 64
    v_mfma_f32_32x32x16_bf16 v[96:111], v[56:59], v[44:47], v[96:111]
    s_add_u32 s45, s45, 36864
    ds_read_b128 v[24:27], v160 offset:28672
    ds_read_b128 v[28:31], v160 offset:30720
    v_mfma_f32_32x32x16_bf16 v[112:127], v[56:59], v[48:51], v[112:127]
    ds_read_b64_tr_b16 v[32:33], v162 offset:28672
    ds_read_b64_tr_b16 v[34:35], v162 offset:30208
    ds_read_b64_tr_b16 v[36:37], v163 offset:28672
    v_mfma_f32_32x32x16_bf16 v[128:143], v[60:63], v[44:47], v[128:143]
    ds_read_b64_tr_b16 v[38:39], v163 offset:30208
    ds_read_b64_tr_b16 v[40:41], v164 offset:28672
    ds_read_b64_tr_b16 v[42:43], v164 offset:30208
    v_mfma_f32_32x32x16_bf16 v[144:159], v[60:63], v[48:51], v[144:159]
    s_waitcnt lgkmcnt(0)
    v_mfma_f32_32x32x16_bf16 v[64:79], v[32:35], v[24:27], v[64:79]
    ds_read_b128 v[44:47], v161 offset:28672
    ds_read_b128 v[48:51], v161 offset:30720
    v_mfma_f32_32x32x16_bf16 v[80:95], v[32:35], v[28:31], v[80:95]
    ds_read_b64_tr_b16 v[52:53], v162 offset:34816
    ds_read_b64_tr_b16 v[54:55], v162 offset:36352
    v_mfma_f32_32x32x16_bf16 v[96:111], v[36:39], v[24:27], v[96:111]
    ds_read_b64_tr_b16 v[56:57], v163 offset:34816
    ds_read_b64_tr_b16 v[58:59], v163 offset:36352
    v_mfma_f32_32x32x16_bf16 v[112:127], v[36:39], v[28:31], v[112:127]
    ds_read_b64_tr_b16 v[60:61], v164 offset:34816
    ds_read_b64_tr_b16 v[62:63], v164 offset:36352
    v_mfma_f32_32x32x16_bf16 v[128:143], v[40:43], v[24:27], v[128:143]
    v_mfma_f32_32x32x16_bf16 v[144:159], v[40:43], v[28:31], v[144:159]
    s_waitcnt lgkmcnt(0)
    s_waitcnt vmcnt(20)
    s_barrier
    v_mfma_f32_32x32x16_bf16 v[64:79], v[52:55], v[44:47], v[64:79]
    s_add_u32 m0, s48, 40960
    s_nop 0
    buffer_load_dwordx4 v1, s[16:19], s44 offen lds
    s_add_u32 m0, s48, 41984
    s_nop 0
    buffer_load_dwordx4 v2, s[16:19], s44 offen lds
    s_add_u32 m0, s49, 40960
    s_nop 0
    buffer_load_dwordx4 v4, s[20:23], s45 offen lds
    v_mfma_f32_32x32x16_bf16 v[80:95], v[52:55], v[48:51], v[80:95]
    s_add_u32 m0, s49, 41984
    s_nop 0
    buffer_load_dwordx4 v5, s[20:23], s45 offen lds
    s_add_u32 m0, s49, 43008
    s_nop 0
    buffer_load_dwordx4 v6, s[20:23], s45 offen lds
    s_add_u32 s44, s44, 64
    v_mfma_f32_32x32x16_bf16 v[96:111], v[56:59], v[44:47], v[96:111]
    s_add_u32 s45, s45, 36864
    ds_read_b128 v[24:27], v165 offset:16384
    ds_read_b128 v[28:31], v165 offset:18432
    v_mfma_f32_32x32x16_bf16 v[112:127], v[56:59], v[48:51], v[112:127]
    ds_read_b64_tr_b16 v[32:33], v167 offset:16384
    ds_read_b64_tr_b16 v[34:35], v167 offset:17920
    ds_read_b64_tr_b16 v[36:37], v168 offset:16384
    v_mfma_f32_32x32x16_bf16 v[128:143], v[60:63], v[44:47], v[128:143]
    ds_read_b64_tr_b16 v[38:39], v168 offset:17920
    ds_read_b64_tr_b16 v[40:41], v169 offset:16384
    ds_read_b64_tr_b16 v[42:43], v169 offset:17920
    v_mfma_f32_32x32x16_bf16 v[144:159], v[60:63], v[48:51], v[144:159]
    s_waitcnt lgkmcnt(0)
    v_mfma_f32_32x32x16_bf16 v[64:79], v[32:35], v[24:27], v[64:79]
    ds_read_b128 v[44:47], v166 offset:16384
    ds_read_b128 v[48:51], v166 offset:18432
    v_mfma_f32_32x32x16_bf16 v[80:95], v[32:35], v[28:31], v[80:95]
    ds_read_b64_tr_b16 v[52:53], v167 offset:22528
    ds_read_b64_tr_b16 v[54:55], v167 offset:24064
    v_mfma_f32_32x32x16_bf16 v[96:111], v[36:39], v[24:27], v[96:111]
    ds_read_b64_tr_b16 v[56:57], v168 offset:22528
    ds_read_b64_tr_b16 v[58:59], v168 offset:24064
    v_mfma_f32_32x32x16_bf16 v[112:127], v[36:39], v[28:31], v[112:127]
    ds_read_b64_tr_b16 v[60:61], v169 offset:22528
    ds_read_b64_tr_b16 v[62:63], v169 offset:24064
    v_mfma_f32_32x32x16_bf16 v[128:143], v[40:43], v[24:27], v[128:143]
    v_mfma_f32_32x32x16_bf16 v[144:159], v[40:43], v[28:31], v[144:159]
    s_waitcnt lgkmcnt(0)
    s_waitcnt vmcnt(20)
    s_barrier
    v_mfma_f32_32x32x16_bf16 v[64:79], v[52:55], v[44:47], v[64:79]
    s_add_u32 m0, s48, 61440
    s_nop 0
    buffer_load_dwordx4 v1, s[16:19], s44 offen lds
    s_add_u32 m0, s48, 62464
    s_nop 0
    buffer_load_dwordx4 v2, s[16:19], s44 offen lds
    s_add_u32 m0, s49, 61440
    s_nop 0
    buffer_load_dwordx4 v4, s[20:23], s45 offen lds
    v_mfma_f32_32x32x16_bf16 v[80:95], v[52:55], v[48:51], v[80:95]
    s_add_u32 m0, s49, 62464
    s_nop 0
    buffer_load_dwordx4 v5, s[20:23], s45 offen lds
    s_add_u32 m0, s49, 63488
    s_nop 0
    buffer_load_dwordx4 v6, s[20:23], s45 offen lds
    s_add_u32 s44, s44, 64
    v_mfma_f32_32x32x16_bf16 v[96:111], v[56:59], v[44:47], v[96:111]
    s_add_u32 s45, s45, 36864
    ds_read_b128 v[24:27], v170 offset:4096
    ds_read_b128 v[28:31], v170 offset:6144
    v_mfma_f32_32x32x16_bf16 v[112:127], v[56:59], v[48:51], v[112:127]
    ds_read_b64_tr_b16 v[32:33], v172 offset:4096
    ds_read_b64_tr_b16 v[34:35], v172 offset:5632
    ds_read_b64_tr_b16 v[36:37], v173 offset:4096
    v_mfma_f32_32x32x16_bf16 v[128:143], v[60:63], v[44:47], v[128:143]
    ds_read_b64_tr_b16 v[38:39], v173 offset:5632
    ds_read_b64_tr_b16 v[40:41], v174 offset:4096
    ds_read_b64_tr_b16 v[42:43], v174 offset:5632
    v_mfma_f32_32x32x16_bf16 v[144:159], v[60:63], v[48:51], v[144:159]
    s_waitcnt lgkmcnt(0)
    v_mfma_f32_32x32x16_bf16 v[64:79], v[32:35], v[24:27], v[64:79]
    ds_read_b128 v[44:47], v171 offset:4096
    ds_read_b128 v[48:51], v171 offset:6144
    v_mfma_f32_32x32x16_bf16 v[80:95], v[32:35], v[28:31], v[80:95]
    ds_read_b64_tr_b16 v[52:53], v172 offset:10240
    ds_read_b64_tr_b16 v[54:55], v172 offset:11776
    v_mfma_f32_32x32x16_bf16 v[96:111], v[36:39], v[24:27], v[96:111]
    ds_read_b64_tr_b16 v[56:57], v173 offset:10240
    ds_read_b64_tr_b16 v[58:59], v173 offset:11776
    v_mfma_f32_32x32x16_bf16 v[112:127], v[36:39], v[28:31], v[112:127]
    ds_read_b64_tr_b16 v[60:61], v174 offset:10240
    ds_read_b64_tr_b16 v[62:63], v174 offset:11776
    v_mfma_f32_32x32x16_bf16 v[128:143], v[40:43], v[24:27], v[128:143]
    v_mfma_f32_32x32x16_bf16 v[144:159], v[40:43], v[28:31], v[144:159]
    s_waitcnt lgkmcnt(0)
    s_waitcnt vmcnt(20)
    s_barrier
    v_mfma_f32_32x32x16_bf16 v[64:79], v[52:55], v[44:47], v[64:79]
    s_add_u32 m0, s48, 81920
    s_nop 0
    buffer_load_dwordx4 v1, s[16:19], s44 offen lds
    s_add_u32 m0, s48, 82944
    s_nop 0
    buffer_load_dwordx4 v2, s[16:19], s44 offen lds
    s_add_u32 m0, s49, 81920
    s_nop 0
    buffer_load_dwordx4 v4, s[20:23], s45 offen lds
    v_mfma_f32_32x32x16_bf16 v[80:95], v[52:55], v[48:51], v[80:95]
    s_add_u32 m0, s49, 82944
    s_nop 0
    buffer_load_dwordx4 v5, s[20:23], s45 offen lds
    s_add_u32 m0, s49, 83968
    s_nop 0
    buffer_load_dwordx4 v6, s[20:23], s45 offen lds
    s_add_u32 s44, s44, 64
    v_mfma_f32_32x32x16_bf16 v[96:111], v[56:59], v[44:47], v[96:111]
    s_add_u32 s45, s45, 36864
    ds_read_b128 v[24:27], v170 offset:24576
    ds_read_b128 v[28:31], v170 offset:26624
    v_mfma_f32_32x32x16_bf16 v[112:127], v[56:59], v[48:51], v[112:127]
    ds_read_b64_tr_b16 v[32:33], v172 offset:24576
    ds_read_b64_tr_b16 v[34:35], v172 offset:26112
    ds_read_b64_tr_b16 v[36:37], v173 offset:24576
    v_mfma_f32_32x32x16_bf16 v[128:143], v[60:63], v[44:47], v[128:143]
    ds_read_b64_tr_b16 v[38:39], v173 offset:26112
    ds_read_b64_tr_b16 v[40:41], v174 offset:24576
    ds_read_b64_tr_b16 v[42:43], v174 offset:26112
    v_mfma_f32_32x32x16_bf16 v[144:159], v[60:63], v[48:51], v[144:159]
    s_waitcnt lgkmcnt(0)
    v_mfma_f32_32x32x16_bf16 v[64:79], v[32:35], v[24:27], v[64:79]
    ds_read_b128 v[44:47], v171 offset:24576
    ds_read_b128 v[48:51], v171 offset:26624
    v_mfma_f32_32x32x16_bf16 v[80:95], v[32:35], v[28:31], v[80:95]
    ds_read_b64_tr_b16 v[52:53], v172 offset:30720
    ds_read_b64_tr_b16 v[54:55], v172 offset:32256
    v_mfma_f32_32x32x16_bf16 v[96:111], v[36:39], v[24:27], v[96:111]
    ds_read_b64_tr_b16 v[56:57], v173 offset:30720
    ds_read_b64_tr_b16 v[58:59], v173 offset:32256
    v_mfma_f32_32x32x16_bf16 v[112:127], v[36:39], v[28:31], v[112:127]
    ds_read_b64_tr_b16 v[60:61], v174 offset:30720
    ds_read_b64_tr_b16 v[62:63], v174 offset:32256
    v_mfma_f32_32x32x16_bf16 v[128:143], v[40:43], v[24:27], v[128:143]
    v_mfma_f32_32x32x16_bf16 v[144:159], v[40:43], v[28:31], v[144:159]
    s_waitcnt lgkmcnt(0)
    s_waitcnt vmcnt(20)
    s_barrier
    v_mfma_f32_32x32x16_bf16 v[64:79], v[52:55], v[44:47], v[64:79]
    s_add_u32 m0, s48, 102400
    s_nop 0
    buffer_load_dwordx4 v1, s[16:19], s44 offen lds
    s_add_u32 m0, s48, 103424
    s_nop 0
    buffer_load_dwordx4 v2, s[16:19], s44 offen lds
    s_add_u32 m0, s49, 102400
    s_nop 0
    buffer_load_dwordx4 v4, s[20:23], s45 offen lds
    v_mfma_f32_32x32x16_bf16 v[80:95], v[52:55], v[48:51], v[80:95]
    s_add_u32 m0, s49, 103424
    s_nop 0
    buffer_load_dwordx4 v5, s[20:23], s45 offen lds
    s_add_u32 m0, s49, 104448
    s_nop 0
    buffer_load_dwordx4 v6, s[20:23], s45 offen lds
    s_add_u32 s44, s44, 64
    v_mfma_f32_32x32x16_bf16 v[96:111], v[56:59], v[44:47], v[96:111]
    s_add_u32 s45, s45, 36864
    ds_read_b128 v[24:27], v7 offset:0
    ds_read_b128 v[28:31], v7 offset:2048
    v_mfma_f32_32x32x16_bf16 v[112:127], v[56:59], v[48:51], v[112:127]
    ds_read_b64_tr_b16 v[32:33], v9 offset:0
    ds_read_b64_tr_b16 v[34:35], v9 offset:1536
    ds_read_b64_tr_b16 v[36:37], v10 offset:0
    v_mfma_f32_32x32x16_bf16 v[128:143], v[60:63], v[44:47], v[128:143]
    ds_read_b64_tr_b16 v[38:39], v10 offset:1536
    ds_read_b64_tr_b16 v[40:41], v11 offset:0
    ds_read_b64_tr_b16 v[42:43], v11 offset:1536
    v_mfma_f32_32x32x16_bf16 v[144:159], v[60:63], v[48:51], v[144:159]
    s_sub_u32 s46, s46, 1
    s_cmp_lg_u32 s46, 0
    s_cbranch_scc1 .g5a_loop
    s_waitcnt lgkmcnt(0)
    v_mfma_f32_32x32x16_bf16 v[64:79], v[32:35], v[24:27], v[64:79]
    ds_read_b128 v[44:47], v8 offset:0
    ds_read_b128 v[48:51], v8 offset:2048
    v_mfma_f32_32x32x16_bf16 v[80:95], v[32:35], v[28:31], v[80:95]
    ds_read_b64_tr_b16 v[52:53], v9 offset:6144
    ds_read_b64_tr_b16 v[54:55], v9 offset:7680
    v_mfma_f32_32x32x16_bf16 v[96:111], v[36:39], v[24:27], v[96:111]
    ds_read_b64_tr_b16 v[56:57], v10 offset:6144
    ds_read_b64_tr_b16 v[58:59], v10 offset:7680
    v_mfma_f32_32x32x16_bf16 v[112:127], v[36:39], v[28:31], v[112:127]
    ds_read_b64_tr_b16 v[60:61], v11 offset:6144
    ds_read_b64_tr_b16 v[62:63], v11 offset:7680
    v_mfma_f32_32x32x16_bf16 v[128:143], v[40:43], v[24:27], v[128:143]
    v_mfma_f32_32x32x16_bf16 v[144:159], v[40:43], v[28:31], v[144:159]
    s_waitcnt lgkmcnt(0)
    s_waitcnt vmcnt(20)
    s_barrier
    v_mfma_f32_32x32x16_bf16 v[64:79], v[52:55], v[44:47], v[64:79]
    s_add_u32 m0, s48, 122880
    s_nop 0
    buffer_load_dwordx4 v1, s[16:19], s44 offen lds
    s_add_u32 m0, s48, 123904
    s_nop 0
    buffer_load_dwordx4 v2, s[16:19], s44 offen lds
    s_add_u32 m0, s49, 122880
    s_nop 0
    buffer_load_dwordx4 v4, s[20:23], s45 offen lds
    v_mfma_f32_32x32x16_bf16 v[80:95], v[52:55], v[48:51], v[80:95]
    s_add_u32 m0, s49, 123904
    s_nop 0
    buffer_load_dwordx4 v5, s[20:23], s45 offen lds
    s_add_u32 m0, s49, 124928
    s_nop 0
    buffer_load_dwordx4 v6, s[20:23], s45 offen lds
    s_add_u32 s44, s44, 64
    v_mfma_f32_32x32x16_bf16 v[96:111], v[56:59], v[44:47], v[96:111]
    s_add_u32 s45, s45, 36864
    ds_read_b128 v[24:27], v7 offset:20480
    ds_read_b128 v[28:31], v7 offset:22528
    v_mfma_f32_32x32x16_bf16 v[112:127], v[56:59], v[48:51], v[112:127]
    ds_read_b64_tr_b16 v[32:33], v9 offset:20480
    ds_read_b64_tr_b16 v[34:35], v9 offset:22016
    ds_read_b64_tr_b16 v[36:37], v10 offset:20480
    v_mfma_f32_32x32x16_bf16 v[128:143], v[60:63], v[44:47], v[128:143]
    ds_read_b64_tr_b16 v[38:39], v10 offset:22016
    ds_read_b64_tr_b16 v[40:41], v11 offset:20480
    ds_read_b64_tr_b16 v[42:43], v11 offset:22016
    v_mfma_f32_32x32x16_bf16 v[144:159], v[60:63], v[48:51], v[144:159]
    s_waitcnt lgkmcnt(0)
    v_mfma_f32_32x32x16_bf16 v[64:79], v[32:35], v[24:27], v[64:79]
    ds_read_b128 v[44:47], v8 offset:20480
    ds_read_b128 v[48:51], v8 offset:22528
    v_mfma_f32_32x32x16_bf16 v[80:95], v[32:35], v[28:31], v[80:95]
    ds_read_b64_tr_b16 v[52:53], v9 offset:26624
    ds_read_b64_tr_b16 v[54:55], v9 offset:28160
    v_mfma_f32_32x32x16_bf16 v[96:111], v[36:39], v[24:27], v[96:111]
    ds_read_b64_tr_b16 v[56:57], v10 offset:26624
    ds_read_b64_tr_b16 v[58:59], v10 offset:28160
    v_mfma_f32_32x32x16_bf16 v[112:127], v[36:39], v[28:31], v[112:127]
    ds_read_b64_tr_b16 v[60:61], v11 offset:26624
    ds_read_b64_tr_b16 v[62:63], v11 offset:28160
    v_mfma_f32_32x32x16_bf16 v[128:143], v[40:43], v[24:27], v[128:143]
    v_mfma_f32_32x32x16_bf16 v[144:159], v[40:43], v[28:31], v[144:159]
    s_waitcnt lgkmcnt(0)
    s_waitcnt vmcnt(20)
    s_barrier
    v_mfma_f32_32x32x16_bf16 v[64:79], v[52:55], v[44:47], v[64:79]
    s_add_u32 m0, s48, 0
    s_nop 0
    buffer_load_dwordx4 v1, s[16:19], s44 offen lds
    s_add_u32 m0, s48, 1024
    s_nop 0
    buffer_load_dwordx4 v2, s[16:19], s44 offen lds
    s_add_u32 m0, s49, 0
    s_nop 0
    buffer_load_dwordx4 v4, s[20:23], s45 offen lds
    v_mfma_f32_32x32x16_bf16 v[80:95], v[52:55], v[48:51], v[80:95]
    s_add_u32 m0, s49, 1024
    s_nop 0
    buffer_load_dwordx4 v5, s[20:23], s45 offen lds
    s_add_u32 m0, s49, 2048
    s_nop 0
    buffer_load_dwordx4 v6, s[20:23], s45 offen lds
    s_add_u32 s44, s44, 64
    v_mfma_f32_32x32x16_bf16 v[96:111], v[56:59], v[44:47], v[96:111]
    s_add_u32 s45, s45, 36864
    ds_read_b128 v[24:27], v160 offset:8192
    ds_read_b128 v[28:31], v160 offset:10240
    v_mfma_f32_32x32x16_bf16 v[112:127], v[56:59], v[48:51], v[112:127]
    ds_read_b64_tr_b16 v[32:33], v162 offset:8192
    ds_read_b64_tr_b16 v[34:35], v162 offset:9728
    ds_read_b64_tr_b16 v[36:37], v163 offset:8192
    v_mfma_f32_32x32x16_bf16 v[128:143], v[60:63], v[44:47], v[128:143]
    ds_read_b64_tr_b16 v[38:39], v163 offset:9728
    ds_read_b64_tr_b16 v[40:41], v164 offset:8192
    ds_read_b64_tr_b16 v[42:43], v164 offset:9728
    v_mfma_f32_32x32x16_bf16 v[144:159], v[60:63], v[48:51], v[144:159]
    s_waitcnt lgkmcnt(0)
    v_mfma_f32_32x32x16_bf16 v[64:79], v[32:35], v[24:27], v[64:79]
    ds_read_b128 v[44:47], v161 offset:8192
    ds_read_b128 v[48:51], v161 offset:10240
    v_mfma_f32_32x32x16_bf16 v[80:95], v[32:35], v[28:31], v[80:95]
    ds_read_b64_tr_b16 v[52:53], v162 offset:14336
    ds_read_b64_tr_b16 v[54:55], v162 offset:15872
    v_mfma_f32_32x32x16_bf16 v[96:111], v[36:39], v[24:27], v[96:111]
    ds_read_b64_tr_b16 v[56:57], v163 offset:14336
    ds_read_b64_tr_b16 v[58:59], v163 offset:15872
    v_mfma_f32_32x32x16_bf16 v[112:127], v[36:39], v[28:31], v[112:127]
    ds_read_b64_tr_b16 v[60:61], v164 offset:14336
    ds_read_b64_tr_b16 v[62:63], v164 offset:15872
    v_mfma_f32_32x32x16_bf16 v[128:143], v[40:43], v[24:27], v[128:143]
    v_mfma_f32_32x32x16_bf16 v[144:159], v[40:43], v[28:31], v[144:159]
    s_waitcnt lgkmcnt(0)
    s_waitcnt vmcnt(20)
    s_barrier
    v_mfma_f32_32x32x16_bf16 v[64:79], v[52:55], v[44:47], v[64:79]
    ds_read_b128 v[24:27], v160 offset:28672
    ds_read_b128 v[28:31], v160 offset:30720
    v_mfma_f32_32x32x16_bf16 v[80:95], v[52:55], v[48:51], v[80:95]
    ds_read_b64_tr_b16 v[32:33], v162 offset:28672
    ds_read_b64_tr_b16 v[34:35], v162 offset:30208
    v_mfma_f32_32x32x16_bf16 v[96:111], v[56:59], v[44:47], v[96:111]
    ds_read_b64_tr_b16 v[36:37], v163 offset:28672
    ds_read_b64_tr_b16 v[38:39], v163 offset:30208
    v_mfma_f32_32x32x16_bf16 v[112:127], v[56:59], v[48:51], v[112:127]
    ds_read_b64_tr_b16 v[40:41], v164 offset:28672
    ds_read_b64_tr_b16 v[42:43], v164 offset:30208
    v_mfma_f32_32x32x16_bf16 v[128:143], v[60:63], v[44:47], v[128:143]
    v_mfma_f32_32x32x16_bf16 v[144:159], v[60:63], v[48:51], v[144:159]
    s_waitcnt lgkmcnt(0)
    v_mfma_f32_32x32x16_bf16 v[64:79], v[32:35], v[24:27], v[64:79]
    ds_read_b128 v[44:47], v161 offset:28672
    ds_read_b128 v[48:51], v161 offset:30720
    v_mfma_f32_32x32x16_bf16 v[80:95], v[32:35], v[28:31], v[80:95]
    ds_read_b64_tr_b16 v[52:53], v162 offset:34816
    ds_read_b64_tr_b16 v[54:55], v162 offset:36352
    v_mfma_f32_32x32x16_bf16 v[96:111], v[36:39], v[24:27], v[96:111]
    ds_read_b64_tr_b16 v[56:57], v163 offset:34816
    ds_read_b64_tr_b16 v[58:59], v163 offset:36352
    v_mfma_f32_32x32x16_bf16 v[112:127], v[36:39], v[28:31], v[112:127]
    ds_read_b64_tr_b16 v[60:61], v164 offset:34816
    ds_read_b64_tr_b16 v[62:63], v164 offset:36352
    v_mfma_f32_32x32x16_bf16 v[128:143], v[40:43], v[24:27], v[128:143]
    v_mfma_f32_32x32x16_bf16 v[144:159], v[40:43], v[28:31], v[144:159]
    s_waitcnt lgkmcnt(0)
    s_waitcnt vmcnt(15)
    s_barrier
    v_mfma_f32_32x32x16_bf16 v[64:79], v[52:55], v[44:47], v[64:79]
    ds_read_b128 v[24:27], v165 offset:16384
    ds_read_b128 v[28:31], v165 offset:18432
    v_mfma_f32_32x32x16_bf16 v[80:95], v[52:55], v[48:51], v[80:95]
    ds_read_b64_tr_b16 v[32:33], v167 offset:16384
    ds_read_b64_tr_b16 v[34:35], v167 offset:17920
    v_mfma_f32_32x32x16_bf16 v[96:111], v[56:59], v[44:47], v[96:111]
    ds_read_b64_tr_b16 v[36:37], v168 offset:16384
    ds_read_b64_tr_b16 v[38:39], v168 offset:17920
    v_mfma_f32_32x32x16_bf16 v[112:127], v[56:59], v[48:51], v[112:127]
    ds_read_b64_tr_b16 v[40:41], v169 offset:16384
    ds_read_b64_tr_b16 v[42:43], v169 offset:17920
    v_mfma_f32_32x32x16_bf16 v[128:143], v[60:63], v[44:47], v[128:143]
    v_mfma_f32_32x32x16_bf16 v[144:159], v[60:63], v[48:51], v[144:159]
    s_waitcnt lgkmcnt(0)
    v_mfma_f32_32x32x16_bf16 v[64:79], v[32:35], v[24:27], v[64:79]
    ds_read_b128 v[44:47], v166 offset:16384
    ds_read_b128 v[48:51], v166 offset:18432
    v_mfma_f32_32x32x16_bf16 v[80:95], v[32:35], v[28:31], v[80:95]
    ds_read_b64_tr_b16 v[52:53], v167 offset:22528
    ds_read_b64_tr_b16 v[54:55], v167 offset:24064
    v_mfma_f32_32x32x16_bf16 v[96:111], v[36:39], v[24:27], v[96:111]
    ds_read_b64_tr_b16 v[56:57], v168 offset:22528
    ds_read_b64_tr_b16 v[58:59], v168 offset:24064
    v_mfma_f32_32x32x16_bf16 v[112:127], v[36:39], v[28:31], v[112:127]
    ds_read_b64_tr_b16 v[60:61], v169 offset:22528
    ds_read_b64_tr_b16 v[62:63], v169 offset:24064
    v_mfma_f32_32x32x16_bf16 v[128:143], v[40:43], v[24:27], v[128:143]
    v_mfma_f32_32x32x16_bf16 v[144:159], v[40:43], v[28:31], v[144:159]
    s_waitcnt lgkmcnt(0)
    s_waitcnt vmcnt(10)
    s_barrier
    v_mfma_f32_32x32x16_bf16 v[64:79], v[52:55], v[44:47], v[64:79]
    ds_read_b128 v[24:27], v170 offset:4096
    ds_read_b128 v[28:31], v170 offset:6144
    v_mfma_f32_32x32x16_bf16 v[80:95], v[52:55], v[48:51], v[80:95]
    ds_read_b64_tr_b16 v[32:33], v172 offset:4096
    ds_read_b64_tr_b16 v[34:35], v172 offset:5632
    v_mfma_f32_32x32x16_bf16 v[96:111], v[56:59], v[44:47], v[96:111]
    ds_read_b64_tr_b16 v[36:37], v173 offset:4096
    ds_read_b64_tr_b16 v[38:39], v173 offset:5632
    v_mfma_f32_32x32x16_bf16 v[112:127], v[56:59], v[48:51], v[112:127]
    ds_read_b64_tr_b16 v[40:41], v174 offset:4096
    ds_read_b64_tr_b16 v[42:43], v174 offset:5632
    v_mfma_f32_32x32x16_bf16 v[128:143], v[60:63], v[44:47], v[128:143]
    v_mfma_f32_32x32x16_bf16 v[144:159], v[60:63], v[48:51], v[144:159]
    s_waitcnt lgkmcnt(0)
    v_mfma_f32_32x32x16_bf16 v[64:79], v[32:35], v[24:27], v[64:79]
    ds_read_b128 v[44:47], v171 offset:4096
    ds_read_b128 v[48:51], v171 offset:6144
    v_mfma_f32_32x32x16_bf16 v[80:95], v[32:35], v[28:31], v[80:95]
    ds_read_b64_tr_b16 v[52:53], v172 offset:10240
    ds_read_b64_tr_b16 v[54:55], v172 offset:11776
    v_mfma_f32_32x32x16_bf16 v[96:111], v[36:39], v[24:27], v[96:111]
    ds_read_b64_tr_b16 v[56:57], v173 offset:10240
    ds_read_b64_tr_b16 v[58:59], v173 offset:11776
    v_mfma_f32_32x32x16_bf16 v[112:127], v[36:39], v[28:31], v[112:127]
    ds_read_b64_tr_b16 v[60:61], v174 offset:10240
    ds_read_b64_tr_b16 v[62:63], v174 offset:11776
    v_mfma_f32_32x32x16_bf16 v[128:143], v[40:43], v[24:27], v[128:143]
    v_mfma_f32_32x32x16_bf16 v[144:159], v[40:43], v[28:31], v[144:159]
    s_waitcnt lgkmcnt(0)
    s_waitcnt vmcnt(5)
    s_barrier
    v_mfma_f32_32x32x16_bf16 v[64:79], v[52:55], v[44:47], v[64:79]
    ds_read_b128 v[24:27], v170 offset:24576
    ds_read_b128 v[28:31], v170 offset:26624
    v_mfma_f32_32x32x16_bf16 v[80:95], v[52:55], v[48:51], v[80:95]
    ds_read_b64_tr_b16 v[32:33], v172 offset:24576
    ds_read_b64_tr_b16 v[34:35], v172 offset:26112
    v_mfma_f32_32x32x16_bf16 v[96:111], v[56:59], v[44:47], v[96:111]
    ds_read_b64_tr_b16 v[36:37], v173 offset:24576
    ds_read_b64_tr_b16 v[38:39], v173 offset:26112
    v_mfma_f32_32x32x16_bf16 v[112:127], v[56:59], v[48:51], v[112:127]
    ds_read_b64_tr_b16 v[40:41], v174 offset:24576
    ds_read_b64_tr_b16 v[42:43], v174 offset:26112
    v_mfma_f32_32x32x16_bf16 v[128:143], v[60:63], v[44:47], v[128:143]
    v_mfma_f32_32x32x16_bf16 v[144:159], v[60:63], v[48:51], v[144:159]
    s_waitcnt lgkmcnt(0)
    v_mfma_f32_32x32x16_bf16 v[64:79], v[32:35], v[24:27], v[64:79]
    ds_read_b128 v[44:47], v171 offset:24576
    ds_read_b128 v[48:51], v171 offset:26624
    v_mfma_f32_32x32x16_bf16 v[80:95], v[32:35], v[28:31], v[80:95]
    ds_read_b64_tr_b16 v[52:53], v172 offset:30720
    ds_read_b64_tr_b16 v[54:55], v172 offset:32256
    v_mfma_f32_32x32x16_bf16 v[96:111], v[36:39], v[24:27], v[96:111]
    ds_read_b64_tr_b16 v[56:57], v173 offset:30720
    ds_read_b64_tr_b16 v[58:59], v173 offset:32256
    v_mfma_f32_32x32x16_bf16 v[112:127], v[36:39], v[28:31], v[112:127]
    ds_read_b64_tr_b16 v[60:61], v174 offset:30720
    ds_read_b64_tr_b16 v[62:63], v174 offset:32256
    v_mfma_f32_32x32x16_bf16 v[128:143], v[40:43], v[24:27], v[128:143]
    v_mfma_f32_32x32x16_bf16 v[144:159], v[40:43], v[28:31], v[144:159]
    s_waitcnt lgkmcnt(0)
    s_waitcnt vmcnt(0)
    s_barrier
    v_mfma_f32_32x32x16_bf16 v[64:79], v[52:55], v[44:47], v[64:79]
    ds_read_b128 v[24:27], v7 offset:0
    ds_read_b128 v[28:31], v7 offset:2048
    v_mfma_f32_32x32x16_bf16 v[80:95], v[52:55], v[48:51], v[80:95]
    ds_read_b64_tr_b16 v[32:33], v9 offset:0
    ds_read_b64_tr_b16 v[34:35], v9 offset:1536
    v_mfma_f32_32x32x16_bf16 v[96:111], v[56:59], v[44:47], v[96:111]
    ds_read_b64_tr_b16 v[36:37], v10 offset:0
    ds_read_b64_tr_b16 v[38:39], v10 offset:1536
    v_mfma_f32_32x32x16_bf16 v[112:127], v[56:59], v[48:51], v[112:127]
    ds_read_b64_tr_b16 v[40:41], v11 offset:0
    ds_read_b64_tr_b16 v[42:43], v11 offset:1536
    v_mfma_f32_32x32x16_bf16 v[128:143], v[60:63], v[44:47], v[128:143]
    v_mfma_f32_32x32x16_bf16 v[144:159], v[60:63], v[48:51], v[144:159]
    s_waitcnt lgkmcnt(0)
    v_mfma_f32_32x32x16_bf16 v[64:79], v[32:35], v[24:27], v[64:79]
    ds_read_b128 v[44:47], v8 offset:0
    ds_read_b128 v[48:51], v8 offset:2048
    v_mfma_f32_32x32x16_bf16 v[80:95], v[32:35], v[28:31], v[80:95]
    ds_read_b64_tr_b16 v[52:53], v9 offset:6144
    ds_read_b64_tr_b16 v[54:55], v9 offset:7680
    v_mfma_f32_32x32x16_bf16 v[96:111], v[36:39], v[24:27], v[96:111]
    ds_read_b64_tr_b16 v[56:57], v10 offset:6144
    ds_read_b64_tr_b16 v[58:59], v10 offset:7680
    v_mfma_f32_32x32x16_bf16 v[112:127], v[36:39], v[28:31], v[112:127]
    ds_read_b64_tr_b16 v[60:61], v11 offset:6144
    ds_read_b64_tr_b16 v[62:63], v11 offset:7680
    v_mfma_f32_32x32x16_bf16 v[128:143], v[40:43], v[24:27], v[128:143]
    v_mfma_f32_32x32x16_bf16 v[144:159], v[40:43], v[28:31], v[144:159]
    s_waitcnt lgkmcnt(0)
    v_mfma_f32_32x32x16_bf16 v[64:79], v[52:55], v[44:47], v[64:79]
    v_mfma_f32_32x32x16_bf16 v[80:95], v[52:55], v[48:51], v[80:95]
    v_mfma_f32_32x32x16_bf16 v[96:111], v[56:59], v[44:47], v[96:111]
    v_mfma_f32_32x32x16_bf16 v[112:127], v[56:59], v[48:51], v[112:127]
    v_mfma_f32_32x32x16_bf16 v[128:143], v[60:63], v[44:47], v[128:143]
    v_mfma_f32_32x32x16_bf16 v[144:159], v[60:63], v[48:51], v[144:159]
    s_branch .g5_epi
.g5_wo:
    s_add_u32 s16, s8, 41943040
    s_addc_u32 s17, s9, 0
    s_mov_b32 s18, 2359296
    s_mov_b32 s19, 0x00020000
    s_mov_b32 s20, s6
    s_mov_b32 s21, s7
    s_mov_b32 s22, 663552
    s_mov_b32 s23, 0x00020000
    s_mov_b32 s44, 0
    s_mov_b32 s45, 0
    v_and_b32 v17, 63, v0
    v_lshrrev_b32 v18, 6, v0
    v_mul_u32_u24 v19, 128, v18
    v_add_u32 v19, v19, v17
    v_lshrrev_b32 v20, 2, v19
    v_and_b32 v19, 3, v19
    v_bfe_u32 v21, v20, 2, 2
    v_xor_b32 v19, v19, v21
    v_add_u32 v20, s40, v20
    s_mov_b32 s42, 1152
    v_mul_lo_u32 v20, v20, s42
    v_lshl_add_u32 v1, v19, 4, v20
    v_mul_u32_u24 v19, 128, v18
    v_add_u32 v19, v19, v17
    v_add_u32 v19, 64, v19
    v_lshrrev_b32 v20, 2, v19
    v_and_b32 v19, 3, v19
    v_bfe_u32 v21, v20, 2, 2
    v_xor_b32 v19, v19, v21
    v_add_u32 v20, s40, v20
    s_mov_b32 s42, 1152
    v_mul_lo_u32 v20, v20, s42
    v_lshl_add_u32 v2, v19, 4, v20
    v_mul_u32_u24 v19, 192, v18
    v_add_u32 v19, v19, v17
    s_mov_b32 s42, 683
    v_mul_lo_u32 v20, v19, s42
    v_lshrrev_b32 v20, 14, v20
    v_mul_u32_u24 v21, 24, v20
    v_sub_u32 v19, v19, v21
    v_bfe_u32 v21, v20, 1, 1
    v_lshlrev_b32 v21, 2, v21
    v_xor_b32 v19, v19, v21
    s_mov_b32 s42, 1152
    v_mul_lo_u32 v20, v20, s42
    v_lshl_add_u32 v20, v19, 4, v20
    s_lshl_b32 s42, s41, 1
    v_add_u32 v4, s42, v20
    v_mul_u32_u24 v19, 192, v18
    v_add_u32 v19, v19, v17
    v_add_u32 v19, 64, v19
    s_mov_b32 s42, 683
    v_mul_lo_u32 v20, v19, s42
    v_lshrrev_b32 v20, 14, v20
    v_mul_u32_u24 v21, 24, v20
    v_sub_u32 v19, v19, v21
    v_bfe_u32 v21, v20, 1, 1
    v_lshlrev_b32 v21, 2, v21
    v_xor_b32 v19, v19, v21
    s_mov_b32 s42, 1152
    v_mul_lo_u32 v20, v20, s42
    v_lshl_add_u32 v20, v19, 4, v20
    s_lshl_b32 s42, s41, 1
    v_add_u32 v5, s42, v20
    v_mul_u32_u24 v19, 192, v18
    v_add_u32 v19, v19, v17
    v_add_u32 v19, 128, v19
    s_mov_b32 s42, 683
    v_mul_lo_u32 v20, v19, s42
    v_lshrrev_b32 v20, 14, v20
    v_mul_u32_u24 v21, 24, v20
    v_sub_u32 v19, v19, v21
    v_bfe_u32 v21, v20, 1, 1
    v_lshlrev_b32 v21, 2, v21
    v_xor_b32 v19, v19, v21
    s_mov_b32 s42, 1152
    v_mul_lo_u32 v20, v20, s42
    v_lshl_add_u32 v20, v19, 4, v20
    s_lshl_b32 s42, s41, 1
    v_add_u32 v6, s42, v20
    s_nop 0
    v_readfirstlane_b32 s47, v18
    s_mul_i32 s48, s47, 2048
    s_mul_i32 s49, s47, 3072
    s_add_u32 s49, s49, 8192
    v_lshrrev_b32 v19, 1, v18
    v_mul_u32_u24 v19, 64, v19
    v_and_b32 v20, 31, v17
    v_add_u32 v19, v19, v20
    v_bfe_u32 v20, v19, 2, 2
    v_lshrrev_b32 v21, 5, v17
    v_add_u32 v22, 0, v21
    v_xor_b32 v22, v22, v20
    v_lshlrev_b32 v22, 4, v22
    v_mul_u32_u24 v7, 64, v19
    v_add_u32 v7, v7, v22
    v_add_u32 v22, 2, v21
    v_xor_b32 v22, v22, v20
    v_lshlrev_b32 v22, 4, v22
    v_mul_u32_u24 v8, 64, v19
    v_add_u32 v8, v8, v22
    v_lshrrev_b32 v19, 5, v17
    v_lshlrev_b32 v19, 3, v19
    v_bfe_u32 v20, v17, 2, 2
    v_add_u32 v19, v19, v20
    v_mul_u32_u24 v19, 384, v19
    v_bfe_u32 v20, v17, 4, 1
    v_lshl_add_u32 v19, v20, 5, v19
    v_and_b32 v20, 3, v17
    v_lshl_add_u32 v19, v20, 3, v19
    v_add_u32 v19, 8192, v19
    v_and_b32 v20, 1, v18
    v_mul_u32_u24 v20, 3, v20
    v_bfe_u32 v21, v17, 3, 1
    v_add_u32 v22, 0, v20
    v_xor_b32 v22, v22, v21
    v_lshl_add_u32 v9, v22, 6, v19
    v_add_u32 v22, 1, v20
    v_xor_b32 v22, v22, v21
    v_lshl_add_u32 v10, v22, 6, v19
    v_add_u32 v22, 2, v20
    v_xor_b32 v22, v22, v21
    v_lshl_add_u32 v11, v22, 6, v19
    v_add_u32 v160, 32768, v7
    v_add_u32 v161, 32768, v8
    v_add_u32 v162, 32768, v9
    v_add_u32 v163, 32768, v10
    v_add_u32 v164, 32768, v11
    v_add_u32 v165, 65536, v7
    v_add_u32 v166, 65536, v8
    v_add_u32 v167, 65536, v9
    v_add_u32 v168, 65536, v10
    v_add_u32 v169, 65536, v11
    v_add_u32 v170, 98304, v7
    v_add_u32 v171, 98304, v8
    v_add_u32 v172, 98304, v9
    v_add_u32 v173, 98304, v10
    v_add_u32 v174, 98304, v11
    v_mov_b32 v64, 0
    v_mov_b32 v65, 0
    v_mov_b32 v66, 0
    v_mov_b32 v67, 0
    v_mov_b32 v68, 0
    v_mov_b32 v69, 0
    v_mov_b32 v70, 0
    v_mov_b32 v71, 0
    v_mov_b32 v72, 0
    v_mov_b32 v73, 0
    v_mov_b32 v74, 0
    v_mov_b32 v75, 0
    v_mov_b32 v76, 0
    v_mov_b32 v77, 0
    v_mov_b32 v78, 0
    v_mov_b32 v79, 0
    v_mov_b32 v80, 0
    v_mov_b32 v81, 0
    v_mov_b32 v82, 0
    v_mov_b32 v83, 0
    v_mov_b32 v84, 0
    v_mov_b32 v85, 0
    v_mov_b32 v86, 0
    v_mov_b32 v87, 0
    v_mov_b32 v88, 0
    v_mov_b32 v89, 0
    v_mov_b32 v90, 0
    v_mov_b32 v91, 0
    v_mov_b32 v92, 0
    v_mov_b32 v93, 0
    v_mov_b32 v94, 0
    v_mov_b32 v95, 0
    v_mov_b32 v96, 0
    v_mov_b32 v97, 0
    v_mov_b32 v98, 0
    v_mov_b32 v99, 0
    v_mov_b32 v100, 0
    v_mov_b32 v101, 0
    v_mov_b32 v102, 0
    v_mov_b32 v103, 0
    v_mov_b32 v104, 0
    v_mov_b32 v105, 0
    v_mov_b32 v106, 0
    v_mov_b32 v107, 0
    v_mov_b32 v108, 0
    v_mov_b32 v109, 0
    v_mov_b32 v110, 0
    v_mov_b32 v111, 0
    v_mov_b32 v112, 0
    v_mov_b32 v113, 0
    v_mov_b32 v114, 0
    v_mov_b32 v115, 0
    v_mov_b32 v116, 0
    v_mov_b32 v117, 0
    v_mov_b32 v118, 0
    v_mov_b32 v119, 0
    v_mov_b32 v120, 0
    v_mov_b32 v121, 0
    v_mov_b32 v122, 0
    v_mov_b32 v123, 0
    v_mov_b32 v124, 0
    v_mov_b32 v125, 0
    v_mov_b32 v126, 0
    v_mov_b32 v127, 0
    v_mov_b32 v128, 0
    v_mov_b32 v129, 0
    v_mov_b32 v130, 0
    v_mov_b32 v131, 0
    v_mov_b32 v132, 0
    v_mov_b32 v133, 0
    v_mov_b32 v134, 0
    v_mov_b32 v135, 0
    v_mov_b32 v136, 0
    v_mov_b32 v137, 0
    v_mov_b32 v138, 0
    v_mov_b32 v139, 0
    v_mov_b32 v140, 0
    v_mov_b32 v141, 0
    v_mov_b32 v142, 0
    v_mov_b32 v143, 0
    v_mov_b32 v144, 0
    v_mov_b32 v145, 0
    v_mov_b32 v146, 0
    v_mov_b32 v147, 0
    v_mov_b32 v148, 0
    v_mov_b32 v149, 0
    v_mov_b32 v150, 0
    v_mov_b32 v151, 0
    v_mov_b32 v152, 0
    v_mov_b32 v153, 0
    v_mov_b32 v154, 0
    v_mov_b32 v155, 0
    v_mov_b32 v156, 0
    v_mov_b32 v157, 0
    v_mov_b32 v158, 0
    v_mov_b32 v159, 0
    s_add_u32 m0, s48, 0
    s_nop 0
    buffer_load_dwordx4 v1, s[16:19], s44 offen lds
    s_add_u32 m0, s48, 1024
    s_nop 0
    buffer_load_dwordx4 v2, s[16:19], s44 offen lds
    s_add_u32 m0, s49, 0
    s_nop 0
    buffer_load_dwordx4 v4, s[20:23], s45 offen lds
    s_add_u32 m0, s49, 1024
    s_nop 0
    buffer_load_dwordx4 v5, s[20:23], s45 offen lds
    s_add_u32 m0, s49, 2048
    s_nop 0
    buffer_load_dwordx4 v6, s[20:23], s45 offen lds
    s_add_u32 s44, s44, 64
    s_add_u32 s45, s45, 36864
    s_add_u32 m0, s48, 20480
    s_nop 0
    buffer_load_dwordx4 v1, s[16:19], s44 offen lds
    s_add_u32 m0, s48, 21504
    s_nop 0
    buffer_load_dwordx4 v2, s[16:19], s44 offen lds
    s_add_u32 m0, s49, 20480
    s_nop 0
    buffer_load_dwordx4 v4, s[20:23], s45 offen lds
    s_add_u32 m0, s49, 21504
    s_nop 0
    buffer_load_dwordx4 v5, s[20:23], s45 offen lds
    s_add_u32 m0, s49, 22528
    s_nop 0
    buffer_load_dwordx4 v6, s[20:23], s45 offen lds
    s_add_u32 s44, s44, 64
    s_add_u32 s45, s45, 36864
    s_add_u32 m0, s48, 40960
    s_nop 0
    buffer_load_dwordx4 v1, s[16:19], s44 offen lds
    s_add_u32 m0, s48, 41984
    s_nop 0
    buffer_load_dwordx4 v2, s[16:19], s44 offen lds
    s_add_u32 m0, s49, 40960
    s_nop 0
    buffer_load_dwordx4 v4, s[20:23], s45 offen lds
    s_add_u32 m0, s49, 41984
    s_nop 0
    buffer_load_dwordx4 v5, s[20:23], s45 offen lds
    s_add_u32 m0, s49, 43008
    s_nop 0
    buffer_load_dwordx4 v6, s[20:23], s45 offen lds
    s_add_u32 s44, s44, 64
    s_add_u32 s45, s45, 36864
    s_add_u32 m0, s48, 61440
    s_nop 0
    buffer_load_dwordx4 v1, s[16:19], s44 offen lds
    s_add_u32 m0, s48, 62464
    s_nop 0
    buffer_load_dwordx4 v2, s[16:19], s44 offen lds
    s_add_u32 m0, s49, 61440
    s_nop 0
    buffer_load_dwordx4 v4, s[20:23], s45 offen lds
    s_add_u32 m0, s49, 62464
    s_nop 0
    buffer_load_dwordx4 v5, s[20:23], s45 offen lds
    s_add_u32 m0, s49, 63488
    s_nop 0
    buffer_load_dwordx4 v6, s[20:23], s45 offen lds
    s_add_u32 s44, s44, 64
    s_add_u32 s45, s45, 36864
    s_add_u32 m0, s48, 81920
    s_nop 0
    buffer_load_dwordx4 v1, s[16:19], s44 offen lds
    s_add_u32 m0, s48, 82944
    s_nop 0
    buffer_load_dwordx4 v2, s[16:19], s44 offen lds
    s_add_u32 m0, s49, 81920
    s_nop 0
    buffer_load_dwordx4 v4, s[20:23], s45 offen lds
    s_add_u32 m0, s49, 82944
    s_nop 0
    buffer_load_dwordx4 v5, s[20:23], s45 offen lds
    s_add_u32 m0, s49, 83968
    s_nop 0
    buffer_load_dwordx4 v6, s[20:23], s45 offen lds
    s_add_u32 s44, s44, 64
    s_add_u32 s45, s45, 36864
    s_add_u32 m0, s48, 102400
    s_nop 0
    buffer_load_dwordx4 v1, s[16:19], s44 offen lds
    s_add_u32 m0, s48, 103424
    s_nop 0
    buffer_load_dwordx4 v2, s[16:19], s44 offen lds
    s_add_u32 m0, s49, 102400
    s_nop 0
    buffer_load_dwordx4 v4, s[20:23], s45 offen lds
    s_add_u32 m0, s49, 103424
    s_nop 0
    buffer_load_dwordx4 v5, s[20:23], s45 offen lds
    s_add_u32 m0, s49, 104448
    s_nop 0
    buffer_load_dwordx4 v6, s[20:23], s45 offen lds
    s_add_u32 s44, s44, 64
    s_add_u32 s45, s45, 36864
    s_waitcnt vmcnt(25)
    s_barrier
    ds_read_b128 v[24:27], v7 offset:0
    ds_read_b128 v[28:31], v7 offset:2048
    ds_read_b64_tr_b16 v[32:33], v9 offset:0
    ds_read_b64_tr_b16 v[34:35], v9 offset:1536
    ds_read_b64_tr_b16 v[36:37], v10 offset:0
    ds_read_b64_tr_b16 v[38:39], v10 offset:1536
    ds_read_b64_tr_b16 v[40:41], v11 offset:0
    ds_read_b64_tr_b16 v[42:43], v11 offset:1536
    s_waitcnt lgkmcnt(0)
    v_mfma_f32_32x32x16_bf16 v[64:79], v[32:35], v[24:27], v[64:79]
    ds_read_b128 v[44:47], v8 offset:0
    ds_read_b128 v[48:51], v8 offset:2048
    v_mfma_f32_32x32x16_bf16 v[80:95], v[32:35], v[28:31], v[80:95]
    ds_read_b64_tr_b16 v[52:53], v9 offset:6144
    ds_read_b64_tr_b16 v[54:55], v9 offset:7680
    v_mfma_f32_32x32x16_bf16 v[96:111], v[36:39], v[24:27], v[96:111]
    ds_read_b64_tr_b16 v[56:57], v10 offset:6144
    ds_read_b64_tr_b16 v[58:59], v10 offset:7680
    v_mfma_f32_32x32x16_bf16 v[112:127], v[36:39], v[28:31], v[112:127]
    ds_read_b64_tr_b16 v[60:61], v11 offset:6144
    ds_read_b64_tr_b16 v[62:63], v11 offset:7680
    v_mfma_f32_32x32x16_bf16 v[128:143], v[40:43], v[24:27], v[128:143]
    v_mfma_f32_32x32x16_bf16 v[144:159], v[40:43], v[28:31], v[144:159]
    s_waitcnt lgkmcnt(0)
    s_waitcnt vmcnt(20)
    s_barrier
    v_mfma_f32_32x32x16_bf16 v[64:79], v[52:55], v[44:47], v[64:79]
    s_add_u32 m0, s48, 122880
    s_nop 0
    buffer_load_dwordx4 v1, s[16:19], s44 offen lds
    s_add_u32 m0, s48, 123904
    s_nop 0
    buffer_load_dwordx4 v2, s[16:19], s44 offen lds
    s_add_u32 m0, s49, 122880
    s_nop 0
    buffer_load_dwordx4 v4, s[20:23], s45 offen lds
    v_mfma_f32_32x32x16_bf16 v[80:95], v[52:55], v[48:51], v[80:95]
    s_add_u32 m0, s49, 123904
    s_nop 0
    buffer_load_dwordx4 v5, s[20:23], s45 offen lds
    s_add_u32 m0, s49, 124928
    s_nop 0
    buffer_load_dwordx4 v6, s[20:23], s45 offen lds
    s_add_u32 s44, s44, 64
    v_mfma_f32_32x32x16_bf16 v[96:111], v[56:59], v[44:47], v[96:111]
    s_add_u32 s45, s45, 36864
    ds_read_b128 v[24:27], v7 offset:20480
    ds_read_b128 v[28:31], v7 offset:22528
    v_mfma_f32_32x32x16_bf16 v[112:127], v[56:59], v[48:51], v[112:127]
    ds_read_b64_tr_b16 v[32:33], v9 offset:20480
    ds_read_b64_tr_b16 v[34:35], v9 offset:22016
    ds_read_b64_tr_b16 v[36:37], v10 offset:20480
    v_mfma_f32_32x32x16_bf16 v[128:143], v[60:63], v[44:47], v[128:143]
    ds_read_b64_tr_b16 v[38:39], v10 offset:22016
    ds_read_b64_tr_b16 v[40:41], v11 offset:20480
    ds_read_b64_tr_b16 v[42:43], v11 offset:22016
    v_mfma_f32_32x32x16_bf16 v[144:159], v[60:63], v[48:51], v[144:159]
    s_waitcnt lgkmcnt(0)
    v_mfma_f32_32x32x16_bf16 v[64:79], v[32:35], v[24:27], v[64:79]
    ds_read_b128 v[44:47], v8 offset:20480
    ds_read_b128 v[48:51], v8 offset:22528
    v_mfma_f32_32x32x16_bf16 v[80:95], v[32:35], v[28:31], v[80:95]
    ds_read_b64_tr_b16 v[52:53], v9 offset:26624
    ds_read_b64_tr_b16 v[54:55], v9 offset:28160
    v_mfma_f32_32x32x16_bf16 v[96:111], v[36:39], v[24:27], v[96:111]
    ds_read_b64_tr_b16 v[56:57], v10 offset:26624
    ds_read_b64_tr_b16 v[58:59], v10 offset:28160
    v_mfma_f32_32x32x16_bf16 v[112:127], v[36:39], v[28:31], v[112:127]
    ds_read_b64_tr_b16 v[60:61], v11 offset:26624
    ds_read_b64_tr_b16 v[62:63], v11 offset:28160
    v_mfma_f32_32x32x16_bf16 v[128:143], v[40:43], v[24:27], v[128:143]
    v_mfma_f32_32x32x16_bf16 v[144:159], v[40:43], v[28:31], v[144:159]
    s_waitcnt lgkmcnt(0)
    s_waitcnt vmcnt(20)
    s_barrier
    v_mfma_f32_32x32x16_bf16 v[64:79], v[52:55], v[44:47], v[64:79]
    s_add_u32 m0, s48, 0
    s_nop 0
    buffer_load_dwordx4 v1, s[16:19], s44 offen lds
    s_add_u32 m0, s48, 1024
    s_nop 0
    buffer_load_dwordx4 v2, s[16:19], s44 offen lds
    s_add_u32 m0, s49, 0
    s_nop 0
    buffer_load_dwordx4 v4, s[20:23], s45 offen lds
    v_mfma_f32_32x32x16_bf16 v[80:95], v[52:55], v[48:51], v[80:95]
    s_add_u32 m0, s49, 1024
    s_nop 0
    buffer_load_dwordx4 v5, s[20:23], s45 offen lds
    s_add_u32 m0, s49, 2048
    s_nop 0
    buffer_load_dwordx4 v6, s[20:23], s45 offen lds
    s_add_u32 s44, s44, 64
    v_mfma_f32_32x32x16_bf16 v[96:111], v[56:59], v[44:47], v[96:111]
    s_add_u32 s45, s45, 36864
    ds_read_b128 v[24:27], v160 offset:8192
    ds_read_b128 v[28:31], v160 offset:10240
    v_mfma_f32_32x32x16_bf16 v[112:127], v[56:59], v[48:51], v[112:127]
    ds_read_b64_tr_b16 v[32:33], v162 offset:8192
    ds_read_b64_tr_b16 v[34:35], v162 offset:9728
    ds_read_b64_tr_b16 v[36:37], v163 offset:8192
    v_mfma_f32_32x32x16_bf16 v[128:143], v[60:63], v[44:47], v[128:143]
    ds_read_b64_tr_b16 v[38:39], v163 offset:9728
    ds_read_b64_tr_b16 v[40:41], v164 offset:8192
    ds_read_b64_tr_b16 v[42:43], v164 offset:9728
    v_mfma_f32_32x32x16_bf16 v[144:159], v[60:63], v[48:51], v[144:159]
    s_waitcnt lgkmcnt(0)
    v_mfma_f32_32x32x16_bf16 v[64:79], v[32:35], v[24:27], v[64:79]
    ds_read_b128 v[44:47], v161 offset:8192
    ds_read_b128 v[48:51], v161 offset:10240
    v_mfma_f32_32x32x16_bf16 v[80:95], v[32:35], v[28:31], v[80:95]
    ds_read_b64_tr_b16 v[52:53], v162 offset:14336
    ds_read_b64_tr_b16 v[54:55], v162 offset:15872
    v_mfma_f32_32x32x16_bf16 v[96:111], v[36:39], v[24:27], v[96:111]
    ds_read_b64_tr_b16 v[56:57], v163 offset:14336
    ds_read_b64_tr_b16 v[58:59], v163 offset:15872
    v_mfma_f32_32x32x16_bf16 v[112:127], v[36:39], v[28:31], v[112:127]
    ds_read_b64_tr_b16 v[60:61], v164 offset:14336
    ds_read_b64_tr_b16 v[62:63], v164 offset:15872
    v_mfma_f32_32x32x16_bf16 v[128:143], v[40:43], v[24:27], v[128:143]
    v_mfma_f32_32x32x16_bf16 v[144:159], v[40:43], v[28:31], v[144:159]
    s_waitcnt lgkmcnt(0)
    s_waitcnt vmcnt(20)
    s_barrier
    v_mfma_f32_32x32x16_bf16 v[64:79], v[52:55], v[44:47], v[64:79]
    s_add_u32 m0, s48, 20480
    s_nop 0
    buffer_load_dwordx4 v1, s[16:19], s44 offen lds
    s_add_u32 m0, s48, 21504
    s_nop 0
    buffer_load_dwordx4 v2, s[16:19], s44 offen lds
    s_add_u32 m0, s49, 20480
    s_nop 0
    buffer_load_dwordx4 v4, s[20:23], s45 offen lds
    v_mfma_f32_32x32x16_bf16 v[80:95], v[52:55], v[48:51], v[80:95]
    s_add_u32 m0, s49, 21504
    s_nop 0
    buffer_load_dwordx4 v5, s[20:23], s45 offen lds
    s_add_u32 m0, s49, 22528
    s_nop 0
    buffer_load_dwordx4 v6, s[20:23], s45 offen lds
    s_add_u32 s44, s44, 64
    v_mfma_f32_32x32x16_bf16 v[96:111], v[56:59], v[44:47], v[96:111]
    s_add_u32 s45, s45, 36864
    ds_read_b128 v[24:27], v160 offset:28672
    ds_read_b128 v[28:31], v160 offset:30720
    v_mfma_f32_32x32x16_bf16 v[112:127], v[56:59], v[48:51], v[112:127]
    ds_read_b64_tr_b16 v[32:33], v162 offset:28672
    ds_read_b64_tr_b16 v[34:35], v162 offset:30208
    ds_read_b64_tr_b16 v[36:37], v163 offset:28672
    v_mfma_f32_32x32x16_bf16 v[128:143], v[60:63], v[44:47], v[128:143]
    ds_read_b64_tr_b16 v[38:39], v163 offset:30208
    ds_read_b64_tr_b16 v[40:41], v164 offset:28672
    ds_read_b64_tr_b16 v[42:43], v164 offset:30208
    v_mfma_f32_32x32x16_bf16 v[144:159], v[60:63], v[48:51], v[144:159]
    s_waitcnt lgkmcnt(0)
    v_mfma_f32_32x32x16_bf16 v[64:79], v[32:35], v[24:27], v[64:79]
    ds_read_b128 v[44:47], v161 offset:28672
    ds_read_b128 v[48:51], v161 offset:30720
    v_mfma_f32_32x32x16_bf16 v[80:95], v[32:35], v[28:31], v[80:95]
    ds_read_b64_tr_b16 v[52:53], v162 offset:34816
    ds_read_b64_tr_b16 v[54:55], v162 offset:36352
    v_mfma_f32_32x32x16_bf16 v[96:111], v[36:39], v[24:27], v[96:111]
    ds_read_b64_tr_b16 v[56:57], v163 offset:34816
    ds_read_b64_tr_b16 v[58:59], v163 offset:36352
    v_mfma_f32_32x32x16_bf16 v[112:127], v[36:39], v[28:31], v[112:127]
    ds_read_b64_tr_b16 v[60:61], v164 offset:34816
    ds_read_b64_tr_b16 v[62:63], v164 offset:36352
    v_mfma_f32_32x32x16_bf16 v[128:143], v[40:43], v[24:27], v[128:143]
    v_mfma_f32_32x32x16_bf16 v[144:159], v[40:43], v[28:31], v[144:159]
    s_waitcnt lgkmcnt(0)
    s_waitcnt vmcnt(20)
    s_barrier
    v_mfma_f32_32x32x16_bf16 v[64:79], v[52:55], v[44:47], v[64:79]
    s_add_u32 m0, s48, 40960
    s_nop 0
    buffer_load_dwordx4 v1, s[16:19], s44 offen lds
    s_add_u32 m0, s48, 41984
    s_nop 0
    buffer_load_dwordx4 v2, s[16:19], s44 offen lds
    s_add_u32 m0, s49, 40960
    s_nop 0
    buffer_load_dwordx4 v4, s[20:23], s45 offen lds
    v_mfma_f32_32x32x16_bf16 v[80:95], v[52:55], v[48:51], v[80:95]
    s_add_u32 m0, s49, 41984
    s_nop 0
    buffer_load_dwordx4 v5, s[20:23], s45 offen lds
    s_add_u32 m0, s49, 43008
    s_nop 0
    buffer_load_dwordx4 v6, s[20:23], s45 offen lds
    s_add_u32 s44, s44, 64
    v_mfma_f32_32x32x16_bf16 v[96:111], v[56:59], v[44:47], v[96:111]
    s_add_u32 s45, s45, 36864
    ds_read_b128 v[24:27], v165 offset:16384
    ds_read_b128 v[28:31], v165 offset:18432
    v_mfma_f32_32x32x16_bf16 v[112:127], v[56:59], v[48:51], v[112:127]
    ds_read_b64_tr_b16 v[32:33], v167 offset:16384
    ds_read_b64_tr_b16 v[34:35], v167 offset:17920
    ds_read_b64_tr_b16 v[36:37], v168 offset:16384
    v_mfma_f32_32x32x16_bf16 v[128:143], v[60:63], v[44:47], v[128:143]
    ds_read_b64_tr_b16 v[38:39], v168 offset:17920
    ds_read_b64_tr_b16 v[40:41], v169 offset:16384
    ds_read_b64_tr_b16 v[42:43], v169 offset:17920
    v_mfma_f32_32x32x16_bf16 v[144:159], v[60:63], v[48:51], v[144:159]
    s_waitcnt lgkmcnt(0)
    v_mfma_f32_32x32x16_bf16 v[64:79], v[32:35], v[24:27], v[64:79]
    ds_read_b128 v[44:47], v166 offset:16384
    ds_read_b128 v[48:51], v166 offset:18432
    v_mfma_f32_32x32x16_bf16 v[80:95], v[32:35], v[28:31], v[80:95]
    ds_read_b64_tr_b16 v[52:53], v167 offset:22528
    ds_read_b64_tr_b16 v[54:55], v167 offset:24064
    v_mfma_f32_32x32x16_bf16 v[96:111], v[36:39], v[24:27], v[96:111]
    ds_read_b64_tr_b16 v[56:57], v168 offset:22528
    ds_read_b64_tr_b16 v[58:59], v168 offset:24064
    v_mfma_f32_32x32x16_bf16 v[112:127], v[36:39], v[28:31], v[112:127]
    ds_read_b64_tr_b16 v[60:61], v169 offset:22528
    ds_read_b64_tr_b16 v[62:63], v169 offset:24064
    v_mfma_f32_32x32x16_bf16 v[128:143], v[40:43], v[24:27], v[128:143]
    v_mfma_f32_32x32x16_bf16 v[144:159], v[40:43], v[28:31], v[144:159]
    s_waitcnt lgkmcnt(0)
    s_waitcnt vmcnt(20)
    s_barrier
    v_mfma_f32_32x32x16_bf16 v[64:79], v[52:55], v[44:47], v[64:79]
    s_add_u32 m0, s48, 61440
    s_nop 0
    buffer_load_dwordx4 v1, s[16:19], s44 offen lds
    s_add_u32 m0, s48, 62464
    s_nop 0
    buffer_load_dwordx4 v2, s[16:19], s44 offen lds
    s_add_u32 m0, s49, 61440
    s_nop 0
    buffer_load_dwordx4 v4, s[20:23], s45 offen lds
    v_mfma_f32_32x32x16_bf16 v[80:95], v[52:55], v[48:51], v[80:95]
    s_add_u32 m0, s49, 62464
    s_nop 0
    buffer_load_dwordx4 v5, s[20:23], s45 offen lds
    s_add_u32 m0, s49, 63488
    s_nop 0
    buffer_load_dwordx4 v6, s[20:23], s45 offen lds
    s_add_u32 s44, s44, 64
    v_mfma_f32_32x32x16_bf16 v[96:111], v[56:59], v[44:47], v[96:111]
    s_add_u32 s45, s45, 36864
    ds_read_b128 v[24:27], v170 offset:4096
    ds_read_b128 v[28:31], v170 offset:6144
    v_mfma_f32_32x32x16_bf16 v[112:127], v[56:59], v[48:51], v[112:127]
    ds_read_b64_tr_b16 v[32:33], v172 offset:4096
    ds_read_b64_tr_b16 v[34:35], v172 offset:5632
    ds_read_b64_tr_b16 v[36:37], v173 offset:4096
    v_mfma_f32_32x32x16_bf16 v[128:143], v[60:63], v[44:47], v[128:143]
    ds_read_b64_tr_b16 v[38:39], v173 offset:5632
    ds_read_b64_tr_b16 v[40:41], v174 offset:4096
    ds_read_b64_tr_b16 v[42:43], v174 offset:5632
    v_mfma_f32_32x32x16_bf16 v[144:159], v[60:63], v[48:51], v[144:159]
    s_waitcnt lgkmcnt(0)
    v_mfma_f32_32x32x16_bf16 v[64:79], v[32:35], v[24:27], v[64:79]
    ds_read_b128 v[44:47], v171 offset:4096
    ds_read_b128 v[48:51], v171 offset:6144
    v_mfma_f32_32x32x16_bf16 v[80:95], v[32:35], v[28:31], v[80:95]
    ds_read_b64_tr_b16 v[52:53], v172 offset:10240
    ds_read_b64_tr_b16 v[54:55], v172 offset:11776
    v_mfma_f32_32x32x16_bf16 v[96:111], v[36:39], v[24:27], v[96:111]
    ds_read_b64_tr_b16 v[56:57], v173 offset:10240
    ds_read_b64_tr_b16 v[58:59], v173 offset:11776
    v_mfma_f32_32x32x16_bf16 v[112:127], v[36:39], v[28:31], v[112:127]
    ds_read_b64_tr_b16 v[60:61], v174 offset:10240
    ds_read_b64_tr_b16 v[62:63], v174 offset:11776
    v_mfma_f32_32x32x16_bf16 v[128:143], v[40:43], v[24:27], v[128:143]
    v_mfma_f32_32x32x16_bf16 v[144:159], v[40:43], v[28:31], v[144:159]
    s_waitcnt lgkmcnt(0)
    s_waitcnt vmcnt(20)
    s_barrier
    v_mfma_f32_32x32x16_bf16 v[64:79], v[52:55], v[44:47], v[64:79]
    s_add_u32 m0, s48, 81920
    s_nop 0
    buffer_load_dwordx4 v1, s[16:19], s44 offen lds
    s_add_u32 m0, s48, 82944
    s_nop 0
    buffer_load_dwordx4 v2, s[16:19], s44 offen lds
    s_add_u32 m0, s49, 81920
    s_nop 0
    buffer_load_dwordx4 v4, s[20:23], s45 offen lds
    v_mfma_f32_32x32x16_bf16 v[80:95], v[52:55], v[48:51], v[80:95]
    s_add_u32 m0, s49, 82944
    s_nop 0
    buffer_load_dwordx4 v5, s[20:23], s45 offen lds
    s_add_u32 m0, s49, 83968
    s_nop 0
    buffer_load_dwordx4 v6, s[20:23], s45 offen lds
    s_add_u32 s44, s44, 64
    v_mfma_f32_32x32x16_bf16 v[96:111], v[56:59], v[44:47], v[96:111]
    s_add_u32 s45, s45, 36864
    ds_read_b128 v[24:27], v170 offset:24576
    ds_read_b128 v[28:31], v170 offset:26624
    v_mfma_f32_32x32x16_bf16 v[112:127], v[56:59], v[48:51], v[112:127]
    ds_read_b64_tr_b16 v[32:33], v172 offset:24576
    ds_read_b64_tr_b16 v[34:35], v172 offset:26112
    ds_read_b64_tr_b16 v[36:37], v173 offset:24576
    v_mfma_f32_32x32x16_bf16 v[128:143], v[60:63], v[44:47], v[128:143]
    ds_read_b64_tr_b16 v[38:39], v173 offset:26112
    ds_read_b64_tr_b16 v[40:41], v174 offset:24576
    ds_read_b64_tr_b16 v[42:43], v174 offset:26112
    v_mfma_f32_32x32x16_bf16 v[144:159], v[60:63], v[48:51], v[144:159]
    s_waitcnt lgkmcnt(0)
    v_mfma_f32_32x32x16_bf16 v[64:79], v[32:35], v[24:27], v[64:79]
    ds_read_b128 v[44:47], v171 offset:24576
    ds_read_b128 v[48:51], v171 offset:26624
    v_mfma_f32_32x32x16_bf16 v[80:95], v[32:35], v[28:31], v[80:95]
    ds_read_b64_tr_b16 v[52:53], v172 offset:30720
    ds_read_b64_tr_b16 v[54:55], v172 offset:32256
    v_mfma_f32_32x32x16_bf16 v[96:111], v[36:39], v[24:27], v[96:111]
    ds_read_b64_tr_b16 v[56:57], v173 offset:30720
    ds_read_b64_tr_b16 v[58:59], v173 offset:32256
    v_mfma_f32_32x32x16_bf16 v[112:127], v[36:39], v[28:31], v[112:127]
    ds_read_b64_tr_b16 v[60:61], v174 offset:30720
    ds_read_b64_tr_b16 v[62:63], v174 offset:32256
    v_mfma_f32_32x32x16_bf16 v[128:143], v[40:43], v[24:27], v[128:143]
    v_mfma_f32_32x32x16_bf16 v[144:159], v[40:43], v[28:31], v[144:159]
    s_waitcnt lgkmcnt(0)
    s_waitcnt vmcnt(20)
    s_barrier
    v_mfma_f32_32x32x16_bf16 v[64:79], v[52:55], v[44:47], v[64:79]
    s_add_u32 m0, s48, 102400
    s_nop 0
    buffer_load_dwordx4 v1, s[16:19], s44 offen lds
    s_add_u32 m0, s48, 103424
    s_nop 0
    buffer_load_dwordx4 v2, s[16:19], s44 offen lds
    s_add_u32 m0, s49, 102400
    s_nop 0
    buffer_load_dwordx4 v4, s[20:23], s45 offen lds
    v_mfma_f32_32x32x16_bf16 v[80:95], v[52:55], v[48:51], v[80:95]
    s_add_u32 m0, s49, 103424
    s_nop 0
    buffer_load_dwordx4 v5, s[20:23], s45 offen lds
    s_add_u32 m0, s49, 104448
    s_nop 0
    buffer_load_dwordx4 v6, s[20:23], s45 offen lds
    s_add_u32 s44, s44, 64
    v_mfma_f32_32x32x16_bf16 v[96:111], v[56:59], v[44:47], v[96:111]
    s_add_u32 s45, s45, 36864
    ds_read_b128 v[24:27], v7 offset:0
    ds_read_b128 v[28:31], v7 offset:2048
    v_mfma_f32_32x32x16_bf16 v[112:127], v[56:59], v[48:51], v[112:127]
    ds_read_b64_tr_b16 v[32:33], v9 offset:0
    ds_read_b64_tr_b16 v[34:35], v9 offset:1536
    ds_read_b64_tr_b16 v[36:37], v10 offset:0
    v_mfma_f32_32x32x16_bf16 v[128:143], v[60:63], v[44:47], v[128:143]
    ds_read_b64_tr_b16 v[38:39], v10 offset:1536
    ds_read_b64_tr_b16 v[40:41], v11 offset:0
    ds_read_b64_tr_b16 v[42:43], v11 offset:1536
    v_mfma_f32_32x32x16_bf16 v[144:159], v[60:63], v[48:51], v[144:159]
    s_waitcnt lgkmcnt(0)
    v_mfma_f32_32x32x16_bf16 v[64:79], v[32:35], v[24:27], v[64:79]
    ds_read_b128 v[44:47], v8 offset:0
    ds_read_b128 v[48:51], v8 offset:2048
    v_mfma_f32_32x32x16_bf16 v[80:95], v[32:35], v[28:31], v[80:95]
    ds_read_b64_tr_b16 v[52:53], v9 offset:6144
    ds_read_b64_tr_b16 v[54:55], v9 offset:7680
    v_mfma_f32_32x32x16_bf16 v[96:111], v[36:39], v[24:27], v[96:111]
    ds_read_b64_tr_b16 v[56:57], v10 offset:6144
    ds_read_b64_tr_b16 v[58:59], v10 offset:7680
    v_mfma_f32_32x32x16_bf16 v[112:127], v[36:39], v[28:31], v[112:127]
    ds_read_b64_tr_b16 v[60:61], v11 offset:6144
    ds_read_b64_tr_b16 v[62:63], v11 offset:7680
    v_mfma_f32_32x32x16_bf16 v[128:143], v[40:43], v[24:27], v[128:143]
    v_mfma_f32_32x32x16_bf16 v[144:159], v[40:43], v[28:31], v[144:159]
    s_waitcnt lgkmcnt(0)
    s_waitcnt vmcnt(20)
    s_barrier
    v_mfma_f32_32x32x16_bf16 v[64:79], v[52:55], v[44:47], v[64:79]
    s_add_u32 m0, s48, 122880
    s_nop 0
    buffer_load_dwordx4 v1, s[16:19], s44 offen lds
    s_add_u32 m0, s48, 123904
    s_nop 0
    buffer_load_dwordx4 v2, s[16:19], s44 offen lds
    s_add_u32 m0, s49, 122880
    s_nop 0
    buffer_load_dwordx4 v4, s[20:23], s45 offen lds
    v_mfma_f32_32x32x16_bf16 v[80:95], v[52:55], v[48:51], v[80:95]
    s_add_u32 m0, s49, 123904
    s_nop 0
    buffer_load_dwordx4 v5, s[20:23], s45 offen lds
    s_add_u32 m0, s49, 124928
    s_nop 0
    buffer_load_dwordx4 v6, s[20:23], s45 offen lds
    s_add_u32 s44, s44, 64
    v_mfma_f32_32x32x16_bf16 v[96:111], v[56:59], v[44:47], v[96:111]
    s_add_u32 s45, s45, 36864
    ds_read_b128 v[24:27], v7 offset:20480
    ds_read_b128 v[28:31], v7 offset:22528
    v_mfma_f32_32x32x16_bf16 v[112:127], v[56:59], v[48:51], v[112:127]
    ds_read_b64_tr_b16 v[32:33], v9 offset:20480
    ds_read_b64_tr_b16 v[34:35], v9 offset:22016
    ds_read_b64_tr_b16 v[36:37], v10 offset:20480
    v_mfma_f32_32x32x16_bf16 v[128:143], v[60:63], v[44:47], v[128:143]
    ds_read_b64_tr_b16 v[38:39], v10 offset:22016
    ds_read_b64_tr_b16 v[40:41], v11 offset:20480
    ds_read_b64_tr_b16 v[42:43], v11 offset:22016
    v_mfma_f32_32x32x16_bf16 v[144:159], v[60:63], v[48:51], v[144:159]
    s_waitcnt lgkmcnt(0)
    v_mfma_f32_32x32x16_bf16 v[64:79], v[32:35], v[24:27], v[64:79]
    ds_read_b128 v[44:47], v8 offset:20480
    ds_read_b128 v[48:51], v8 offset:22528
    v_mfma_f32_32x32x16_bf16 v[80:95], v[32:35], v[28:31], v[80:95]
    ds_read_b64_tr_b16 v[52:53], v9 offset:26624
    ds_read_b64_tr_b16 v[54:55], v9 offset:28160
    v_mfma_f32_32x32x16_bf16 v[96:111], v[36:39], v[24:27], v[96:111]
    ds_read_b64_tr_b16 v[56:57], v10 offset:26624
    ds_read_b64_tr_b16 v[58:59], v10 offset:28160
    v_mfma_f32_32x32x16_bf16 v[112:127], v[36:39], v[28:31], v[112:127]
    ds_read_b64_tr_b16 v[60:61], v11 offset:26624
    ds_read_b64_tr_b16 v[62:63], v11 offset:28160
    v_mfma_f32_32x32x16_bf16 v[128:143], v[40:43], v[24:27], v[128:143]
    v_mfma_f32_32x32x16_bf16 v[144:159], v[40:43], v[28:31], v[144:159]
    s_waitcnt lgkmcnt(0)
    s_waitcnt vmcnt(20)
    s_barrier
    v_mfma_f32_32x32x16_bf16 v[64:79], v[52:55], v[44:47], v[64:79]
    s_add_u32 m0, s48, 0
    s_nop 0
    buffer_load_dwordx4 v1, s[16:19], s44 offen lds
    s_add_u32 m0, s48, 1024
    s_nop 0
    buffer_load_dwordx4 v2, s[16:19], s44 offen lds
    s_add_u32 m0, s49, 0
    s_nop 0
    buffer_load_dwordx4 v4, s[20:23], s45 offen lds
    v_mfma_f32_32x32x16_bf16 v[80:95], v[52:55], v[48:51], v[80:95]
    s_add_u32 m0, s49, 1024
    s_nop 0
    buffer_load_dwordx4 v5, s[20:23], s45 offen lds
    s_add_u32 m0, s49, 2048
    s_nop 0
    buffer_load_dwordx4 v6, s[20:23], s45 offen lds
    s_add_u32 s44, s44, 64
    v_mfma_f32_32x32x16_bf16 v[96:111], v[56:59], v[44:47], v[96:111]
    s_add_u32 s45, s45, 36864
    ds_read_b128 v[24:27], v160 offset:8192
    ds_read_b128 v[28:31], v160 offset:10240
    v_mfma_f32_32x32x16_bf16 v[112:127], v[56:59], v[48:51], v[112:127]
    ds_read_b64_tr_b16 v[32:33], v162 offset:8192
    ds_read_b64_tr_b16 v[34:35], v162 offset:9728
    ds_read_b64_tr_b16 v[36:37], v163 offset:8192
    v_mfma_f32_32x32x16_bf16 v[128:143], v[60:63], v[44:47], v[128:143]
    ds_read_b64_tr_b16 v[38:39], v163 offset:9728
    ds_read_b64_tr_b16 v[40:41], v164 offset:8192
    ds_read_b64_tr_b16 v[42:43], v164 offset:9728
    v_mfma_f32_32x32x16_bf16 v[144:159], v[60:63], v[48:51], v[144:159]
    s_waitcnt lgkmcnt(0)
    v_mfma_f32_32x32x16_bf16 v[64:79], v[32:35], v[24:27], v[64:79]
    ds_read_b128 v[44:47], v161 offset:8192
    ds_read_b128 v[48:51], v161 offset:10240
    v_mfma_f32_32x32x16_bf16 v[80:95], v[32:35], v[28:31], v[80:95]
    ds_read_b64_tr_b16 v[52:53], v162 offset:14336
    ds_read_b64_tr_b16 v[54:55], v162 offset:15872
    v_mfma_f32_32x32x16_bf16 v[96:111], v[36:39], v[24:27], v[96:111]
    ds_read_b64_tr_b16 v[56:57], v163 offset:14336
    ds_read_b64_tr_b16 v[58:59], v163 offset:15872
    v_mfma_f32_32x32x16_bf16 v[112:127], v[36:39], v[28:31], v[112:127]
    ds_read_b64_tr_b16 v[60:61], v164 offset:14336
    ds_read_b64_tr_b16 v[62:63], v164 offset:15872
    v_mfma_f32_32x32x16_bf16 v[128:143], v[40:43], v[24:27], v[128:143]
    v_mfma_f32_32x32x16_bf16 v[144:159], v[40:43], v[28:31], v[144:159]
    s_waitcnt lgkmcnt(0)
    s_waitcnt vmcnt(20)
    s_barrier
    v_mfma_f32_32x32x16_bf16 v[64:79], v[52:55], v[44:47], v[64:79]
    s_add_u32 m0, s48, 20480
    s_nop 0
    buffer_load_dwordx4 v1, s[16:19], s44 offen lds
    s_add_u32 m0, s48, 21504
    s_nop 0
    buffer_load_dwordx4 v2, s[16:19], s44 offen lds
    s_add_u32 m0, s49, 20480
    s_nop 0
    buffer_load_dwordx4 v4, s[20:23], s45 offen lds
    v_mfma_f32_32x32x16_bf16 v[80:95], v[52:55], v[48:51], v[80:95]
    s_add_u32 m0, s49, 21504
    s_nop 0
    buffer_load_dwordx4 v5, s[20:23], s45 offen lds
    s_add_u32 m0, s49, 22528
    s_nop 0
    buffer_load_dwordx4 v6, s[20:23], s45 offen lds
    s_add_u32 s44, s44, 64
    v_mfma_f32_32x32x16_bf16 v[96:111], v[56:59], v[44:47], v[96:111]
    s_add_u32 s45, s45, 36864
    ds_read_b128 v[24:27], v160 offset:28672
    ds_read_b128 v[28:31], v160 offset:30720
    v_mfma_f32_32x32x16_bf16 v[112:127], v[56:59], v[48:51], v[112:127]
    ds_read_b64_tr_b16 v[32:33], v162 offset:28672
    ds_read_b64_tr_b16 v[34:35], v162 offset:30208
    ds_read_b64_tr_b16 v[36:37], v163 offset:28672
    v_mfma_f32_32x32x16_bf16 v[128:143], v[60:63], v[44:47], v[128:143]
    ds_read_b64_tr_b16 v[38:39], v163 offset:30208
    ds_read_b64_tr_b16 v[40:41], v164 offset:28672
    ds_read_b64_tr_b16 v[42:43], v164 offset:30208
    v_mfma_f32_32x32x16_bf16 v[144:159], v[60:63], v[48:51], v[144:159]
    s_waitcnt lgkmcnt(0)
    v_mfma_f32_32x32x16_bf16 v[64:79], v[32:35], v[24:27], v[64:79]
    ds_read_b128 v[44:47], v161 offset:28672
    ds_read_b128 v[48:51], v161 offset:30720
    v_mfma_f32_32x32x16_bf16 v[80:95], v[32:35], v[28:31], v[80:95]
    ds_read_b64_tr_b16 v[52:53], v162 offset:34816
    ds_read_b64_tr_b16 v[54:55], v162 offset:36352
    v_mfma_f32_32x32x16_bf16 v[96:111], v[36:39], v[24:27], v[96:111]
    ds_read_b64_tr_b16 v[56:57], v163 offset:34816
    ds_read_b64_tr_b16 v[58:59], v163 offset:36352
    v_mfma_f32_32x32x16_bf16 v[112:127], v[36:39], v[28:31], v[112:127]
    ds_read_b64_tr_b16 v[60:61], v164 offset:34816
    ds_read_b64_tr_b16 v[62:63], v164 offset:36352
    v_mfma_f32_32x32x16_bf16 v[128:143], v[40:43], v[24:27], v[128:143]
    v_mfma_f32_32x32x16_bf16 v[144:159], v[40:43], v[28:31], v[144:159]
    s_waitcnt lgkmcnt(0)
    s_waitcnt vmcnt(20)
    s_barrier
    v_mfma_f32_32x32x16_bf16 v[64:79], v[52:55], v[44:47], v[64:79]
    s_add_u32 m0, s48, 40960
    s_nop 0
    buffer_load_dwordx4 v1, s[16:19], s44 offen lds
    s_add_u32 m0, s48, 41984
    s_nop 0
    buffer_load_dwordx4 v2, s[16:19], s44 offen lds
    s_add_u32 m0, s49, 40960
    s_nop 0
    buffer_load_dwordx4 v4, s[20:23], s45 offen lds
    v_mfma_f32_32x32x16_bf16 v[80:95], v[52:55], v[48:51], v[80:95]
    s_add_u32 m0, s49, 41984
    s_nop 0
    buffer_load_dwordx4 v5, s[20:23], s45 offen lds
    s_add_u32 m0, s49, 43008
    s_nop 0
    buffer_load_dwordx4 v6, s[20:23], s45 offen lds
    s_add_u32 s44, s44, 64
    v_mfma_f32_32x32x16_bf16 v[96:111], v[56:59], v[44:47], v[96:111]
    s_add_u32 s45, s45, 36864
    ds_read_b128 v[24:27], v165 offset:16384
    ds_read_b128 v[28:31], v165 offset:18432
    v_mfma_f32_32x32x16_bf16 v[112:127], v[56:59], v[48:51], v[112:127]
    ds_read_b64_tr_b16 v[32:33], v167 offset:16384
    ds_read_b64_tr_b16 v[34:35], v167 offset:17920
    ds_read_b64_tr_b16 v[36:37], v168 offset:16384
    v_mfma_f32_32x32x16_bf16 v[128:143], v[60:63], v[44:47], v[128:143]
    ds_read_b64_tr_b16 v[38:39], v168 offset:17920
    ds_read_b64_tr_b16 v[40:41], v169 offset:16384
    ds_read_b64_tr_b16 v[42:43], v169 offset:17920
    v_mfma_f32_32x32x16_bf16 v[144:159], v[60:63], v[48:51], v[144:159]
    s_waitcnt lgkmcnt(0)
    v_mfma_f32_32x32x16_bf16 v[64:79], v[32:35], v[24:27], v[64:79]
    ds_read_b128 v[44:47], v166 offset:16384
    ds_read_b128 v[48:51], v166 offset:18432
    v_mfma_f32_32x32x16_bf16 v[80:95], v[32:35], v[28:31], v[80:95]
    ds_read_b64_tr_b16 v[52:53], v167 offset:22528
    ds_read_b64_tr_b16 v[54:55], v167 offset:24064
    v_mfma_f32_32x32x16_bf16 v[96:111], v[36:39], v[24:27], v[96:111]
    ds_read_b64_tr_b16 v[56:57], v168 offset:22528
    ds_read_b64_tr_b16 v[58:59], v168 offset:24064
    v_mfma_f32_32x32x16_bf16 v[112:127], v[36:39], v[28:31], v[112:127]
    ds_read_b64_tr_b16 v[60:61], v169 offset:22528
    ds_read_b64_tr_b16 v[62:63], v169 offset:24064
    v_mfma_f32_32x32x16_bf16 v[128:143], v[40:43], v[24:27], v[128:143]
    v_mfma_f32_32x32x16_bf16 v[144:159], v[40:43], v[28:31], v[144:159]
    s_waitcnt lgkmcnt(0)
    s_waitcnt vmcnt(20)
    s_barrier
    v_mfma_f32_32x32x16_bf16 v[64:79], v[52:55], v[44:47], v[64:79]
    s_add_u32 m0, s48, 61440
    s_nop 0
    buffer_load_dwordx4 v1, s[16:19], s44 offen lds
    s_add_u32 m0, s48, 62464
    s_nop 0
    buffer_load_dwordx4 v2, s[16:19], s44 offen lds
    s_add_u32 m0, s49, 61440
    s_nop 0
    buffer_load_dwordx4 v4, s[20:23], s45 offen lds
    v_mfma_f32_32x32x16_bf16 v[80:95], v[52:55], v[48:51], v[80:95]
    s_add_u32 m0, s49, 62464
    s_nop 0
    buffer_load_dwordx4 v5, s[20:23], s45 offen lds
    s_add_u32 m0, s49, 63488
    s_nop 0
    buffer_load_dwordx4 v6, s[20:23], s45 offen lds
    s_add_u32 s44, s44, 64
    v_mfma_f32_32x32x16_bf16 v[96:111], v[56:59], v[44:47], v[96:111]
    s_add_u32 s45, s45, 36864
    ds_read_b128 v[24:27], v170 offset:4096
    ds_read_b128 v[28:31], v170 offset:6144
    v_mfma_f32_32x32x16_bf16 v[112:127], v[56:59], v[48:51], v[112:127]
    ds_read_b64_tr_b16 v[32:33], v172 offset:4096
    ds_read_b64_tr_b16 v[34:35], v172 offset:5632
    ds_read_b64_tr_b16 v[36:37], v173 offset:4096
    v_mfma_f32_32x32x16_bf16 v[128:143], v[60:63], v[44:47], v[128:143]
    ds_read_b64_tr_b16 v[38:39], v173 offset:5632
    ds_read_b64_tr_b16 v[40:41], v174 offset:4096
    ds_read_b64_tr_b16 v[42:43], v174 offset:5632
    v_mfma_f32_32x32x16_bf16 v[144:159], v[60:63], v[48:51], v[144:159]
    s_waitcnt lgkmcnt(0)
    v_mfma_f32_32x32x16_bf16 v[64:79], v[32:35], v[24:27], v[64:79]
    ds_read_b128 v[44:47], v171 offset:4096
    ds_read_b128 v[48:51], v171 offset:6144
    v_mfma_f32_32x32x16_bf16 v[80:95], v[32:35], v[28:31], v[80:95]
    ds_read_b64_tr_b16 v[52:53], v172 offset:10240
    ds_read_b64_tr_b16 v[54:55], v172 offset:11776
    v_mfma_f32_32x32x16_bf16 v[96:111], v[36:39], v[24:27], v[96:111]
    ds_read_b64_tr_b16 v[56:57], v173 offset:10240
    ds_read_b64_tr_b16 v[58:59], v173 offset:11776
    v_mfma_f32_32x32x16_bf16 v[112:127], v[36:39], v[28:31], v[112:127]
    ds_read_b64_tr_b16 v[60:61], v174 offset:10240
    ds_read_b64_tr_b16 v[62:63], v174 offset:11776
    v_mfma_f32_32x32x16_bf16 v[128:143], v[40:43], v[24:27], v[128:143]
    v_mfma_f32_32x32x16_bf16 v[144:159], v[40:43], v[28:31], v[144:159]
    s_waitcnt lgkmcnt(0)
    s_waitcnt vmcnt(20)
    s_barrier
    v_mfma_f32_32x32x16_bf16 v[64:79], v[52:55], v[44:47], v[64:79]
    ds_read_b128 v[24:27], v170 offset:24576
    ds_read_b128 v[28:31], v170 offset:26624
    v_mfma_f32_32x32x16_bf16 v[80:95], v[52:55], v[48:51], v[80:95]
    ds_read_b64_tr_b16 v[32:33], v172 offset:24576
    ds_read_b64_tr_b16 v[34:35], v172 offset:26112
    v_mfma_f32_32x32x16_bf16 v[96:111], v[56:59], v[44:47], v[96:111]
    ds_read_b64_tr_b16 v[36:37], v173 offset:24576
    ds_read_b64_tr_b16 v[38:39], v173 offset:26112
    v_mfma_f32_32x32x16_bf16 v[112:127], v[56:59], v[48:51], v[112:127]
    ds_read_b64_tr_b16 v[40:41], v174 offset:24576
    ds_read_b64_tr_b16 v[42:43], v174 offset:26112
    v_mfma_f32_32x32x16_bf16 v[128:143], v[60:63], v[44:47], v[128:143]
    v_mfma_f32_32x32x16_bf16 v[144:159], v[60:63], v[48:51], v[144:159]
    s_waitcnt lgkmcnt(0)
    v_mfma_f32_32x32x16_bf16 v[64:79], v[32:35], v[24:27], v[64:79]
    ds_read_b128 v[44:47], v171 offset:24576
    ds_read_b128 v[48:51], v171 offset:26624
    v_mfma_f32_32x32x16_bf16 v[80:95], v[32:35], v[28:31], v[80:95]
    ds_read_b64_tr_b16 v[52:53], v172 offset:30720
    ds_read_b64_tr_b16 v[54:55], v172 offset:32256
    v_mfma_f32_32x32x16_bf16 v[96:111], v[36:39], v[24:27], v[96:111]
    ds_read_b64_tr_b16 v[56:57], v173 offset:30720
    ds_read_b64_tr_b16 v[58:59], v173 offset:32256
    v_mfma_f32_32x32x16_bf16 v[112:127], v[36:39], v[28:31], v[112:127]
    ds_read_b64_tr_b16 v[60:61], v174 offset:30720
    ds_read_b64_tr_b16 v[62:63], v174 offset:32256
    v_mfma_f32_32x32x16_bf16 v[128:143], v[40:43], v[24:27], v[128:143]
    v_mfma_f32_32x32x16_bf16 v[144:159], v[40:43], v[28:31], v[144:159]
    s_waitcnt lgkmcnt(0)
    s_waitcnt vmcnt(15)
    s_barrier
    v_mfma_f32_32x32x16_bf16 v[64:79], v[52:55], v[44:47], v[64:79]
    ds_read_b128 v[24:27], v7 offset:0
    ds_read_b128 v[28:31], v7 offset:2048
    v_mfma_f32_32x32x16_bf16 v[80:95], v[52:55], v[48:51], v[80:95]
    ds_read_b64_tr_b16 v[32:33], v9 offset:0
    ds_read_b64_tr_b16 v[34:35], v9 offset:1536
    v_mfma_f32_32x32x16_bf16 v[96:111], v[56:59], v[44:47], v[96:111]
    ds_read_b64_tr_b16 v[36:37], v10 offset:0
    ds_read_b64_tr_b16 v[38:39], v10 offset:1536
    v_mfma_f32_32x32x16_bf16 v[112:127], v[56:59], v[48:51], v[112:127]
    ds_read_b64_tr_b16 v[40:41], v11 offset:0
    ds_read_b64_tr_b16 v[42:43], v11 offset:1536
    v_mfma_f32_32x32x16_bf16 v[128:143], v[60:63], v[44:47], v[128:143]
    v_mfma_f32_32x32x16_bf16 v[144:159], v[60:63], v[48:51], v[144:159]
    s_waitcnt lgkmcnt(0)
    v_mfma_f32_32x32x16_bf16 v[64:79], v[32:35], v[24:27], v[64:79]
    ds_read_b128 v[44:47], v8 offset:0
    ds_read_b128 v[48:51], v8 offset:2048
    v_mfma_f32_32x32x16_bf16 v[80:95], v[32:35], v[28:31], v[80:95]
    ds_read_b64_tr_b16 v[52:53], v9 offset:6144
    ds_read_b64_tr_b16 v[54:55], v9 offset:7680
    v_mfma_f32_32x32x16_bf16 v[96:111], v[36:39], v[24:27], v[96:111]
    ds_read_b64_tr_b16 v[56:57], v10 offset:6144
    ds_read_b64_tr_b16 v[58:59], v10 offset:7680
    v_mfma_f32_32x32x16_bf16 v[112:127], v[36:39], v[28:31], v[112:127]
    ds_read_b64_tr_b16 v[60:61], v11 offset:6144
    ds_read_b64_tr_b16 v[62:63], v11 offset:7680
    v_mfma_f32_32x32x16_bf16 v[128:143], v[40:43], v[24:27], v[128:143]
    v_mfma_f32_32x32x16_bf16 v[144:159], v[40:43], v[28:31], v[144:159]
    s_waitcnt lgkmcnt(0)
    s_waitcnt vmcnt(10)
    s_barrier
    v_mfma_f32_32x32x16_bf16 v[64:79], v[52:55], v[44:47], v[64:79]
    ds_read_b128 v[24:27], v7 offset:20480
    ds_read_b128 v[28:31], v7 offset:22528
    v_mfma_f32_32x32x16_bf16 v[80:95], v[52:55], v[48:51], v[80:95]
    ds_read_b64_tr_b16 v[32:33], v9 offset:20480
    ds_read_b64_tr_b16 v[34:35], v9 offset:22016
    v_mfma_f32_32x32x16_bf16 v[96:111], v[56:59], v[44:47], v[96:111]
    ds_read_b64_tr_b16 v[36:37], v10 offset:20480
    ds_read_b64_tr_b16 v[38:39], v10 offset:22016
    v_mfma_f32_32x32x16_bf16 v[112:127], v[56:59], v[48:51], v[112:127]
    ds_read_b64_tr_b16 v[40:41], v11 offset:20480
    ds_read_b64_tr_b16 v[42:43], v11 offset:22016
    v_mfma_f32_32x32x16_bf16 v[128:143], v[60:63], v[44:47], v[128:143]
    v_mfma_f32_32x32x16_bf16 v[144:159], v[60:63], v[48:51], v[144:159]
    s_waitcnt lgkmcnt(0)
    v_mfma_f32_32x32x16_bf16 v[64:79], v[32:35], v[24:27], v[64:79]
    ds_read_b128 v[44:47], v8 offset:20480
    ds_read_b128 v[48:51], v8 offset:22528
    v_mfma_f32_32x32x16_bf16 v[80:95], v[32:35], v[28:31], v[80:95]
    ds_read_b64_tr_b16 v[52:53], v9 offset:26624
    ds_read_b64_tr_b16 v[54:55], v9 offset:28160
    v_mfma_f32_32x32x16_bf16 v[96:111], v[36:39], v[24:27], v[96:111]
    ds_read_b64_tr_b16 v[56:57], v10 offset:26624
    ds_read_b64_tr_b16 v[58:59], v10 offset:28160
    v_mfma_f32_32x32x16_bf16 v[112:127], v[36:39], v[28:31], v[112:127]
    ds_read_b64_tr_b16 v[60:61], v11 offset:26624
    ds_read_b64_tr_b16 v[62:63], v11 offset:28160
    v_mfma_f32_32x32x16_bf16 v[128:143], v[40:43], v[24:27], v[128:143]
    v_mfma_f32_32x32x16_bf16 v[144:159], v[40:43], v[28:31], v[144:159]
    s_waitcnt lgkmcnt(0)
    s_waitcnt vmcnt(5)
    s_barrier
    v_mfma_f32_32x32x16_bf16 v[64:79], v[52:55], v[44:47], v[64:79]
    ds_read_b128 v[24:27], v160 offset:8192
    ds_read_b128 v[28:31], v160 offset:10240
    v_mfma_f32_32x32x16_bf16 v[80:95], v[52:55], v[48:51], v[80:95]
    ds_read_b64_tr_b16 v[32:33], v162 offset:8192
    ds_read_b64_tr_b16 v[34:35], v162 offset:9728
    v_mfma_f32_32x32x16_bf16 v[96:111], v[56:59], v[44:47], v[96:111]
    ds_read_b64_tr_b16 v[36:37], v163 offset:8192
    ds_read_b64_tr_b16 v[38:39], v163 offset:9728
    v_mfma_f32_32x32x16_bf16 v[112:127], v[56:59], v[48:51], v[112:127]
    ds_read_b64_tr_b16 v[40:41], v164 offset:8192
    ds_read_b64_tr_b16 v[42:43], v164 offset:9728
    v_mfma_f32_32x32x16_bf16 v[128:143], v[60:63], v[44:47], v[128:143]
    v_mfma_f32_32x32x16_bf16 v[144:159], v[60:63], v[48:51], v[144:159]
    s_waitcnt lgkmcnt(0)
    v_mfma_f32_32x32x16_bf16 v[64:79], v[32:35], v[24:27], v[64:79]
    ds_read_b128 v[44:47], v161 offset:8192
    ds_read_b128 v[48:51], v161 offset:10240
    v_mfma_f32_32x32x16_bf16 v[80:95], v[32:35], v[28:31], v[80:95]
    ds_read_b64_tr_b16 v[52:53], v162 offset:14336
    ds_read_b64_tr_b16 v[54:55], v162 offset:15872
    v_mfma_f32_32x32x16_bf16 v[96:111], v[36:39], v[24:27], v[96:111]
    ds_read_b64_tr_b16 v[56:57], v163 offset:14336
    ds_read_b64_tr_b16 v[58:59], v163 offset:15872
    v_mfma_f32_32x32x16_bf16 v[112:127], v[36:39], v[28:31], v[112:127]
    ds_read_b64_tr_b16 v[60:61], v164 offset:14336
    ds_read_b64_tr_b16 v[62:63], v164 offset:15872
    v_mfma_f32_32x32x16_bf16 v[128:143], v[40:43], v[24:27], v[128:143]
    v_mfma_f32_32x32x16_bf16 v[144:159], v[40:43], v[28:31], v[144:159]
    s_waitcnt lgkmcnt(0)
    s_waitcnt vmcnt(0)
    s_barrier
    v_mfma_f32_32x32x16_bf16 v[64:79], v[52:55], v[44:47], v[64:79]
    ds_read_b128 v[24:27], v160 offset:28672
    ds_read_b128 v[28:31], v160 offset:30720
    v_mfma_f32_32x32x16_bf16 v[80:95], v[52:55], v[48:51], v[80:95]
    ds_read_b64_tr_b16 v[32:33], v162 offset:28672
    ds_read_b64_tr_b16 v[34:35], v162 offset:30208
    v_mfma_f32_32x32x16_bf16 v[96:111], v[56:59], v[44:47], v[96:111]
    ds_read_b64_tr_b16 v[36:37], v163 offset:28672
    ds_read_b64_tr_b16 v[38:39], v163 offset:30208
    v_mfma_f32_32x32x16_bf16 v[112:127], v[56:59], v[48:51], v[112:127]
    ds_read_b64_tr_b16 v[40:41], v164 offset:28672
    ds_read_b64_tr_b16 v[42:43], v164 offset:30208
    v_mfma_f32_32x32x16_bf16 v[128:143], v[60:63], v[44:47], v[128:143]
    v_mfma_f32_32x32x16_bf16 v[144:159], v[60:63], v[48:51], v[144:159]
    s_waitcnt lgkmcnt(0)
    v_mfma_f32_32x32x16_bf16 v[64:79], v[32:35], v[24:27], v[64:79]
    ds_read_b128 v[44:47], v161 offset:28672
    ds_read_b128 v[48:51], v161 offset:30720
    v_mfma_f32_32x32x16_bf16 v[80:95], v[32:35], v[28:31], v[80:95]
    ds_read_b64_tr_b16 v[52:53], v162 offset:34816
    ds_read_b64_tr_b16 v[54:55], v162 offset:36352
    v_mfma_f32_32x32x16_bf16 v[96:111], v[36:39], v[24:27], v[96:111]
    ds_read_b64_tr_b16 v[56:57], v163 offset:34816
    ds_read_b64_tr_b16 v[58:59], v163 offset:36352
    v_mfma_f32_32x32x16_bf16 v[112:127], v[36:39], v[28:31], v[112:127]
    ds_read_b64_tr_b16 v[60:61], v164 offset:34816
    ds_read_b64_tr_b16 v[62:63], v164 offset:36352
    v_mfma_f32_32x32x16_bf16 v[128:143], v[40:43], v[24:27], v[128:143]
    v_mfma_f32_32x32x16_bf16 v[144:159], v[40:43], v[28:31], v[144:159]
    s_waitcnt lgkmcnt(0)
    v_mfma_f32_32x32x16_bf16 v[64:79], v[52:55], v[44:47], v[64:79]
    v_mfma_f32_32x32x16_bf16 v[80:95], v[52:55], v[48:51], v[80:95]
    v_mfma_f32_32x32x16_bf16 v[96:111], v[56:59], v[44:47], v[96:111]
    v_mfma_f32_32x32x16_bf16 v[112:127], v[56:59], v[48:51], v[112:127]
    v_mfma_f32_32x32x16_bf16 v[128:143], v[60:63], v[44:47], v[128:143]
    v_mfma_f32_32x32x16_bf16 v[144:159], v[60:63], v[48:51], v[144:159]
.g5_epi:
    s_nop 15
    s_add_u32 s24, s8, 50331648
    s_addc_u32 s25, s9, 0
    s_mov_b32 s26, 23592960
    s_mov_b32 s27, 0x00020000
    s_barrier
    v_lshrrev_b32 v18, 6, v0
    v_lshrrev_b32 v19, 1, v18
    v_mul_u32_u24 v19, 64, v19
    v_and_b32 v20, 31, v0
    v_add_u32 v19, v19, v20
    v_mul_u32_u24 v19, 784, v19
    v_and_b32 v18, 1, v18
    v_mul_u32_u24 v18, 96, v18
    v_bfe_u32 v20, v0, 5, 1
    v_lshl_add_u32 v18, v20, 2, v18
    v_mul_u32_u24 v18, 4, v18
    v_add_u32 v1, v18, v19
    ds_write_b128 v1, v[64:67] offset:0
    ds_write_b128 v1, v[68:71] offset:32
    ds_write_b128 v1, v[72:75] offset:64
    ds_write_b128 v1, v[76:79] offset:96
    ds_write_b128 v1, v[80:83] offset:25088
    ds_write_b128 v1, v[84:87] offset:25120
    ds_write_b128 v1, v[88:91] offset:25152
    ds_write_b128 v1, v[92:95] offset:25184
    ds_write_b128 v1, v[96:99] offset:128
    ds_write_b128 v1, v[100:103] offset:160
    ds_write_b128 v1, v[104:107] offset:192
    ds_write_b128 v1, v[108:111] offset:224
    ds_write_b128 v1, v[112:115] offset:25216
    ds_write_b128 v1, v[116:119] offset:25248
    ds_write_b128 v1, v[120:123] offset:25280
    ds_write_b128 v1, v[124:127] offset:25312
    ds_write_b128 v1, v[128:131] offset:256
    ds_write_b128 v1, v[132:135] offset:288
    ds_write_b128 v1, v[136:139] offset:320
    ds_write_b128 v1, v[140:143] offset:352
    ds_write_b128 v1, v[144:147] offset:25344
    ds_write_b128 v1, v[148:151] offset:25376
    ds_write_b128 v1, v[152:155] offset:25408
    ds_write_b128 v1, v[156:159] offset:25440
    s_waitcnt lgkmcnt(0)
    s_barrier
    s_mov_b32 s42, 89478486
    s_lshl_b32 s43, s41, 2
    v_add_u32 v17, 0, v0
    v_mul_hi_u32 v18, v17, s42
    v_mul_u32_u24 v19, 48, v18
    v_sub_u32 v19, v17, v19
    v_mul_u32_u24 v20, 784, v18
    v_lshl_add_u32 v20, v19, 4, v20
    ds_read_b128 v[24:27], v20
    v_add_u32 v18, s40, v18
    v_mul_u32_u24 v18, 2304, v18
    v_lshl_add_u32 v18, v19, 4, v18
    v_add_u32 v48, s43, v18
    v_add_u32 v17, 256, v0
    v_mul_hi_u32 v18, v17, s42
    v_mul_u32_u24 v19, 48, v18
    v_sub_u32 v19, v17, v19
    v_mul_u32_u24 v20, 784, v18
    v_lshl_add_u32 v20, v19, 4, v20
    ds_read_b128 v[28:31], v20
    v_add_u32 v18, s40, v18
    v_mul_u32_u24 v18, 2304, v18
    v_lshl_add_u32 v18, v19, 4, v18
    v_add_u32 v49, s43, v18
    v_add_u32 v17, 512, v0
    v_mul_hi_u32 v18, v17, s42
    v_mul_u32_u24 v19, 48, v18
    v_sub_u32 v19, v17, v19
    v_mul_u32_u24 v20, 784, v18
    v_lshl_add_u32 v20, v19, 4, v20
    ds_read_b128 v[32:35], v20
    v_add_u32 v18, s40, v18
    v_mul_u32_u24 v18, 2304, v18
    v_lshl_add_u32 v18, v19, 4, v18
    v_add_u32 v50, s43, v18
    v_add_u32 v17, 768, v0
    v_mul_hi_u32 v18, v17, s42
    v_mul_u32_u24 v19, 48, v18
    v_sub_u32 v19, v17, v19
    v_mul_u32_u24 v20, 784, v18
    v_lshl_add_u32 v20, v19, 4, v20
    ds_read_b128 v[36:39], v20
    v_add_u32 v18, s40, v18
    v_mul_u32_u24 v18, 2304, v18
    v_lshl_add_u32 v18, v19, 4, v18
    v_add_u32 v51, s43, v18
    v_add_u32 v17, 1024, v0
    v_mul_hi_u32 v18, v17, s42
    v_mul_u32_u24 v19, 48, v18
    v_sub_u32 v19, v17, v19
    v_mul_u32_u24 v20, 784, v18
    v_lshl_add_u32 v20, v19, 4, v20
    ds_read_b128 v[40:43], v20
    v_add_u32 v18, s40, v18
    v_mul_u32_u24 v18, 2304, v18
    v_lshl_add_u32 v18, v19, 4, v18
    v_add_u32 v52, s43, v18
    v_add_u32 v17, 1280, v0
    v_mul_hi_u32 v18, v17, s42
    v_mul_u32_u24 v19, 48, v18
    v_sub_u32 v19, v17, v19
    v_mul_u32_u24 v20, 784, v18
    v_lshl_add_u32 v20, v19, 4, v20
    ds_read_b128 v[44:47], v20
    v_add_u32 v18, s40, v18
    v_mul_u32_u24 v18, 2304, v18
    v_lshl_add_u32 v18, v19, 4, v18
    v_add_u32 v53, s43, v18
    s_waitcnt lgkmcnt(0)
    buffer_store_dwordx4 v[24:27], v48, s[24:27], s50 offen
    buffer_store_dwordx4 v[28:31], v49, s[24:27], s50 offen
    buffer_store_dwordx4 v[32:35], v50, s[24:27], s50 offen
    buffer_store_dwordx4 v[36:39], v51, s[24:27], s50 offen
    buffer_store_dwordx4 v[40:43], v52, s[24:27], s50 offen
    buffer_store_dwordx4 v[44:47], v53, s[24:27], s50 offen
    s_nop 1
    v_add_u32 v17, 1536, v0
    v_mul_hi_u32 v18, v17, s42
    v_mul_u32_u24 v19, 48, v18
    v_sub_u32 v19, v17, v19
    v_mul_u32_u24 v20, 784, v18
    v_lshl_add_u32 v20, v19, 4, v20
    ds_read_b128 v[24:27], v20
    v_add_u32 v18, s40, v18
    v_mul_u32_u24 v18, 2304, v18
    v_lshl_add_u32 v18, v19, 4, v18
    v_add_u32 v48, s43, v18
    v_add_u32 v17, 1792, v0
    v_mul_hi_u32 v18, v17, s42
    v_mul_u32_u24 v19, 48, v18
    v_sub_u32 v19, v17, v19
    v_mul_u32_u24 v20, 784, v18
    v_lshl_add_u32 v20, v19, 4, v20
    ds_read_b128 v[28:31], v20
    v_add_u32 v18, s40, v18
    v_mul_u32_u24 v18, 2304, v18
    v_lshl_add_u32 v18, v19, 4, v18
    v_add_u32 v49, s43, v18
    v_add_u32 v17, 2048, v0
    v_mul_hi_u32 v18, v17, s42
    v_mul_u32_u24 v19, 48, v18
    v_sub_u32 v19, v17, v19
    v_mul_u32_u24 v20, 784, v18
    v_lshl_add_u32 v20, v19, 4, v20
    ds_read_b128 v[32:35], v20
    v_add_u32 v18, s40, v18
    v_mul_u32_u24 v18, 2304, v18
    v_lshl_add_u32 v18, v19, 4, v18
    v_add_u32 v50, s43, v18
    v_add_u32 v17, 2304, v0
    v_mul_hi_u32 v18, v17, s42
    v_mul_u32_u24 v19, 48, v18
    v_sub_u32 v19, v17, v19
    v_mul_u32_u24 v20, 784, v18
    v_lshl_add_u32 v20, v19, 4, v20
    ds_read_b128 v[36:39], v20
    v_add_u32 v18, s40, v18
    v_mul_u32_u24 v18, 2304, v18
    v_lshl_add_u32 v18, v19, 4, v18
    v_add_u32 v51, s43, v18
    v_add_u32 v17, 2560, v0
    v_mul_hi_u32 v18, v17, s42
    v_mul_u32_u24 v19, 48, v18
    v_sub_u32 v19, v17, v19
    v_mul_u32_u24 v20, 784, v18
    v_lshl_add_u32 v20, v19, 4, v20
    ds_read_b128 v[40:43], v20
    v_add_u32 v18, s40, v18
    v_mul_u32_u24 v18, 2304, v18
    v_lshl_add_u32 v18, v19, 4, v18
    v_add_u32 v52, s43, v18
    v_add_u32 v17, 2816, v0
    v_mul_hi_u32 v18, v17, s42
    v_mul_u32_u24 v19, 48, v18
    v_sub_u32 v19, v17, v19
    v_mul_u32_u24 v20, 784, v18
    v_lshl_add_u32 v20, v19, 4, v20
    ds_read_b128 v[44:47], v20
    v_add_u32 v18, s40, v18
    v_mul_u32_u24 v18, 2304, v18
    v_lshl_add_u32 v18, v19, 4, v18
    v_add_u32 v53, s43, v18
    s_waitcnt lgkmcnt(0)
    buffer_store_dwordx4 v[24:27], v48, s[24:27], s50 offen
    buffer_store_dwordx4 v[28:31], v49, s[24:27], s50 offen
    buffer_store_dwordx4 v[32:35], v50, s[24:27], s50 offen
    buffer_store_dwordx4 v[36:39], v51, s[24:27], s50 offen
    buffer_store_dwordx4 v[40:43], v52, s[24:27], s50 offen
    buffer_store_dwordx4 v[44:47], v53, s[24:27], s50 offen
    s_nop 1
    v_add_u32 v17, 3072, v0
    v_mul_hi_u32 v18, v17, s42
    v_mul_u32_u24 v19, 48, v18
    v_sub_u32 v19, v17, v19
    v_mul_u32_u24 v20, 784, v18
    v_lshl_add_u32 v20, v19, 4, v20
    ds_read_b128 v[24:27], v20
    v_add_u32 v18, s40, v18
    v_mul_u32_u24 v18, 2304, v18
    v_lshl_add_u32 v18, v19, 4, v18
    v_add_u32 v48, s43, v18
    v_add_u32 v17, 3328, v0
    v_mul_hi_u32 v18, v17, s42
    v_mul_u32_u24 v19, 48, v18
    v_sub_u32 v19, v17, v19
    v_mul_u32_u24 v20, 784, v18
    v_lshl_add_u32 v20, v19, 4, v20
    ds_read_b128 v[28:31], v20
    v_add_u32 v18, s40, v18
    v_mul_u32_u24 v18, 2304, v18
    v_lshl_add_u32 v18, v19, 4, v18
    v_add_u32 v49, s43, v18
    v_add_u32 v17, 3584, v0
    v_mul_hi_u32 v18, v17, s42
    v_mul_u32_u24 v19, 48, v18
    v_sub_u32 v19, v17, v19
    v_mul_u32_u24 v20, 784, v18
    v_lshl_add_u32 v20, v19, 4, v20
    ds_read_b128 v[32:35], v20
    v_add_u32 v18, s40, v18
    v_mul_u32_u24 v18, 2304, v18
    v_lshl_add_u32 v18, v19, 4, v18
    v_add_u32 v50, s43, v18
    v_add_u32 v17, 3840, v0
    v_mul_hi_u32 v18, v17, s42
    v_mul_u32_u24 v19, 48, v18
    v_sub_u32 v19, v17, v19
    v_mul_u32_u24 v20, 784, v18
    v_lshl_add_u32 v20, v19, 4, v20
    ds_read_b128 v[36:39], v20
    v_add_u32 v18, s40, v18
    v_mul_u32_u24 v18, 2304, v18
    v_lshl_add_u32 v18, v19, 4, v18
    v_add_u32 v51, s43, v18
    v_add_u32 v17, 4096, v0
    v_mul_hi_u32 v18, v17, s42
    v_mul_u32_u24 v19, 48, v18
    v_sub_u32 v19, v17, v19
    v_mul_u32_u24 v20, 784, v18
    v_lshl_add_u32 v20, v19, 4, v20
    ds_read_b128 v[40:43], v20
    v_add_u32 v18, s40, v18
    v_mul_u32_u24 v18, 2304, v18
    v_lshl_add_u32 v18, v19, 4, v18
    v_add_u32 v52, s43, v18
    v_add_u32 v17, 4352, v0
    v_mul_hi_u32 v18, v17, s42
    v_mul_u32_u24 v19, 48, v18
    v_sub_u32 v19, v17, v19
    v_mul_u32_u24 v20, 784, v18
    v_lshl_add_u32 v20, v19, 4, v20
    ds_read_b128 v[44:47], v20
    v_add_u32 v18, s40, v18
    v_mul_u32_u24 v18, 2304, v18
    v_lshl_add_u32 v18, v19, 4, v18
    v_add_u32 v53, s43, v18
    s_waitcnt lgkmcnt(0)
    buffer_store_dwordx4 v[24:27], v48, s[24:27], s50 offen
    buffer_store_dwordx4 v[28:31], v49, s[24:27], s50 offen
    buffer_store_dwordx4 v[32:35], v50, s[24:27], s50 offen
    buffer_store_dwordx4 v[36:39], v51, s[24:27], s50 offen
    buffer_store_dwordx4 v[40:43], v52, s[24:27], s50 offen
    buffer_store_dwordx4 v[44:47], v53, s[24:27], s50 offen
    s_nop 1
    v_add_u32 v17, 4608, v0
    v_mul_hi_u32 v18, v17, s42
    v_mul_u32_u24 v19, 48, v18
    v_sub_u32 v19, v17, v19
    v_mul_u32_u24 v20, 784, v18
    v_lshl_add_u32 v20, v19, 4, v20
    ds_read_b128 v[24:27], v20
    v_add_u32 v18, s40, v18
    v_mul_u32_u24 v18, 2304, v18
    v_lshl_add_u32 v18, v19, 4, v18
    v_add_u32 v48, s43, v18
    v_add_u32 v17, 4864, v0
    v_mul_hi_u32 v18, v17, s42
    v_mul_u32_u24 v19, 48, v18
    v_sub_u32 v19, v17, v19
    v_mul_u32_u24 v20, 784, v18
    v_lshl_add_u32 v20, v19, 4, v20
    ds_read_b128 v[28:31], v20
    v_add_u32 v18, s40, v18
    v_mul_u32_u24 v18, 2304, v18
    v_lshl_add_u32 v18, v19, 4, v18
    v_add_u32 v49, s43, v18
    v_add_u32 v17, 5120, v0
    v_mul_hi_u32 v18, v17, s42
    v_mul_u32_u24 v19, 48, v18
    v_sub_u32 v19, v17, v19
    v_mul_u32_u24 v20, 784, v18
    v_lshl_add_u32 v20, v19, 4, v20
    ds_read_b128 v[32:35], v20
    v_add_u32 v18, s40, v18
    v_mul_u32_u24 v18, 2304, v18
    v_lshl_add_u32 v18, v19, 4, v18
    v_add_u32 v50, s43, v18
    v_add_u32 v17, 5376, v0
    v_mul_hi_u32 v18, v17, s42
    v_mul_u32_u24 v19, 48, v18
    v_sub_u32 v19, v17, v19
    v_mul_u32_u24 v20, 784, v18
    v_lshl_add_u32 v20, v19, 4, v20
    ds_read_b128 v[36:39], v20
    v_add_u32 v18, s40, v18
    v_mul_u32_u24 v18, 2304, v18
    v_lshl_add_u32 v18, v19, 4, v18
    v_add_u32 v51, s43, v18
    v_add_u32 v17, 5632, v0
    v_mul_hi_u32 v18, v17, s42
    v_mul_u32_u24 v19, 48, v18
    v_sub_u32 v19, v17, v19
    v_mul_u32_u24 v20, 784, v18
    v_lshl_add_u32 v20, v19, 4, v20
    ds_read_b128 v[40:43], v20
    v_add_u32 v18, s40, v18
    v_mul_u32_u24 v18, 2304, v18
    v_lshl_add_u32 v18, v19, 4, v18
    v_add_u32 v52, s43, v18
    v_add_u32 v17, 5888, v0
    v_mul_hi_u32 v18, v17, s42
    v_mul_u32_u24 v19, 48, v18
    v_sub_u32 v19, v17, v19
    v_mul_u32_u24 v20, 784, v18
    v_lshl_add_u32 v20, v19, 4, v20
    ds_read_b128 v[44:47], v20
    v_add_u32 v18, s40, v18
    v_mul_u32_u24 v18, 2304, v18
    v_lshl_add_u32 v18, v19, 4, v18
    v_add_u32 v53, s43, v18
    s_waitcnt lgkmcnt(0)
    buffer_store_dwordx4 v[24:27], v48, s[24:27], s50 offen
    buffer_store_dwordx4 v[28:31], v49, s[24:27], s50 offen
    buffer_store_dwordx4 v[32:35], v50, s[24:27], s50 offen
    buffer_store_dwordx4 v[36:39], v51, s[24:27], s50 offen
    buffer_store_dwordx4 v[40:43], v52, s[24:27], s50 offen
    buffer_store_dwordx4 v[44:47], v53, s[24:27], s50 offen
    s_nop 1
.g5_end:
    s_endpgm
.globl reduce_kernel
.p2align 8
.type reduce_kernel,@function
reduce_kernel:
    s_cmp_ge_u32 s2, 576
    s_cbranch_scc1 .rd_end
    s_load_dwordx2 s[4:5], s[0:1], 88
    s_load_dwordx2 s[6:7], s[0:1], 64
    s_load_dwordx2 s[8:9], s[0:1], 0
    s_load_dwordx2 s[10:11], s[0:1], 72
    s_waitcnt lgkmcnt(0)
    s_add_u32 s16, s4, 50331648
    s_addc_u32 s17, s5, 0
    s_mov_b32 s18, 23592960
    s_mov_b32 s19, 0x00020000
    s_mov_b32 s20, s6
    s_mov_b32 s21, s7
    s_mov_b32 s22, 1152
    s_mov_b32 s23, 0x00020000
    s_mov_b32 s24, s8
    s_mov_b32 s25, s9
    s_mov_b32 s26, 2359296
    s_mov_b32 s27, 0x00020000
    s_mov_b32 s28, s10
    s_mov_b32 s29, s11
    s_mov_b32 s30, 2359296
    s_mov_b32 s31, 0x00020000
    s_lshl_b32 s3, s2, 8
    v_add_u32 v1, s3, v0
    s_mov_b32 s12, 59652324
    v_mul_hi_u32 v2, v1, s12
    v_mul_u32_u24 v2, 72, v2
    v_sub_u32 v2, v1, v2
    v_lshlrev_b32 v2, 4, v2
    v_lshlrev_b32 v3, 5, v1
    v_lshlrev_b32 v4, 4, v1
    s_mov_b32 s12, 0
    buffer_load_dwordx4 v[8:11], v3, s[16:19], s12 offen
    buffer_load_dwordx4 v[12:15], v3, s[16:19], s12 offen offset:16
    s_mov_b32 s12, 4718592
    buffer_load_dwordx4 v[16:19], v3, s[16:19], s12 offen
    buffer_load_dwordx4 v[20:23], v3, s[16:19], s12 offen offset:16
    s_mov_b32 s12, 9437184
    buffer_load_dwordx4 v[24:27], v3, s[16:19], s12 offen
    buffer_load_dwordx4 v[28:31], v3, s[16:19], s12 offen offset:16
    s_mov_b32 s12, 14155776
    buffer_load_dwordx4 v[32:35], v3, s[16:19], s12 offen
    buffer_load_dwordx4 v[36:39], v3, s[16:19], s12 offen offset:16
    s_mov_b32 s12, 18874368
    buffer_load_dwordx4 v[40:43], v3, s[16:19], s12 offen
    buffer_load_dwordx4 v[44:47], v3, s[16:19], s12 offen offset:16
    buffer_load_dwordx4 v[48:51], v4, s[24:27], 0 offen
    buffer_load_dwordx4 v[52:55], v2, s[20:23], 0 offen
    s_waitcnt vmcnt(0)
    v_add_f32 v8, v8, v16
    v_add_f32 v24, v24, v32
    v_add_f32 v9, v9, v17
    v_add_f32 v25, v25, v33
    v_add_f32 v10, v10, v18
    v_add_f32 v26, v26, v34
    v_add_f32 v11, v11, v19
    v_add_f32 v27, v27, v35
    v_add_f32 v12, v12, v20
    v_add_f32 v28, v28, v36
    v_add_f32 v13, v13, v21
    v_add_f32 v29, v29, v37
    v_add_f32 v14, v14, v22
    v_add_f32 v30, v30, v38
    v_add_f32 v15, v15, v23
    v_add_f32 v31, v31, v39
    v_add_f32 v8, v8, v24
    v_add_f32 v9, v9, v25
    v_add_f32 v10, v10, v26
    v_add_f32 v11, v11, v27
    v_add_f32 v12, v12, v28
    v_add_f32 v13, v13, v29
    v_add_f32 v14, v14, v30
    v_add_f32 v15, v15, v31
    v_lshlrev_b32 v60, 16, v48
    v_lshlrev_b32 v61, 16, v52
    v_cvt_pk_bf16_f32 v62, v8, v40
    v_lshlrev_b32 v63, 16, v62
    v_and_b32 v59, 0xffff0000, v62
    v_add_f32 v63, v63, v61
    v_cvt_pk_bf16_f32 v62, v63, v63
    v_lshlrev_b32 v63, 16, v62
    v_mul_f32 v62, 0xbfb8aa3b, v63
    v_exp_f32 v62, v62
    s_nop 0
    v_add_f32 v62, 1.0, v62
    v_rcp_f32 v62, v62
    s_nop 0
    v_mul_f32 v63, v63, v62
    v_cvt_pk_bf16_f32 v62, v63, v63
    v_lshlrev_b32 v63, 16, v62
    v_mul_f32 v63, v63, v59
    v_cvt_pk_bf16_f32 v62, v63, v63
    v_lshlrev_b32 v63, 16, v62
    v_add_f32 v8, v60, v63
    v_and_b32 v60, 0xffff0000, v48
    v_and_b32 v61, 0xffff0000, v52
    v_cvt_pk_bf16_f32 v62, v9, v41
    v_lshlrev_b32 v63, 16, v62
    v_and_b32 v59, 0xffff0000, v62
    v_add_f32 v63, v63, v61
    v_cvt_pk_bf16_f32 v62, v63, v63
    v_lshlrev_b32 v63, 16, v62
    v_mul_f32 v62, 0xbfb8aa3b, v63
    v_exp_f32 v62, v62
    s_nop 0
    v_add_f32 v62, 1.0, v62
    v_rcp_f32 v62, v62
    s_nop 0
    v_mul_f32 v63, v63, v62
    v_cvt_pk_bf16_f32 v62, v63, v63
    v_lshlrev_b32 v63, 16, v62
    v_mul_f32 v63, v63, v59
    v_cvt_pk_bf16_f32 v62, v63, v63
    v_lshlrev_b32 v63, 16, v62
    v_add_f32 v9, v60, v63
    v_lshlrev_b32 v60, 16, v49
    v_lshlrev_b32 v61, 16, v53
    v_cvt_pk_bf16_f32 v62, v10, v42
    v_lshlrev_b32 v63, 16, v62
    v_and_b32 v59, 0xffff0000, v62
    v_add_f32 v63, v63, v61
    v_cvt_pk_bf16_f32 v62, v63, v63
    v_lshlrev_b32 v63, 16, v62
    v_mul_f32 v62, 0xbfb8aa3b, v63
    v_exp_f32 v62, v62
    s_nop 0
    v_add_f32 v62, 1.0, v62
    v_rcp_f32 v62, v62
    s_nop 0
    v_mul_f32 v63, v63, v62
    v_cvt_pk_bf16_f32 v62, v63, v63
    v_lshlrev_b32 v63, 16, v62
    v_mul_f32 v63, v63, v59
    v_cvt_pk_bf16_f32 v62, v63, v63
    v_lshlrev_b32 v63, 16, v62
    v_add_f32 v10, v60, v63
    v_and_b32 v60, 0xffff0000, v49
    v_and_b32 v61, 0xffff0000, v53
    v_cvt_pk_bf16_f32 v62, v11, v43
    v_lshlrev_b32 v63, 16, v62
    v_and_b32 v59, 0xffff0000, v62
    v_add_f32 v63, v63, v61
    v_cvt_pk_bf16_f32 v62, v63, v63
    v_lshlrev_b32 v63, 16, v62
    v_mul_f32 v62, 0xbfb8aa3b, v63
    v_exp_f32 v62, v62
    s_nop 0
    v_add_f32 v62, 1.0, v62
    v_rcp_f32 v62, v62
    s_nop 0
    v_mul_f32 v63, v63, v62
    v_cvt_pk_bf16_f32 v62, v63, v63
    v_lshlrev_b32 v63, 16, v62
    v_mul_f32 v63, v63, v59
    v_cvt_pk_bf16_f32 v62, v63, v63
    v_lshlrev_b32 v63, 16, v62
    v_add_f32 v11, v60, v63
    v_lshlrev_b32 v60, 16, v50
    v_lshlrev_b32 v61, 16, v54
    v_cvt_pk_bf16_f32 v62, v12, v44
    v_lshlrev_b32 v63, 16, v62
    v_and_b32 v59, 0xffff0000, v62
    v_add_f32 v63, v63, v61
    v_cvt_pk_bf16_f32 v62, v63, v63
    v_lshlrev_b32 v63, 16, v62
    v_mul_f32 v62, 0xbfb8aa3b, v63
    v_exp_f32 v62, v62
    s_nop 0
    v_add_f32 v62, 1.0, v62
    v_rcp_f32 v62, v62
    s_nop 0
    v_mul_f32 v63, v63, v62
    v_cvt_pk_bf16_f32 v62, v63, v63
    v_lshlrev_b32 v63, 16, v62
    v_mul_f32 v63, v63, v59
    v_cvt_pk_bf16_f32 v62, v63, v63
    v_lshlrev_b32 v63, 16, v62
    v_add_f32 v12, v60, v63
    v_and_b32 v60, 0xffff0000, v50
    v_and_b32 v61, 0xffff0000, v54
    v_cvt_pk_bf16_f32 v62, v13, v45
    v_lshlrev_b32 v63, 16, v62
    v_and_b32 v59, 0xffff0000, v62
    v_add_f32 v63, v63, v61
    v_cvt_pk_bf16_f32 v62, v63, v63
    v_lshlrev_b32 v63, 16, v62
    v_mul_f32 v62, 0xbfb8aa3b, v63
    v_exp_f32 v62, v62
    s_nop 0
    v_add_f32 v62, 1.0, v62
    v_rcp_f32 v62, v62
    s_nop 0
    v_mul_f32 v63, v63, v62
    v_cvt_pk_bf16_f32 v62, v63, v63
    v_lshlrev_b32 v63, 16, v62
    v_mul_f32 v63, v63, v59
    v_cvt_pk_bf16_f32 v62, v63, v63
    v_lshlrev_b32 v63, 16, v62
    v_add_f32 v13, v60, v63
    v_lshlrev_b32 v60, 16, v51
    v_lshlrev_b32 v61, 16, v55
    v_cvt_pk_bf16_f32 v62, v14, v46
    v_lshlrev_b32 v63, 16, v62
    v_and_b32 v59, 0xffff0000, v62
    v_add_f32 v63, v63, v61
    v_cvt_pk_bf16_f32 v62, v63, v63
    v_lshlrev_b32 v63, 16, v62
    v_mul_f32 v62, 0xbfb8aa3b, v63
    v_exp_f32 v62, v62
    s_nop 0
    v_add_f32 v62, 1.0, v62
    v_rcp_f32 v62, v62
    s_nop 0
    v_mul_f32 v63, v63, v62
    v_cvt_pk_bf16_f32 v62, v63, v63
    v_lshlrev_b32 v63, 16, v62
    v_mul_f32 v63, v63, v59
    v_cvt_pk_bf16_f32 v62, v63, v63
    v_lshlrev_b32 v63, 16, v62
    v_add_f32 v14, v60, v63
    v_and_b32 v60, 0xffff0000, v51
    v_and_b32 v61, 0xffff0000, v55
    v_cvt_pk_bf16_f32 v62, v15, v47
    v_lshlrev_b32 v63, 16, v62
    v_and_b32 v59, 0xffff0000, v62
    v_add_f32 v63, v63, v61
    v_cvt_pk_bf16_f32 v62, v63, v63
    v_lshlrev_b32 v63, 16, v62
    v_mul_f32 v62, 0xbfb8aa3b, v63
    v_exp_f32 v62, v62
    s_nop 0
    v_add_f32 v62, 1.0, v62
    v_rcp_f32 v62, v62
    s_nop 0
    v_mul_f32 v63, v63, v62
    v_cvt_pk_bf16_f32 v62, v63, v63
    v_lshlrev_b32 v63, 16, v62
    v_mul_f32 v63, v63, v59
    v_cvt_pk_bf16_f32 v62, v63, v63
    v_lshlrev_b32 v63, 16, v62
    v_add_f32 v15, v60, v63
    v_cvt_pk_bf16_f32 v16, v8, v9
    v_cvt_pk_bf16_f32 v17, v10, v11
    v_cvt_pk_bf16_f32 v18, v12, v13
    v_cvt_pk_bf16_f32 v19, v14, v15
    buffer_store_dwordx4 v[16:19], v4, s[28:31], 0 offen
.rd_end:
    s_endpgm
.section .rodata,"a"
.p2align 6
.amdhsa_kernel ln_kernel
  .amdhsa_next_free_vgpr 120
  .amdhsa_next_free_sgpr 102
  .amdhsa_accum_offset 120
  .amdhsa_group_segment_fixed_size 0
  .amdhsa_kernarg_size 96
  .amdhsa_user_sgpr_count 2
  .amdhsa_user_sgpr_kernarg_segment_ptr 1
  .amdhsa_system_sgpr_workgroup_id_x 1
.end_amdhsa_kernel
.p2align 6
.amdhsa_kernel gemm1_kernel
  .amdhsa_next_free_vgpr 168
  .amdhsa_next_free_sgpr 102
  .amdhsa_accum_offset 168
  .amdhsa_group_segment_fixed_size 0
  .amdhsa_kernarg_size 96
  .amdhsa_user_sgpr_count 2
  .amdhsa_user_sgpr_kernarg_segment_ptr 1
  .amdhsa_system_sgpr_workgroup_id_x 1
.end_amdhsa_kernel
.p2align 6
.amdhsa_kernel attna_kernel
  .amdhsa_next_free_vgpr 200
  .amdhsa_next_free_sgpr 102
  .amdhsa_accum_offset 200
  .amdhsa_group_segment_fixed_size 0
  .amdhsa_kernarg_size 96
  .amdhsa_user_sgpr_count 2
  .amdhsa_user_sgpr_kernarg_segment_ptr 1
  .amdhsa_system_sgpr_workgroup_id_x 1
.end_amdhsa_kernel
.p2align 6
.amdhsa_kernel attnb_kernel
  .amdhsa_next_free_vgpr 200
  .amdhsa_next_free_sgpr 102
  .amdhsa_accum_offset 200
  .amdhsa_group_segment_fixed_size 0
  .amdhsa_kernarg_size 96
  .amdhsa_user_sgpr_count 2
  .amdhsa_user_sgpr_kernarg_segment_ptr 1
  .amdhsa_system_sgpr_workgroup_id_x 1
.end_amdhsa_kernel
.p2align 6
.amdhsa_kernel gemm5_kernel
  .amdhsa_next_free_vgpr 184
  .amdhsa_next_free_sgpr 102
  .amdhsa_accum_offset 184
  .amdhsa_group_segment_fixed_size 0
  .amdhsa_kernarg_size 96
  .amdhsa_user_sgpr_count 2
  .amdhsa_user_sgpr_kernarg_segment_ptr 1
  .amdhsa_system_sgpr_workgroup_id_x 1
.end_amdhsa_kernel
.p2align 6
.amdhsa_kernel reduce_kernel
  .amdhsa_next_free_vgpr 64
  .amdhsa_next_free_sgpr 102
  .amdhsa_accum_offset 64
  .amdhsa_group_segment_fixed_size 0
  .amdhsa_kernarg_size 96
  .amdhsa_user_sgpr_count 2
  .amdhsa_user_sgpr_kernarg_segment_ptr 1
  .amdhsa_system_sgpr_workgroup_id_x 1
.end_amdhsa_kernel
```
